```python
import torch

def _softmax(x, axis=-1):
    return torch.softmax(x, dim=axis)

def _gelu(x):
    return torch.nn.functional.gelu(x, approximate='tanh')

def _silu(x):
    return torch.nn.functional.silu(x)

def _sigmoid(x):
    return torch.sigmoid(x)

def _layernorm(x, axis=-1, eps=1e-05):
    m = x.mean(dim=axis, keepdim=True)
    v = x.var(dim=axis, keepdim=True, unbiased=False)
    return (x - m) / torch.sqrt(v + eps)

def _scatter_add(tgt, idx, src, axis=0):
    return tgt.clone().index_add_(axis, idx, src)

def _segment_sum(src, seg, n):
    out = torch.zeros((n,) + src.shape[1:], dtype=src.dtype)
    return out.index_add_(0, seg, src)

def _pad(x, pw):
    flat = tuple((v for pair in reversed(pw) for v in pair))
    return torch.nn.functional.pad(x, flat)
kernel_name = 'gated_mix__ssm_conv_s5__mixer_gmlp__prompt'

def setup_inputs():

    _w = lambda a: (lambda t: t.to(torch.bfloat16) if t.is_floating_point() else t)(torch.as_tensor(a))

    def _A_setup():
        B, S, D = (1, 2048, 512)
        P = D
        Lambda_re = -0.5 * (lambda _x: torch.exp(torch.as_tensor(_x)))((lambda *s: torch.randn(*s, dtype=torch.bfloat16) * 0.8)(P))
        Lambda_im = (lambda *s: torch.randn(*s, dtype=torch.bfloat16) * 0.8)(P) * 1.0
        B_re = (lambda *s: torch.randn(*s, dtype=torch.bfloat16) * 0.8)(P, D) * D ** (-0.5)
        B_im = (lambda *s: torch.randn(*s, dtype=torch.bfloat16) * 0.8)(P, D) * D ** (-0.5)
        C_re = (lambda *s: torch.randn(*s, dtype=torch.bfloat16) * 0.8)(D, P) * P ** (-0.5)
        C_im = (lambda *s: torch.randn(*s, dtype=torch.bfloat16) * 0.8)(D, P) * P ** (-0.5)
        log_dt = (lambda *s: torch.randn(*s, dtype=torch.bfloat16) * 0.8)(P) * 0.3 - 2.0
        Dskip = (lambda *s: torch.randn(*s, dtype=torch.bfloat16) * 0.8)(D)
        return {'x': _w((lambda *s: torch.randn(*s, dtype=torch.bfloat16) * 0.05)(B, S, D)), 'Lambda_re': _w(Lambda_re), 'Lambda_im': _w(Lambda_im), 'B_re': _w(B_re), 'B_im': _w(B_im), 'C_re': _w(C_re), 'C_im': _w(C_im), 'log_dt': _w(log_dt), 'Dskip': _w(Dskip)}
    _A_in = _A_setup()

    def _B_setup():
        B, S, D, F = (1, 2048, 512, 1376)
        Fh = F // 2
        return {'x': _w((lambda *s: torch.randn(*s, dtype=torch.bfloat16) * 0.05)(B, S, D)), 'w_in': _w((lambda *s: torch.randn(*s, dtype=torch.bfloat16) * 0.2)(D, 2 * Fh)), 'w_sp': _w(0.01 * (lambda *s: torch.randn(*s, dtype=torch.bfloat16) * 0.2)(S, S)), 'b_sp': _w(1.0 + 0.01 * (lambda *s: torch.randn(*s, dtype=torch.bfloat16) * 0.05)(S)), 'w_out': _w((lambda *s: torch.randn(*s, dtype=torch.bfloat16) * 0.05)(Fh, D))}
    _B_in = _B_setup()
    return {'A_x': _A_in['x'], 'A_Lambda_re': _A_in['Lambda_re'], 'A_Lambda_im': _A_in['Lambda_im'], 'A_B_re': _A_in['B_re'], 'A_B_im': _A_in['B_im'], 'A_C_re': _A_in['C_re'], 'A_C_im': _A_in['C_im'], 'A_log_dt': _A_in['log_dt'], 'A_Dskip': _A_in['Dskip'], 'B_x': _B_in['x'], 'B_w_in': _B_in['w_in'], 'B_w_sp': _B_in['w_sp'], 'B_b_sp': _B_in['b_sp'], 'B_w_out': _B_in['w_out'], 'gate_w': _w((lambda *s: torch.randn(*s, dtype=torch.bfloat16) * 0.05)(512) * 16.0)}

def reference(A_x, A_Lambda_re, A_Lambda_im, A_B_re, A_B_im, A_C_re, A_C_im, A_log_dt, A_Dskip, B_x, B_w_in, B_w_sp, B_b_sp, B_w_out, gate_w):

    def _A_ref(x, Lambda_re, Lambda_im, B_re, B_im, C_re, C_im, log_dt, Dskip):
        Bsz, L, H = x.shape
        Lam = Lambda_re + 1j * Lambda_im
        Bmat = B_re + 1j * B_im
        Cmat = C_re + 1j * C_im
        dt = torch.exp(log_dt)
        Lam_bar = torch.exp(dt * Lam)
        B_bar = ((Lam_bar - 1.0) / Lam)[:, None] * Bmat
        Bu = torch.einsum('bld,pd->blp', x + 0j, B_bar)
        h = torch.zeros_like(Bu[:, 0, :])
        hs = []
        for t in range(L):
            h = Lam_bar[None, :] * h + Bu[:, t, :]
            hs.append(h)
        hseq = torch.stack(hs, 1)
        y = 2.0 * torch.einsum('blp,dp->bld', hseq, Cmat).real + x * Dskip[None, None, :]
        return y

    def _B_ref(x, w_in, w_sp, b_sp, w_out):
        B, S, D = x.shape
        F = w_in.shape[-1]
        Fh = F // 2
        z = _gelu(torch.einsum('bsd,df->bsf', x, w_in))
        z1 = z[..., :Fh].clone()
        z2 = _layernorm(z[..., Fh:], axis=-1)
        g = torch.einsum('ts,bsf->btf', w_sp, z2) + b_sp[None, :, None]
        return torch.einsum('bsf,fd->bsd', z1 * g, w_out)
    x = A_x
    g = _sigmoid((x * gate_w).sum(-1, keepdims=True))
    a = _A_ref(x, A_Lambda_re, A_Lambda_im, A_B_re, A_B_im, A_C_re, A_C_im, A_log_dt, A_Dskip)
    b = _B_ref(x, B_w_in, B_w_sp, B_b_sp, B_w_out)
    return g * a + (1 - g) * b
```

```asm
; @launch grid=(256,1,1) block=(512,1,1) lds=163840
.amdgcn_target "amdgcn-amd-amdhsa--gfx950"
.text
.globl gated_mix__ssm_conv_s5__mixer_gmlp__prompt_kernel
.p2align 8
.type gated_mix__ssm_conv_s5__mixer_gmlp__prompt_kernel,@function
gated_mix__ssm_conv_s5__mixer_gmlp__prompt_kernel:
  s_cmp_ge_u32 s2, 256
  s_cbranch_scc1 L_end
  s_load_dwordx16 s[16:31], s[0:1], 0
  s_load_dwordx16 s[32:47], s[0:1], 64
  s_load_dwordx4 s[48:51], s[0:1], 128
  s_memrealtime s[76:77]
  v_lshrrev_b32 v2, 6, v0
  v_and_b32 v1, 63, v0
  v_readfirstlane_b32 s3, v2
  s_and_b32 s81, s2, 1
  s_bfe_u32 s4, s2, 0x20001
  s_bfe_u32 s11, s2, 0x20003
  s_lshl2_add_u32 s4, s4, s11
  s_lshr_b32 s82, s2, 5
  s_lshl1_add_u32 s78, s4, s82
  s_mul_i32 s8, s81, 6
  s_add_u32 s8, s8, s82
  s_cmp_eq_u32 s8, 11
  s_cselect_b32 s8, 15, s8
  s_lshl1_add_u32 s11, s81, s82
  s_add_u32 s11, s11, 5
  s_cmp_ge_u32 s82, 6
  s_cselect_b32 s8, s11, s8
  s_and_b32 s10, s82, 1
  s_lshr_b32 s9, s82, 1
  s_lshl2_add_u32 s9, s81, s9
  s_cmp_lt_u32 s3, 4
  s_cbranch_scc1 L_cons
  s_sub_u32 s3, s3, 4
  s_lshl_b32 s84, s3, 12
  v_and_b32 v2, 7, v1
  v_lshrrev_b32 v3, 4, v1
  v_xor_b32 v5, v2, v3
  v_lshlrev_b32 v5, 4, v5
  v_lshrrev_b32 v4, 3, v1
  s_cmp_eq_u32 s8, 15
  s_cbranch_scc1 L_gateload
  s_cmp_lt_u32 s8, 11
  s_cbranch_scc1 L_zload
  s_and_b32 s12, s3, 1
  s_lshl_b32 s12, s12, 5
  s_lshl_b32 s11, s4, 7
  s_add_u32 s11, s11, s12
  s_lshr_b32 s13, s3, 1
  s_lshl3_add_u32 s11, s13, s11
  v_lshrrev_b32 v2, 5, v1
  v_bfe_u32 v3, v1, 3, 1
  v_lshl_add_u32 v2, v2, 2, v3
  v_bfe_u32 v3, v1, 4, 1
  v_lshl_add_u32 v2, v2, 4, v3
  v_add_u32 v2, s11, v2
  v_lshl_add_u32 v6, v2, 10, v5
  v_xor_b32 v7, 64, v6
  v_add_u32 v8, 2048, v6
  v_add_u32 v9, 3072, v7
  v_add_u32 v7, 1024, v7
  s_sub_u32 s11, s8, 11
  s_lshl2_add_u32 s11, s11, s3
  s_lshl_b32 s11, s11, 5
  v_add_u32 v2, s11, v4
  v_lshl_add_u32 v10, v2, 10, v5
  v_xor_b32 v11, 64, v10
  v_add_u32 v12, 14336, v10
  v_add_u32 v13, 21504, v11
  v_add_u32 v11, 7168, v11
  s_waitcnt lgkmcnt(0)
  s_mov_b32 s52, s16
  s_and_b32 s53, s17, 0xffff
  s_mov_b32 s54, 0x200000
  s_mov_b32 s55, 0x20000
  s_mov_b32 s56, s22
  s_and_b32 s57, s23, 0xffff
  s_mov_b32 s58, 0x80000
  s_mov_b32 s59, 0x20000
  s_mov_b32 s16, s24
  s_and_b32 s17, s25, 0xffff
  s_mov_b32 s18, 0x80000
  s_mov_b32 s19, 0x20000
  s_and_b32 s20, s78, 7
  s_lshl_b32 s20, s20, 7
  s_add_u32 m0, s84, 0
  s_and_b32 s20, s20, 0x380
  buffer_load_dwordx4 v6, s[52:55], s20 offen offset:0 lds
  buffer_load_dwordx4 v7, s[52:55], s20 offen offset:1024 lds
  buffer_load_dwordx4 v8, s[52:55], s20 offen offset:2048 lds
  buffer_load_dwordx4 v9, s[52:55], s20 offen offset:3072 lds
  s_add_u32 m0, s84, 16384
  s_nop 0
  buffer_load_dwordx4 v10, s[56:59], s20 offen offset:0 lds
  buffer_load_dwordx4 v11, s[56:59], s20 offen offset:1024 lds
  buffer_load_dwordx4 v12, s[56:59], s20 offen offset:2048 lds
  buffer_load_dwordx4 v13, s[56:59], s20 offen offset:3072 lds
  s_add_u32 m0, s84, 32768
  s_nop 0
  buffer_load_dwordx4 v10, s[16:19], s20 offen offset:0 lds
  buffer_load_dwordx4 v11, s[16:19], s20 offen offset:1024 lds
  buffer_load_dwordx4 v12, s[16:19], s20 offen offset:2048 lds
  buffer_load_dwordx4 v13, s[16:19], s20 offen offset:3072 lds
  s_addk_i32 s20, 128
  s_add_u32 m0, s84, 49152
  s_and_b32 s20, s20, 0x380
  buffer_load_dwordx4 v6, s[52:55], s20 offen offset:0 lds
  buffer_load_dwordx4 v7, s[52:55], s20 offen offset:1024 lds
  buffer_load_dwordx4 v8, s[52:55], s20 offen offset:2048 lds
  buffer_load_dwordx4 v9, s[52:55], s20 offen offset:3072 lds
  s_add_u32 m0, s84, 65536
  s_nop 0
  buffer_load_dwordx4 v10, s[56:59], s20 offen offset:0 lds
  buffer_load_dwordx4 v11, s[56:59], s20 offen offset:1024 lds
  buffer_load_dwordx4 v12, s[56:59], s20 offen offset:2048 lds
  buffer_load_dwordx4 v13, s[56:59], s20 offen offset:3072 lds
  s_add_u32 m0, s84, 81920
  s_nop 0
  buffer_load_dwordx4 v10, s[16:19], s20 offen offset:0 lds
  buffer_load_dwordx4 v11, s[16:19], s20 offen offset:1024 lds
  buffer_load_dwordx4 v12, s[16:19], s20 offen offset:2048 lds
  buffer_load_dwordx4 v13, s[16:19], s20 offen offset:3072 lds
  s_addk_i32 s20, 128
  s_waitcnt vmcnt(12)
  s_barrier
  s_add_u32 m0, s84, 98304
  s_and_b32 s20, s20, 0x380
  buffer_load_dwordx4 v6, s[52:55], s20 offen offset:0 lds
  buffer_load_dwordx4 v7, s[52:55], s20 offen offset:1024 lds
  buffer_load_dwordx4 v8, s[52:55], s20 offen offset:2048 lds
  buffer_load_dwordx4 v9, s[52:55], s20 offen offset:3072 lds
  s_add_u32 m0, s84, 114688
  s_nop 0
  buffer_load_dwordx4 v10, s[56:59], s20 offen offset:0 lds
  buffer_load_dwordx4 v11, s[56:59], s20 offen offset:1024 lds
  buffer_load_dwordx4 v12, s[56:59], s20 offen offset:2048 lds
  buffer_load_dwordx4 v13, s[56:59], s20 offen offset:3072 lds
  s_add_u32 m0, s84, 131072
  s_nop 0
  buffer_load_dwordx4 v10, s[16:19], s20 offen offset:0 lds
  buffer_load_dwordx4 v11, s[16:19], s20 offen offset:1024 lds
  buffer_load_dwordx4 v12, s[16:19], s20 offen offset:2048 lds
  buffer_load_dwordx4 v13, s[16:19], s20 offen offset:3072 lds
  s_addk_i32 s20, 128
  s_waitcnt vmcnt(12)
  s_barrier
  s_add_u32 m0, s84, 0
  s_and_b32 s20, s20, 0x380
  buffer_load_dwordx4 v6, s[52:55], s20 offen offset:0 lds
  buffer_load_dwordx4 v7, s[52:55], s20 offen offset:1024 lds
  buffer_load_dwordx4 v8, s[52:55], s20 offen offset:2048 lds
  buffer_load_dwordx4 v9, s[52:55], s20 offen offset:3072 lds
  s_add_u32 m0, s84, 16384
  s_nop 0
  buffer_load_dwordx4 v10, s[56:59], s20 offen offset:0 lds
  buffer_load_dwordx4 v11, s[56:59], s20 offen offset:1024 lds
  buffer_load_dwordx4 v12, s[56:59], s20 offen offset:2048 lds
  buffer_load_dwordx4 v13, s[56:59], s20 offen offset:3072 lds
  s_add_u32 m0, s84, 32768
  s_nop 0
  buffer_load_dwordx4 v10, s[16:19], s20 offen offset:0 lds
  buffer_load_dwordx4 v11, s[16:19], s20 offen offset:1024 lds
  buffer_load_dwordx4 v12, s[16:19], s20 offen offset:2048 lds
  buffer_load_dwordx4 v13, s[16:19], s20 offen offset:3072 lds
  s_addk_i32 s20, 128
  s_waitcnt vmcnt(12)
  s_barrier
  s_add_u32 m0, s84, 49152
  s_and_b32 s20, s20, 0x380
  buffer_load_dwordx4 v6, s[52:55], s20 offen offset:0 lds
  buffer_load_dwordx4 v7, s[52:55], s20 offen offset:1024 lds
  buffer_load_dwordx4 v8, s[52:55], s20 offen offset:2048 lds
  buffer_load_dwordx4 v9, s[52:55], s20 offen offset:3072 lds
  s_add_u32 m0, s84, 65536
  s_nop 0
  buffer_load_dwordx4 v10, s[56:59], s20 offen offset:0 lds
  buffer_load_dwordx4 v11, s[56:59], s20 offen offset:1024 lds
  buffer_load_dwordx4 v12, s[56:59], s20 offen offset:2048 lds
  buffer_load_dwordx4 v13, s[56:59], s20 offen offset:3072 lds
  s_add_u32 m0, s84, 81920
  s_nop 0
  buffer_load_dwordx4 v10, s[16:19], s20 offen offset:0 lds
  buffer_load_dwordx4 v11, s[16:19], s20 offen offset:1024 lds
  buffer_load_dwordx4 v12, s[16:19], s20 offen offset:2048 lds
  buffer_load_dwordx4 v13, s[16:19], s20 offen offset:3072 lds
  s_addk_i32 s20, 128
  s_waitcnt vmcnt(12)
  s_barrier
  s_add_u32 m0, s84, 98304
  s_and_b32 s20, s20, 0x380
  buffer_load_dwordx4 v6, s[52:55], s20 offen offset:0 lds
  buffer_load_dwordx4 v7, s[52:55], s20 offen offset:1024 lds
  buffer_load_dwordx4 v8, s[52:55], s20 offen offset:2048 lds
  buffer_load_dwordx4 v9, s[52:55], s20 offen offset:3072 lds
  s_add_u32 m0, s84, 114688
  s_nop 0
  buffer_load_dwordx4 v10, s[56:59], s20 offen offset:0 lds
  buffer_load_dwordx4 v11, s[56:59], s20 offen offset:1024 lds
  buffer_load_dwordx4 v12, s[56:59], s20 offen offset:2048 lds
  buffer_load_dwordx4 v13, s[56:59], s20 offen offset:3072 lds
  s_add_u32 m0, s84, 131072
  s_nop 0
  buffer_load_dwordx4 v10, s[16:19], s20 offen offset:0 lds
  buffer_load_dwordx4 v11, s[16:19], s20 offen offset:1024 lds
  buffer_load_dwordx4 v12, s[16:19], s20 offen offset:2048 lds
  buffer_load_dwordx4 v13, s[16:19], s20 offen offset:3072 lds
  s_addk_i32 s20, 128
  s_waitcnt vmcnt(12)
  s_barrier
  s_add_u32 m0, s84, 0
  s_and_b32 s20, s20, 0x380
  buffer_load_dwordx4 v6, s[52:55], s20 offen offset:0 lds
  buffer_load_dwordx4 v7, s[52:55], s20 offen offset:1024 lds
  buffer_load_dwordx4 v8, s[52:55], s20 offen offset:2048 lds
  buffer_load_dwordx4 v9, s[52:55], s20 offen offset:3072 lds
  s_add_u32 m0, s84, 16384
  s_nop 0
  buffer_load_dwordx4 v10, s[56:59], s20 offen offset:0 lds
  buffer_load_dwordx4 v11, s[56:59], s20 offen offset:1024 lds
  buffer_load_dwordx4 v12, s[56:59], s20 offen offset:2048 lds
  buffer_load_dwordx4 v13, s[56:59], s20 offen offset:3072 lds
  s_add_u32 m0, s84, 32768
  s_nop 0
  buffer_load_dwordx4 v10, s[16:19], s20 offen offset:0 lds
  buffer_load_dwordx4 v11, s[16:19], s20 offen offset:1024 lds
  buffer_load_dwordx4 v12, s[16:19], s20 offen offset:2048 lds
  buffer_load_dwordx4 v13, s[16:19], s20 offen offset:3072 lds
  s_addk_i32 s20, 128
  s_waitcnt vmcnt(12)
  s_barrier
  s_add_u32 m0, s84, 49152
  s_and_b32 s20, s20, 0x380
  buffer_load_dwordx4 v6, s[52:55], s20 offen offset:0 lds
  buffer_load_dwordx4 v7, s[52:55], s20 offen offset:1024 lds
  buffer_load_dwordx4 v8, s[52:55], s20 offen offset:2048 lds
  buffer_load_dwordx4 v9, s[52:55], s20 offen offset:3072 lds
  s_add_u32 m0, s84, 65536
  s_nop 0
  buffer_load_dwordx4 v10, s[56:59], s20 offen offset:0 lds
  buffer_load_dwordx4 v11, s[56:59], s20 offen offset:1024 lds
  buffer_load_dwordx4 v12, s[56:59], s20 offen offset:2048 lds
  buffer_load_dwordx4 v13, s[56:59], s20 offen offset:3072 lds
  s_add_u32 m0, s84, 81920
  s_nop 0
  buffer_load_dwordx4 v10, s[16:19], s20 offen offset:0 lds
  buffer_load_dwordx4 v11, s[16:19], s20 offen offset:1024 lds
  buffer_load_dwordx4 v12, s[16:19], s20 offen offset:2048 lds
  buffer_load_dwordx4 v13, s[16:19], s20 offen offset:3072 lds
  s_addk_i32 s20, 128
  s_waitcnt vmcnt(12)
  s_barrier
  s_mov_b32 s60, s50
  s_and_b32 s61, s51, 0xffff
  s_mov_b32 s62, 0x1280000
  s_mov_b32 s63, 0x20000
  s_mov_b32 s72, s42
  s_and_b32 s73, s43, 0xffff
  s_mov_b32 s74, 0xac000
  s_mov_b32 s75, 0x20000
  s_mov_b32 s68, s28
  s_and_b32 s69, s29, 0xffff
  s_mov_b32 s70, 0x80000
  s_mov_b32 s71, 0x20000
  v_lshrrev_b32 v2, 3, v1
  s_lshl_b32 s11, s3, 5
  v_add_u32 v2, s11, v2
  s_cmp_ge_u32 s82, 6
  s_cbranch_scc1 ysetup_1
  s_mov_b32 s64, s38
  s_and_b32 s65, s39, 0xffff
  s_mov_b32 s66, 0x800000
  s_mov_b32 s67, 0x20000
  s_lshl_b32 s11, s4, 7
  v_add_u32 v2, s11, v2
  v_lshl_add_u32 v14, v2, 12, v5
  v_xor_b32 v15, 64, v14
  v_add_u32 v16, 63488, v14
  v_add_u32 v17, 95232, v15
  v_add_u32 v15, 31744, v15
  s_movk_i32 s80, 3968
  s_lshr_b32 s22, s82, 0
  s_mul_i32 s22, s22, 512
  s_mul_i32 s12, s82, 0
  s_add_u32 s12, s12, s4
  s_add_u32 s11, s12, 0
  s_and_b32 s11, s11, 3
  s_lshl_b32 s16, s11, 7
  s_add_u32 s11, s12, 1
  s_and_b32 s11, s11, 3
  s_lshl_b32 s17, s11, 7
  s_add_u32 s11, s12, 2
  s_and_b32 s11, s11, 3
  s_lshl_b32 s18, s11, 7
  s_add_u32 s11, s12, 3
  s_and_b32 s11, s11, 3
  s_lshl_b32 s19, s11, 7
  s_lshl_b32 s11, s8, 18
  s_lshl_b32 s12, s3, 11
  s_add_u32 s11, s11, s12
  s_add_u32 s11, s11, 0x300000
  v_lshl_add_u32 v18, v1, 4, s11
  s_branch setupdone_2
ysetup_1:
  s_mov_b32 s64, s26
  s_and_b32 s65, s27, 0xffff
  s_mov_b32 s66, 0x80000
  s_mov_b32 s67, 0x20000
  s_sub_u32 s12, s8, 11
  s_lshl_b32 s11, s12, 7
  v_add_u32 v2, s11, v2
  v_lshl_add_u32 v14, v2, 10, v5
  v_xor_b32 v15, 64, v14
  v_add_u32 v16, 14336, v14
  v_add_u32 v17, 21504, v15
  v_add_u32 v15, 7168, v15
  s_movk_i32 s80, 896
  s_lshl_b32 s22, s10, 9
  s_lshl_b32 s11, s4, 18
  s_add_u32 s11, s11, s84
  s_add_u32 s11, s11, 0x600000
  v_lshl_add_u32 v18, v1, 4, s11
setupdone_2:
  s_mov_b32 s23, s22
  v_lshrrev_b32 v2, 3, v1
  s_lshl_b32 s11, s3, 4
  v_add_u32 v2, s11, v2
  v_and_b32 v3, 7, v1
  v_bfe_u32 v4, v1, 4, 1
  v_lshlrev_b32 v4, 2, v4
  v_xor_b32 v3, v3, v4
  s_lshl_b32 s11, s9, 7
  v_lshl_add_u32 v19, v3, 4, s11
  v_lshl_add_u32 v19, v2, 10, v19
  v_add_u32 v20, 7168, v19
  s_and_b32 s31, s9, 3
  s_mul_i32 s31, s31, 3
  s_waitcnt vmcnt(0)
  s_barrier
  s_barrier
  s_branch L_yload
L_zload:
  s_lshl_b32 s11, s4, 7
  s_lshl_b32 s12, s3, 5
  s_add_u32 s11, s11, s12
  v_add_u32 v2, s11, v4
  v_lshl_add_u32 v6, v2, 10, v5
  v_xor_b32 v7, 64, v6
  v_add_u32 v8, 14336, v6
  v_add_u32 v9, 21504, v7
  v_add_u32 v7, 7168, v7
  s_mul_i32 s11, s3, 44032
  s_lshl_b32 s12, s8, 7
  s_add_u32 s11, s11, s12
  s_add_u32 s11, s11, 1376
  v_and_b32 v2, 7, v1
  v_bfe_u32 v3, v1, 4, 1
  v_lshlrev_b32 v3, 2, v3
  v_xor_b32 v2, v2, v3
  v_mul_u32_u24 v3, 2752, v4
  v_lshl_add_u32 v2, v2, 4, v3
  v_add_u32 v10, s11, v2
  v_add_u32 v11, 20992, v10
  s_waitcnt lgkmcnt(0)
  s_mov_b32 s52, s16
  s_and_b32 s53, s17, 0xffff
  s_mov_b32 s54, 0x200000
  s_mov_b32 s55, 0x20000
  s_mov_b32 s56, s36
  s_and_b32 s57, s37, 0xffff
  s_mov_b32 s58, 0x158000
  s_mov_b32 s59, 0x20000
  s_and_b32 s20, s78, 7
  s_mul_i32 s21, s20, 176128
  s_mov_b32 s24, 176128
  s_mov_b32 s25, 1409024
  s_lshl_b32 s20, s20, 7
  s_lshr_b32 s30, s84, 1
  s_add_u32 m0, s30, 131072
  s_nop 0
  buffer_load_dwordx4 v10, s[56:59], s21 offen offset:0 lds
  buffer_load_dwordx4 v11, s[56:59], s21 offen offset:1024 lds
  s_add_u32 s21, s21, s24
  s_cmp_eq_u32 s21, s25
  s_cselect_b32 s21, 0, s21
  s_add_u32 m0, s84, 0
  s_and_b32 s20, s20, 0x380
  buffer_load_dwordx4 v6, s[52:55], s20 offen offset:0 lds
  buffer_load_dwordx4 v7, s[52:55], s20 offen offset:1024 lds
  buffer_load_dwordx4 v8, s[52:55], s20 offen offset:2048 lds
  buffer_load_dwordx4 v9, s[52:55], s20 offen offset:3072 lds
  s_addk_i32 s20, 128
  s_add_u32 m0, s30, 139264
  s_nop 0
  buffer_load_dwordx4 v10, s[56:59], s21 offen offset:0 lds
  buffer_load_dwordx4 v11, s[56:59], s21 offen offset:1024 lds
  s_add_u32 s21, s21, s24
  s_cmp_eq_u32 s21, s25
  s_cselect_b32 s21, 0, s21
  s_add_u32 m0, s84, 16384
  s_and_b32 s20, s20, 0x380
  buffer_load_dwordx4 v6, s[52:55], s20 offen offset:0 lds
  buffer_load_dwordx4 v7, s[52:55], s20 offen offset:1024 lds
  buffer_load_dwordx4 v8, s[52:55], s20 offen offset:2048 lds
  buffer_load_dwordx4 v9, s[52:55], s20 offen offset:3072 lds
  s_addk_i32 s20, 128
  s_add_u32 m0, s30, 147456
  s_nop 0
  buffer_load_dwordx4 v10, s[56:59], s21 offen offset:0 lds
  buffer_load_dwordx4 v11, s[56:59], s21 offen offset:1024 lds
  s_add_u32 s21, s21, s24
  s_cmp_eq_u32 s21, s25
  s_cselect_b32 s21, 0, s21
  s_add_u32 m0, s84, 32768
  s_and_b32 s20, s20, 0x380
  buffer_load_dwordx4 v6, s[52:55], s20 offen offset:0 lds
  buffer_load_dwordx4 v7, s[52:55], s20 offen offset:1024 lds
  buffer_load_dwordx4 v8, s[52:55], s20 offen offset:2048 lds
  buffer_load_dwordx4 v9, s[52:55], s20 offen offset:3072 lds
  s_addk_i32 s20, 128
  s_add_u32 m0, s30, 155648
  s_nop 0
  buffer_load_dwordx4 v10, s[56:59], s21 offen offset:0 lds
  buffer_load_dwordx4 v11, s[56:59], s21 offen offset:1024 lds
  s_add_u32 s21, s21, s24
  s_cmp_eq_u32 s21, s25
  s_cselect_b32 s21, 0, s21
  s_add_u32 m0, s84, 49152
  s_and_b32 s20, s20, 0x380
  buffer_load_dwordx4 v6, s[52:55], s20 offen offset:0 lds
  buffer_load_dwordx4 v7, s[52:55], s20 offen offset:1024 lds
  buffer_load_dwordx4 v8, s[52:55], s20 offen offset:2048 lds
  buffer_load_dwordx4 v9, s[52:55], s20 offen offset:3072 lds
  s_addk_i32 s20, 128
  s_waitcnt vmcnt(18)
  s_barrier
  s_add_u32 m0, s84, 65536
  s_and_b32 s20, s20, 0x380
  buffer_load_dwordx4 v6, s[52:55], s20 offen offset:0 lds
  buffer_load_dwordx4 v7, s[52:55], s20 offen offset:1024 lds
  buffer_load_dwordx4 v8, s[52:55], s20 offen offset:2048 lds
  buffer_load_dwordx4 v9, s[52:55], s20 offen offset:3072 lds
  s_addk_i32 s20, 128
  s_waitcnt vmcnt(16)
  s_barrier
  s_add_u32 m0, s30, 131072
  s_nop 0
  buffer_load_dwordx4 v10, s[56:59], s21 offen offset:0 lds
  buffer_load_dwordx4 v11, s[56:59], s21 offen offset:1024 lds
  s_add_u32 s21, s21, s24
  s_cmp_eq_u32 s21, s25
  s_cselect_b32 s21, 0, s21
  s_add_u32 m0, s84, 81920
  s_and_b32 s20, s20, 0x380
  buffer_load_dwordx4 v6, s[52:55], s20 offen offset:0 lds
  buffer_load_dwordx4 v7, s[52:55], s20 offen offset:1024 lds
  buffer_load_dwordx4 v8, s[52:55], s20 offen offset:2048 lds
  buffer_load_dwordx4 v9, s[52:55], s20 offen offset:3072 lds
  s_addk_i32 s20, 128
  s_waitcnt vmcnt(16)
  s_barrier
  s_add_u32 m0, s30, 139264
  s_nop 0
  buffer_load_dwordx4 v10, s[56:59], s21 offen offset:0 lds
  buffer_load_dwordx4 v11, s[56:59], s21 offen offset:1024 lds
  s_add_u32 s21, s21, s24
  s_cmp_eq_u32 s21, s25
  s_cselect_b32 s21, 0, s21
  s_add_u32 m0, s84, 98304
  s_and_b32 s20, s20, 0x380
  buffer_load_dwordx4 v6, s[52:55], s20 offen offset:0 lds
  buffer_load_dwordx4 v7, s[52:55], s20 offen offset:1024 lds
  buffer_load_dwordx4 v8, s[52:55], s20 offen offset:2048 lds
  buffer_load_dwordx4 v9, s[52:55], s20 offen offset:3072 lds
  s_addk_i32 s20, 128
  s_waitcnt vmcnt(16)
  s_barrier
  s_add_u32 m0, s30, 147456
  s_nop 0
  buffer_load_dwordx4 v10, s[56:59], s21 offen offset:0 lds
  buffer_load_dwordx4 v11, s[56:59], s21 offen offset:1024 lds
  s_add_u32 s21, s21, s24
  s_cmp_eq_u32 s21, s25
  s_cselect_b32 s21, 0, s21
  s_add_u32 m0, s84, 114688
  s_and_b32 s20, s20, 0x380
  buffer_load_dwordx4 v6, s[52:55], s20 offen offset:0 lds
  buffer_load_dwordx4 v7, s[52:55], s20 offen offset:1024 lds
  buffer_load_dwordx4 v8, s[52:55], s20 offen offset:2048 lds
  buffer_load_dwordx4 v9, s[52:55], s20 offen offset:3072 lds
  s_addk_i32 s20, 128
  s_waitcnt vmcnt(16)
  s_barrier
  s_add_u32 m0, s30, 155648
  s_nop 0
  buffer_load_dwordx4 v10, s[56:59], s21 offen offset:0 lds
  buffer_load_dwordx4 v11, s[56:59], s21 offen offset:1024 lds
  s_add_u32 s21, s21, s24
  s_cmp_eq_u32 s21, s25
  s_cselect_b32 s21, 0, s21
  s_waitcnt vmcnt(12)
  s_barrier
  s_add_u32 m0, s30, 131072
  v_subrev_u32 v10, 1376, v10
  v_subrev_u32 v11, 1376, v11
  buffer_load_dwordx4 v10, s[56:59], s21 offen offset:0 lds
  buffer_load_dwordx4 v11, s[56:59], s21 offen offset:1024 lds
  s_add_u32 s21, s21, s24
  s_cmp_eq_u32 s21, s25
  s_cselect_b32 s21, 0, s21
  s_waitcnt vmcnt(8)
  s_barrier
  s_add_u32 m0, s30, 139264
  s_nop 0
  buffer_load_dwordx4 v10, s[56:59], s21 offen offset:0 lds
  buffer_load_dwordx4 v11, s[56:59], s21 offen offset:1024 lds
  s_add_u32 s21, s21, s24
  s_cmp_eq_u32 s21, s25
  s_cselect_b32 s21, 0, s21
  s_waitcnt vmcnt(4)
  s_barrier
  s_add_u32 m0, s30, 147456
  s_nop 0
  buffer_load_dwordx4 v10, s[56:59], s21 offen offset:0 lds
  buffer_load_dwordx4 v11, s[56:59], s21 offen offset:1024 lds
  s_add_u32 s21, s21, s24
  s_cmp_eq_u32 s21, s25
  s_cselect_b32 s21, 0, s21
  s_mov_b32 s60, s50
  s_and_b32 s61, s51, 0xffff
  s_mov_b32 s62, 0x1280000
  s_mov_b32 s63, 0x20000
  s_mov_b32 s72, s42
  s_and_b32 s73, s43, 0xffff
  s_mov_b32 s74, 0xac000
  s_mov_b32 s75, 0x20000
  s_mov_b32 s68, s28
  s_and_b32 s69, s29, 0xffff
  s_mov_b32 s70, 0x80000
  s_mov_b32 s71, 0x20000
  v_lshrrev_b32 v2, 3, v1
  s_lshl_b32 s11, s3, 5
  v_add_u32 v2, s11, v2
  s_cmp_ge_u32 s82, 6
  s_cbranch_scc1 ysetup_3
  s_mov_b32 s64, s38
  s_and_b32 s65, s39, 0xffff
  s_mov_b32 s66, 0x800000
  s_mov_b32 s67, 0x20000
  s_lshl_b32 s11, s4, 7
  v_add_u32 v2, s11, v2
  v_lshl_add_u32 v14, v2, 12, v5
  v_xor_b32 v15, 64, v14
  v_add_u32 v16, 63488, v14
  v_add_u32 v17, 95232, v15
  v_add_u32 v15, 31744, v15
  s_movk_i32 s80, 3968
  s_lshr_b32 s22, s82, 0
  s_mul_i32 s22, s22, 512
  s_mul_i32 s12, s82, 0
  s_add_u32 s12, s12, s4
  s_add_u32 s11, s12, 0
  s_and_b32 s11, s11, 3
  s_lshl_b32 s16, s11, 7
  s_add_u32 s11, s12, 1
  s_and_b32 s11, s11, 3
  s_lshl_b32 s17, s11, 7
  s_add_u32 s11, s12, 2
  s_and_b32 s11, s11, 3
  s_lshl_b32 s18, s11, 7
  s_add_u32 s11, s12, 3
  s_and_b32 s11, s11, 3
  s_lshl_b32 s19, s11, 7
  s_lshl_b32 s11, s8, 18
  s_lshl_b32 s12, s3, 11
  s_add_u32 s11, s11, s12
  s_add_u32 s11, s11, 0x300000
  v_lshl_add_u32 v18, v1, 4, s11
  s_branch setupdone_4
ysetup_3:
  s_mov_b32 s64, s26
  s_and_b32 s65, s27, 0xffff
  s_mov_b32 s66, 0x80000
  s_mov_b32 s67, 0x20000
  s_sub_u32 s12, s8, 11
  s_lshl_b32 s11, s12, 7
  v_add_u32 v2, s11, v2
  v_lshl_add_u32 v14, v2, 10, v5
  v_xor_b32 v15, 64, v14
  v_add_u32 v16, 14336, v14
  v_add_u32 v17, 21504, v15
  v_add_u32 v15, 7168, v15
  s_movk_i32 s80, 896
  s_lshl_b32 s22, s10, 9
  s_lshl_b32 s11, s4, 18
  s_add_u32 s11, s11, s84
  s_add_u32 s11, s11, 0x600000
  v_lshl_add_u32 v18, v1, 4, s11
setupdone_4:
  s_mov_b32 s23, s22
  v_lshrrev_b32 v2, 3, v1
  s_lshl_b32 s11, s3, 4
  v_add_u32 v2, s11, v2
  v_and_b32 v3, 7, v1
  v_bfe_u32 v4, v1, 4, 1
  v_lshlrev_b32 v4, 2, v4
  v_xor_b32 v3, v3, v4
  s_lshl_b32 s11, s9, 7
  v_lshl_add_u32 v19, v3, 4, s11
  v_lshl_add_u32 v19, v2, 10, v19
  v_add_u32 v20, 7168, v19
  s_and_b32 s31, s9, 3
  s_mul_i32 s31, s31, 3
  s_waitcnt vmcnt(4)
  s_barrier
  s_add_u32 m0, s30, 155648
  s_nop 0
  buffer_load_dwordx4 v10, s[56:59], s21 offen offset:0 lds
  buffer_load_dwordx4 v11, s[56:59], s21 offen offset:1024 lds
  s_add_u32 s21, s21, s24
  s_cmp_eq_u32 s21, s25
  s_cselect_b32 s21, 0, s21
  s_add_u32 s14, s22, 0
  s_and_b32 s14, s14, s80
  s_add_u32 s14, s14, s18
  buffer_load_dwordx4 v[32:35], v14, s[64:67], s14 offen offset:0
  buffer_load_dwordx4 v[36:39], v15, s[64:67], s14 offen offset:1024
  buffer_load_dwordx4 v[40:43], v16, s[64:67], s14 offen offset:2048
  buffer_load_dwordx4 v[44:47], v17, s[64:67], s14 offen offset:3072
  s_add_u32 s14, s22, 512
  s_and_b32 s14, s14, s80
  s_add_u32 s14, s14, s17
  buffer_load_dwordx4 v[32:35], v14, s[64:67], s14 offen offset:0
  buffer_load_dwordx4 v[36:39], v15, s[64:67], s14 offen offset:1024
  buffer_load_dwordx4 v[40:43], v16, s[64:67], s14 offen offset:2048
  buffer_load_dwordx4 v[44:47], v17, s[64:67], s14 offen offset:3072
  s_add_u32 s14, s22, 1024
  s_and_b32 s14, s14, s80
  s_add_u32 s14, s14, s16
  buffer_load_dwordx4 v[32:35], v14, s[64:67], s14 offen offset:0
  buffer_load_dwordx4 v[36:39], v15, s[64:67], s14 offen offset:1024
  buffer_load_dwordx4 v[40:43], v16, s[64:67], s14 offen offset:2048
  buffer_load_dwordx4 v[44:47], v17, s[64:67], s14 offen offset:3072
  s_waitcnt vmcnt(16)
  s_barrier
  s_add_u32 m0, s30, 0
  s_nop 0
  buffer_load_dwordx4 v10, s[56:59], s21 offen offset:0 lds
  buffer_load_dwordx4 v11, s[56:59], s21 offen offset:1024 lds
  s_add_u32 s21, s21, s24
  s_cmp_eq_u32 s21, s25
  s_cselect_b32 s21, 0, s21
  s_add_u32 m0, s30, 8192
  s_nop 0
  buffer_load_dwordx4 v10, s[56:59], s21 offen offset:0 lds
  buffer_load_dwordx4 v11, s[56:59], s21 offen offset:1024 lds
  s_add_u32 s21, s21, s24
  s_cmp_eq_u32 s21, s25
  s_cselect_b32 s21, 0, s21
  s_add_u32 m0, s30, 131072
  s_nop 0
  buffer_load_dwordx4 v10, s[56:59], s21 offen offset:0 lds
  buffer_load_dwordx4 v11, s[56:59], s21 offen offset:1024 lds
  s_add_u32 s21, s21, s24
  s_cmp_eq_u32 s21, s25
  s_cselect_b32 s21, 0, s21
  s_waitcnt vmcnt(20)
  s_barrier
  s_add_u32 m0, s30, 139264
  s_nop 0
  buffer_load_dwordx4 v10, s[56:59], s21 offen offset:0 lds
  buffer_load_dwordx4 v11, s[56:59], s21 offen offset:1024 lds
  s_add_u32 s21, s21, s24
  s_cmp_eq_u32 s21, s25
  s_cselect_b32 s21, 0, s21
  s_waitcnt vmcnt(20)
  s_barrier
  s_waitcnt vmcnt(6)
  s_barrier
  s_add_u32 s14, s22, 512
  s_and_b32 s14, s14, s80
  s_add_u32 m0, s84, 16384
  s_add_u32 s14, s14, s17
  buffer_load_dwordx4 v14, s[64:67], s14 offen offset:0 lds
  buffer_load_dwordx4 v15, s[64:67], s14 offen offset:1024 lds
  buffer_load_dwordx4 v16, s[64:67], s14 offen offset:2048 lds
  buffer_load_dwordx4 v17, s[64:67], s14 offen offset:3072 lds
  s_add_u32 s14, s22, 1024
  s_and_b32 s14, s14, s80
  s_add_u32 m0, s84, 32768
  s_add_u32 s14, s14, s16
  buffer_load_dwordx4 v14, s[64:67], s14 offen offset:0 lds
  buffer_load_dwordx4 v15, s[64:67], s14 offen offset:1024 lds
  buffer_load_dwordx4 v16, s[64:67], s14 offen offset:2048 lds
  buffer_load_dwordx4 v17, s[64:67], s14 offen offset:3072 lds
  s_waitcnt vmcnt(12)
  s_barrier
  s_waitcnt vmcnt(10)
  s_barrier
  s_add_u32 s14, s22, 0
  s_and_b32 s14, s14, s80
  s_add_u32 m0, s84, 0
  s_add_u32 s14, s14, s18
  buffer_load_dwordx4 v14, s[64:67], s14 offen offset:0 lds
  buffer_load_dwordx4 v15, s[64:67], s14 offen offset:1024 lds
  buffer_load_dwordx4 v16, s[64:67], s14 offen offset:2048 lds
  buffer_load_dwordx4 v17, s[64:67], s14 offen offset:3072 lds
  s_waitcnt vmcnt(12)
  s_barrier
  s_barrier
  s_branch L_gload
L_gload:
  s_lshr_b32 s30, s84, 1
  s_load_dwordx2 s[76:77], s[48:49], 0
  s_barrier
  s_add_u32 s14, s22, 0
  s_and_b32 s14, s14, s80
  s_add_u32 m0, s84, 49152
  s_add_u32 s14, s14, s16
  buffer_load_dwordx4 v14, s[64:67], s14 offen offset:0 lds
  buffer_load_dwordx4 v15, s[64:67], s14 offen offset:1024 lds
  buffer_load_dwordx4 v16, s[64:67], s14 offen offset:2048 lds
  buffer_load_dwordx4 v17, s[64:67], s14 offen offset:3072 lds
  s_add_u32 s14, s22, 0
  s_and_b32 s14, s14, s80
  s_add_u32 m0, s84, 65536
  s_add_u32 s14, s14, s17
  buffer_load_dwordx4 v14, s[64:67], s14 offen offset:0 lds
  buffer_load_dwordx4 v15, s[64:67], s14 offen offset:1024 lds
  buffer_load_dwordx4 v16, s[64:67], s14 offen offset:2048 lds
  buffer_load_dwordx4 v17, s[64:67], s14 offen offset:3072 lds
  s_add_u32 s14, s22, 0
  s_and_b32 s14, s14, s80
  s_add_u32 m0, s84, 81920
  s_add_u32 s14, s14, s19
  buffer_load_dwordx4 v14, s[64:67], s14 offen offset:0 lds
  buffer_load_dwordx4 v15, s[64:67], s14 offen offset:1024 lds
  buffer_load_dwordx4 v16, s[64:67], s14 offen offset:2048 lds
  buffer_load_dwordx4 v17, s[64:67], s14 offen offset:3072 lds
  s_add_u32 s14, s22, 512
  s_and_b32 s14, s14, s80
  s_add_u32 m0, s84, 98304
  s_add_u32 s14, s14, s16
  buffer_load_dwordx4 v14, s[64:67], s14 offen offset:0 lds
  buffer_load_dwordx4 v15, s[64:67], s14 offen offset:1024 lds
  buffer_load_dwordx4 v16, s[64:67], s14 offen offset:2048 lds
  buffer_load_dwordx4 v17, s[64:67], s14 offen offset:3072 lds
  s_waitcnt vmcnt(16)
  s_barrier
  s_barrier
  s_add_u32 s14, s22, 512
  s_and_b32 s14, s14, s80
  s_add_u32 m0, s84, 0
  s_add_u32 s14, s14, s18
  buffer_load_dwordx4 v14, s[64:67], s14 offen offset:0 lds
  buffer_load_dwordx4 v15, s[64:67], s14 offen offset:1024 lds
  buffer_load_dwordx4 v16, s[64:67], s14 offen offset:2048 lds
  buffer_load_dwordx4 v17, s[64:67], s14 offen offset:3072 lds
  s_add_u32 s14, s22, 512
  s_and_b32 s14, s14, s80
  s_add_u32 m0, s84, 16384
  s_add_u32 s14, s14, s19
  buffer_load_dwordx4 v14, s[64:67], s14 offen offset:0 lds
  buffer_load_dwordx4 v15, s[64:67], s14 offen offset:1024 lds
  buffer_load_dwordx4 v16, s[64:67], s14 offen offset:2048 lds
  buffer_load_dwordx4 v17, s[64:67], s14 offen offset:3072 lds
  s_add_u32 s14, s22, 1024
  s_and_b32 s14, s14, s80
  s_add_u32 m0, s84, 32768
  s_add_u32 s14, s14, s17
  buffer_load_dwordx4 v14, s[64:67], s14 offen offset:0 lds
  buffer_load_dwordx4 v15, s[64:67], s14 offen offset:1024 lds
  buffer_load_dwordx4 v16, s[64:67], s14 offen offset:2048 lds
  buffer_load_dwordx4 v17, s[64:67], s14 offen offset:3072 lds
  s_barrier
  s_add_u32 s14, s23, s16
  s_add_u32 m0, s30, 114688
  s_lshl_b32 s14, s14, 6
  buffer_load_dwordx4 v18, s[60:63], s14 offen offset:0 sc1 lds
  buffer_load_dwordx4 v18, s[60:63], s14 offen offset:1024 sc1 lds
  s_add_u32 s14, s23, s17
  s_add_u32 m0, s30, 122880
  s_lshl_b32 s14, s14, 6
  buffer_load_dwordx4 v18, s[60:63], s14 offen offset:0 sc1 lds
  buffer_load_dwordx4 v18, s[60:63], s14 offen offset:1024 sc1 lds
  s_add_u32 s14, s23, s18
  s_add_u32 m0, s30, 131072
  s_lshl_b32 s14, s14, 6
  buffer_load_dwordx4 v18, s[60:63], s14 offen offset:0 sc1 lds
  buffer_load_dwordx4 v18, s[60:63], s14 offen offset:1024 sc1 lds
  s_add_u32 s14, s23, s19
  s_add_u32 m0, s30, 139264
  s_lshl_b32 s14, s14, 6
  buffer_load_dwordx4 v18, s[60:63], s14 offen offset:0 sc1 lds
  buffer_load_dwordx4 v18, s[60:63], s14 offen offset:1024 sc1 lds
  s_addk_i32 s23, 512
  s_and_b32 s23, s23, s80
  s_add_u32 s14, s23, s16
  s_add_u32 m0, s30, 147456
  s_lshl_b32 s14, s14, 6
  buffer_load_dwordx4 v18, s[60:63], s14 offen offset:0 sc1 lds
  buffer_load_dwordx4 v18, s[60:63], s14 offen offset:1024 sc1 lds
  s_add_u32 s14, s23, s17
  s_add_u32 m0, s30, 155648
  s_lshl_b32 s14, s14, 6
  buffer_load_dwordx4 v18, s[60:63], s14 offen offset:0 sc1 lds
  buffer_load_dwordx4 v18, s[60:63], s14 offen offset:1024 sc1 lds
  s_waitcnt vmcnt(10)
  s_barrier
  s_waitcnt vmcnt(8)
  s_barrier
  s_add_u32 s14, s23, s18
  s_add_u32 m0, s30, 114688
  s_lshl_b32 s14, s14, 6
  buffer_load_dwordx4 v18, s[60:63], s14 offen offset:0 sc1 lds
  buffer_load_dwordx4 v18, s[60:63], s14 offen offset:1024 sc1 lds
  s_add_u32 s14, s22, 1024
  s_and_b32 s14, s14, s80
  s_add_u32 m0, s84, 49152
  s_add_u32 s14, s14, s18
  buffer_load_dwordx4 v14, s[64:67], s14 offen offset:0 lds
  buffer_load_dwordx4 v15, s[64:67], s14 offen offset:1024 lds
  buffer_load_dwordx4 v16, s[64:67], s14 offen offset:2048 lds
  buffer_load_dwordx4 v17, s[64:67], s14 offen offset:3072 lds
  s_waitcnt vmcnt(12)
  s_barrier
  s_add_u32 s14, s23, s19
  s_add_u32 m0, s30, 122880
  s_lshl_b32 s14, s14, 6
  buffer_load_dwordx4 v18, s[60:63], s14 offen offset:0 sc1 lds
  buffer_load_dwordx4 v18, s[60:63], s14 offen offset:1024 sc1 lds
  s_addk_i32 s23, 512
  s_and_b32 s23, s23, s80
  s_add_u32 s14, s22, 1024
  s_and_b32 s14, s14, s80
  s_add_u32 m0, s84, 65536
  s_add_u32 s14, s14, s19
  buffer_load_dwordx4 v14, s[64:67], s14 offen offset:0 lds
  buffer_load_dwordx4 v15, s[64:67], s14 offen offset:1024 lds
  buffer_load_dwordx4 v16, s[64:67], s14 offen offset:2048 lds
  buffer_load_dwordx4 v17, s[64:67], s14 offen offset:3072 lds
  s_waitcnt vmcnt(16)
  s_barrier
  s_add_u32 s14, s23, s16
  s_add_u32 m0, s30, 131072
  s_lshl_b32 s14, s14, 6
  buffer_load_dwordx4 v18, s[60:63], s14 offen offset:0 sc1 lds
  buffer_load_dwordx4 v18, s[60:63], s14 offen offset:1024 sc1 lds
  s_waitcnt vmcnt(16)
  s_barrier
  s_add_u32 s14, s23, s17
  s_add_u32 m0, s30, 139264
  s_lshl_b32 s14, s14, 6
  buffer_load_dwordx4 v18, s[60:63], s14 offen offset:0 sc1 lds
  buffer_load_dwordx4 v18, s[60:63], s14 offen offset:1024 sc1 lds
  s_add_u32 s14, s22, 1536
  s_and_b32 s14, s14, s80
  s_add_u32 m0, s84, 81920
  s_add_u32 s14, s14, s16
  buffer_load_dwordx4 v14, s[64:67], s14 offen offset:0 lds
  buffer_load_dwordx4 v15, s[64:67], s14 offen offset:1024 lds
  buffer_load_dwordx4 v16, s[64:67], s14 offen offset:2048 lds
  buffer_load_dwordx4 v17, s[64:67], s14 offen offset:3072 lds
  s_waitcnt vmcnt(20)
  s_barrier
  s_add_u32 s14, s23, s18
  s_add_u32 m0, s30, 147456
  s_lshl_b32 s14, s14, 6
  buffer_load_dwordx4 v18, s[60:63], s14 offen offset:0 sc1 lds
  buffer_load_dwordx4 v18, s[60:63], s14 offen offset:1024 sc1 lds
  s_add_u32 s14, s22, 1536
  s_and_b32 s14, s14, s80
  s_add_u32 m0, s84, 98304
  s_add_u32 s14, s14, s17
  buffer_load_dwordx4 v14, s[64:67], s14 offen offset:0 lds
  buffer_load_dwordx4 v15, s[64:67], s14 offen offset:1024 lds
  buffer_load_dwordx4 v16, s[64:67], s14 offen offset:2048 lds
  buffer_load_dwordx4 v17, s[64:67], s14 offen offset:3072 lds
  s_waitcnt vmcnt(24)
  s_barrier
  s_add_u32 s14, s23, s19
  s_add_u32 m0, s30, 155648
  s_lshl_b32 s14, s14, 6
  buffer_load_dwordx4 v18, s[60:63], s14 offen offset:0 sc1 lds
  buffer_load_dwordx4 v18, s[60:63], s14 offen offset:1024 sc1 lds
  s_addk_i32 s23, 512
  s_and_b32 s23, s23, s80
  s_waitcnt vmcnt(20)
  s_barrier
  s_add_u32 s14, s23, s16
  s_add_u32 m0, s30, 114688
  s_lshl_b32 s14, s14, 6
  buffer_load_dwordx4 v18, s[60:63], s14 offen offset:0 sc1 lds
  buffer_load_dwordx4 v18, s[60:63], s14 offen offset:1024 sc1 lds
  s_add_u32 s14, s22, 1536
  s_and_b32 s14, s14, s80
  s_add_u32 m0, s84, 0
  s_add_u32 s14, s14, s18
  buffer_load_dwordx4 v14, s[64:67], s14 offen offset:0 lds
  buffer_load_dwordx4 v15, s[64:67], s14 offen offset:1024 lds
  buffer_load_dwordx4 v16, s[64:67], s14 offen offset:2048 lds
  buffer_load_dwordx4 v17, s[64:67], s14 offen offset:3072 lds
  s_waitcnt vmcnt(20)
  s_barrier
  s_add_u32 s14, s23, s17
  s_add_u32 m0, s30, 122880
  s_lshl_b32 s14, s14, 6
  buffer_load_dwordx4 v18, s[60:63], s14 offen offset:0 sc1 lds
  buffer_load_dwordx4 v18, s[60:63], s14 offen offset:1024 sc1 lds
  s_add_u32 s14, s22, 1536
  s_and_b32 s14, s14, s80
  s_add_u32 m0, s84, 16384
  s_add_u32 s14, s14, s19
  buffer_load_dwordx4 v14, s[64:67], s14 offen offset:0 lds
  buffer_load_dwordx4 v15, s[64:67], s14 offen offset:1024 lds
  buffer_load_dwordx4 v16, s[64:67], s14 offen offset:2048 lds
  buffer_load_dwordx4 v17, s[64:67], s14 offen offset:3072 lds
  s_waitcnt vmcnt(24)
  s_barrier
  s_add_u32 s14, s23, s18
  s_add_u32 m0, s30, 131072
  s_lshl_b32 s14, s14, 6
  buffer_load_dwordx4 v18, s[60:63], s14 offen offset:0 sc1 lds
  buffer_load_dwordx4 v18, s[60:63], s14 offen offset:1024 sc1 lds
  s_waitcnt vmcnt(20)
  s_barrier
  s_add_u32 s14, s23, s19
  s_add_u32 m0, s30, 139264
  s_lshl_b32 s14, s14, 6
  buffer_load_dwordx4 v18, s[60:63], s14 offen offset:0 sc1 lds
  buffer_load_dwordx4 v18, s[60:63], s14 offen offset:1024 sc1 lds
  s_addk_i32 s23, 512
  s_and_b32 s23, s23, s80
  s_add_u32 s14, s22, 2048
  s_and_b32 s14, s14, s80
  s_add_u32 m0, s84, 32768
  s_add_u32 s14, s14, s16
  buffer_load_dwordx4 v14, s[64:67], s14 offen offset:0 lds
  buffer_load_dwordx4 v15, s[64:67], s14 offen offset:1024 lds
  buffer_load_dwordx4 v16, s[64:67], s14 offen offset:2048 lds
  buffer_load_dwordx4 v17, s[64:67], s14 offen offset:3072 lds
  s_waitcnt vmcnt(20)
  s_barrier
  s_add_u32 s14, s23, s16
  s_add_u32 m0, s30, 147456
  s_lshl_b32 s14, s14, 6
  buffer_load_dwordx4 v18, s[60:63], s14 offen offset:0 sc1 lds
  buffer_load_dwordx4 v18, s[60:63], s14 offen offset:1024 sc1 lds
  s_add_u32 s14, s22, 2048
  s_and_b32 s14, s14, s80
  s_add_u32 m0, s84, 49152
  s_add_u32 s14, s14, s17
  buffer_load_dwordx4 v14, s[64:67], s14 offen offset:0 lds
  buffer_load_dwordx4 v15, s[64:67], s14 offen offset:1024 lds
  buffer_load_dwordx4 v16, s[64:67], s14 offen offset:2048 lds
  buffer_load_dwordx4 v17, s[64:67], s14 offen offset:3072 lds
  s_waitcnt vmcnt(24)
  s_barrier
  s_add_u32 s14, s23, s17
  s_add_u32 m0, s30, 155648
  s_lshl_b32 s14, s14, 6
  buffer_load_dwordx4 v18, s[60:63], s14 offen offset:0 sc1 lds
  buffer_load_dwordx4 v18, s[60:63], s14 offen offset:1024 sc1 lds
  s_add_u32 s14, s22, 2048
  s_and_b32 s14, s14, s80
  s_add_u32 m0, s84, 65536
  s_add_u32 s14, s14, s18
  buffer_load_dwordx4 v14, s[64:67], s14 offen offset:0 lds
  buffer_load_dwordx4 v15, s[64:67], s14 offen offset:1024 lds
  buffer_load_dwordx4 v16, s[64:67], s14 offen offset:2048 lds
  buffer_load_dwordx4 v17, s[64:67], s14 offen offset:3072 lds
  s_waitcnt vmcnt(24)
  s_barrier
  s_add_u32 s14, s23, s18
  s_add_u32 m0, s30, 114688
  s_lshl_b32 s14, s14, 6
  buffer_load_dwordx4 v18, s[60:63], s14 offen offset:0 sc1 lds
  buffer_load_dwordx4 v18, s[60:63], s14 offen offset:1024 sc1 lds
  s_add_u32 s14, s22, 2048
  s_and_b32 s14, s14, s80
  s_add_u32 m0, s84, 81920
  s_add_u32 s14, s14, s19
  buffer_load_dwordx4 v14, s[64:67], s14 offen offset:0 lds
  buffer_load_dwordx4 v15, s[64:67], s14 offen offset:1024 lds
  buffer_load_dwordx4 v16, s[64:67], s14 offen offset:2048 lds
  buffer_load_dwordx4 v17, s[64:67], s14 offen offset:3072 lds
  s_waitcnt vmcnt(24)
  s_barrier
  s_add_u32 s14, s23, s19
  s_add_u32 m0, s30, 122880
  s_lshl_b32 s14, s14, 6
  buffer_load_dwordx4 v18, s[60:63], s14 offen offset:0 sc1 lds
  buffer_load_dwordx4 v18, s[60:63], s14 offen offset:1024 sc1 lds
  s_addk_i32 s23, 512
  s_and_b32 s23, s23, s80
  s_add_u32 s14, s22, 2560
  s_and_b32 s14, s14, s80
  s_add_u32 m0, s84, 98304
  s_add_u32 s14, s14, s16
  buffer_load_dwordx4 v14, s[64:67], s14 offen offset:0 lds
  buffer_load_dwordx4 v15, s[64:67], s14 offen offset:1024 lds
  buffer_load_dwordx4 v16, s[64:67], s14 offen offset:2048 lds
  buffer_load_dwordx4 v17, s[64:67], s14 offen offset:3072 lds
  s_waitcnt vmcnt(28)
  s_barrier
  s_add_u32 s14, s23, s16
  s_add_u32 m0, s30, 131072
  s_lshl_b32 s14, s14, 6
  buffer_load_dwordx4 v18, s[60:63], s14 offen offset:0 sc1 lds
  buffer_load_dwordx4 v18, s[60:63], s14 offen offset:1024 sc1 lds
  s_add_u32 s14, s22, 2560
  s_and_b32 s14, s14, s80
  s_add_u32 m0, s84, 0
  s_add_u32 s14, s14, s17
  buffer_load_dwordx4 v14, s[64:67], s14 offen offset:0 lds
  buffer_load_dwordx4 v15, s[64:67], s14 offen offset:1024 lds
  buffer_load_dwordx4 v16, s[64:67], s14 offen offset:2048 lds
  buffer_load_dwordx4 v17, s[64:67], s14 offen offset:3072 lds
  s_waitcnt vmcnt(28)
  s_barrier
  s_add_u32 s14, s23, s17
  s_add_u32 m0, s30, 139264
  s_lshl_b32 s14, s14, 6
  buffer_load_dwordx4 v18, s[60:63], s14 offen offset:0 sc1 lds
  buffer_load_dwordx4 v18, s[60:63], s14 offen offset:1024 sc1 lds
  s_add_u32 s14, s22, 2560
  s_and_b32 s14, s14, s80
  s_add_u32 m0, s84, 16384
  s_add_u32 s14, s14, s18
  buffer_load_dwordx4 v14, s[64:67], s14 offen offset:0 lds
  buffer_load_dwordx4 v15, s[64:67], s14 offen offset:1024 lds
  buffer_load_dwordx4 v16, s[64:67], s14 offen offset:2048 lds
  buffer_load_dwordx4 v17, s[64:67], s14 offen offset:3072 lds
  s_waitcnt vmcnt(28)
  s_barrier
  s_add_u32 s14, s23, s18
  s_add_u32 m0, s30, 147456
  s_lshl_b32 s14, s14, 6
  buffer_load_dwordx4 v18, s[60:63], s14 offen offset:0 sc1 lds
  buffer_load_dwordx4 v18, s[60:63], s14 offen offset:1024 sc1 lds
  s_add_u32 s14, s22, 2560
  s_and_b32 s14, s14, s80
  s_add_u32 m0, s84, 32768
  s_add_u32 s14, s14, s19
  buffer_load_dwordx4 v14, s[64:67], s14 offen offset:0 lds
  buffer_load_dwordx4 v15, s[64:67], s14 offen offset:1024 lds
  buffer_load_dwordx4 v16, s[64:67], s14 offen offset:2048 lds
  buffer_load_dwordx4 v17, s[64:67], s14 offen offset:3072 lds
  s_waitcnt vmcnt(28)
  s_barrier
  s_add_u32 s14, s23, s19
  s_add_u32 m0, s30, 155648
  s_lshl_b32 s14, s14, 6
  buffer_load_dwordx4 v18, s[60:63], s14 offen offset:0 sc1 lds
  buffer_load_dwordx4 v18, s[60:63], s14 offen offset:1024 sc1 lds
  s_addk_i32 s23, 512
  s_and_b32 s23, s23, s80
  s_add_u32 s14, s22, 3072
  s_and_b32 s14, s14, s80
  s_add_u32 m0, s84, 49152
  s_add_u32 s14, s14, s16
  buffer_load_dwordx4 v14, s[64:67], s14 offen offset:0 lds
  buffer_load_dwordx4 v15, s[64:67], s14 offen offset:1024 lds
  buffer_load_dwordx4 v16, s[64:67], s14 offen offset:2048 lds
  buffer_load_dwordx4 v17, s[64:67], s14 offen offset:3072 lds
  s_waitcnt vmcnt(28)
  s_barrier
  s_add_u32 s14, s23, s16
  s_add_u32 m0, s30, 114688
  s_lshl_b32 s14, s14, 6
  buffer_load_dwordx4 v18, s[60:63], s14 offen offset:0 sc1 lds
  buffer_load_dwordx4 v18, s[60:63], s14 offen offset:1024 sc1 lds
  s_add_u32 s14, s22, 3072
  s_and_b32 s14, s14, s80
  s_add_u32 m0, s84, 65536
  s_add_u32 s14, s14, s17
  buffer_load_dwordx4 v14, s[64:67], s14 offen offset:0 lds
  buffer_load_dwordx4 v15, s[64:67], s14 offen offset:1024 lds
  buffer_load_dwordx4 v16, s[64:67], s14 offen offset:2048 lds
  buffer_load_dwordx4 v17, s[64:67], s14 offen offset:3072 lds
  s_waitcnt vmcnt(28)
  s_barrier
  s_add_u32 s14, s23, s17
  s_add_u32 m0, s30, 122880
  s_lshl_b32 s14, s14, 6
  buffer_load_dwordx4 v18, s[60:63], s14 offen offset:0 sc1 lds
  buffer_load_dwordx4 v18, s[60:63], s14 offen offset:1024 sc1 lds
  s_add_u32 s14, s22, 3072
  s_and_b32 s14, s14, s80
  s_add_u32 m0, s84, 81920
  s_add_u32 s14, s14, s18
  buffer_load_dwordx4 v14, s[64:67], s14 offen offset:0 lds
  buffer_load_dwordx4 v15, s[64:67], s14 offen offset:1024 lds
  buffer_load_dwordx4 v16, s[64:67], s14 offen offset:2048 lds
  buffer_load_dwordx4 v17, s[64:67], s14 offen offset:3072 lds
  s_waitcnt vmcnt(28)
  s_barrier
  s_add_u32 s14, s23, s18
  s_add_u32 m0, s30, 131072
  s_lshl_b32 s14, s14, 6
  buffer_load_dwordx4 v18, s[60:63], s14 offen offset:0 sc1 lds
  buffer_load_dwordx4 v18, s[60:63], s14 offen offset:1024 sc1 lds
  s_add_u32 s14, s22, 3072
  s_and_b32 s14, s14, s80
  s_add_u32 m0, s84, 98304
  s_add_u32 s14, s14, s19
  buffer_load_dwordx4 v14, s[64:67], s14 offen offset:0 lds
  buffer_load_dwordx4 v15, s[64:67], s14 offen offset:1024 lds
  buffer_load_dwordx4 v16, s[64:67], s14 offen offset:2048 lds
  buffer_load_dwordx4 v17, s[64:67], s14 offen offset:3072 lds
  s_waitcnt vmcnt(28)
  s_barrier
  s_add_u32 s14, s23, s19
  s_add_u32 m0, s30, 139264
  s_lshl_b32 s14, s14, 6
  buffer_load_dwordx4 v18, s[60:63], s14 offen offset:0 sc1 lds
  buffer_load_dwordx4 v18, s[60:63], s14 offen offset:1024 sc1 lds
  s_addk_i32 s23, 512
  s_and_b32 s23, s23, s80
  s_add_u32 s14, s22, 3584
  s_and_b32 s14, s14, s80
  s_add_u32 m0, s84, 0
  s_add_u32 s14, s14, s16
  buffer_load_dwordx4 v14, s[64:67], s14 offen offset:0 lds
  buffer_load_dwordx4 v15, s[64:67], s14 offen offset:1024 lds
  buffer_load_dwordx4 v16, s[64:67], s14 offen offset:2048 lds
  buffer_load_dwordx4 v17, s[64:67], s14 offen offset:3072 lds
  s_waitcnt vmcnt(28)
  s_barrier
  s_add_u32 s14, s23, s16
  s_add_u32 m0, s30, 147456
  s_lshl_b32 s14, s14, 6
  buffer_load_dwordx4 v18, s[60:63], s14 offen offset:0 sc1 lds
  buffer_load_dwordx4 v18, s[60:63], s14 offen offset:1024 sc1 lds
  s_add_u32 s14, s22, 3584
  s_and_b32 s14, s14, s80
  s_add_u32 m0, s84, 16384
  s_add_u32 s14, s14, s17
  buffer_load_dwordx4 v14, s[64:67], s14 offen offset:0 lds
  buffer_load_dwordx4 v15, s[64:67], s14 offen offset:1024 lds
  buffer_load_dwordx4 v16, s[64:67], s14 offen offset:2048 lds
  buffer_load_dwordx4 v17, s[64:67], s14 offen offset:3072 lds
  s_waitcnt vmcnt(28)
  s_barrier
  s_add_u32 s14, s23, s17
  s_add_u32 m0, s30, 155648
  s_lshl_b32 s14, s14, 6
  buffer_load_dwordx4 v18, s[60:63], s14 offen offset:0 sc1 lds
  buffer_load_dwordx4 v18, s[60:63], s14 offen offset:1024 sc1 lds
  s_add_u32 s14, s22, 3584
  s_and_b32 s14, s14, s80
  s_add_u32 m0, s84, 32768
  s_add_u32 s14, s14, s18
  buffer_load_dwordx4 v14, s[64:67], s14 offen offset:0 lds
  buffer_load_dwordx4 v15, s[64:67], s14 offen offset:1024 lds
  buffer_load_dwordx4 v16, s[64:67], s14 offen offset:2048 lds
  buffer_load_dwordx4 v17, s[64:67], s14 offen offset:3072 lds
  s_waitcnt vmcnt(28)
  s_barrier
  s_add_u32 s14, s23, s18
  s_add_u32 m0, s30, 114688
  s_lshl_b32 s14, s14, 6
  buffer_load_dwordx4 v18, s[60:63], s14 offen offset:0 sc1 lds
  buffer_load_dwordx4 v18, s[60:63], s14 offen offset:1024 sc1 lds
  s_add_u32 s14, s22, 3584
  s_and_b32 s14, s14, s80
  s_add_u32 m0, s84, 49152
  s_add_u32 s14, s14, s19
  buffer_load_dwordx4 v14, s[64:67], s14 offen offset:0 lds
  buffer_load_dwordx4 v15, s[64:67], s14 offen offset:1024 lds
  buffer_load_dwordx4 v16, s[64:67], s14 offen offset:2048 lds
  buffer_load_dwordx4 v17, s[64:67], s14 offen offset:3072 lds
  s_waitcnt vmcnt(28)
  s_barrier
  s_add_u32 s14, s23, s19
  s_add_u32 m0, s30, 122880
  s_lshl_b32 s14, s14, 6
  buffer_load_dwordx4 v18, s[60:63], s14 offen offset:0 sc1 lds
  buffer_load_dwordx4 v18, s[60:63], s14 offen offset:1024 sc1 lds
  s_addk_i32 s23, 512
  s_and_b32 s23, s23, s80
  s_add_u32 s14, s31, 8
  s_sub_u32 s15, s14, 11
  s_cselect_b32 s14, s14, s15
  s_add_u32 m0, s30, 65536
  s_lshl_b32 s14, s14, 16
  buffer_load_dwordx4 v19, s[72:75], s14 offen lds
  buffer_load_dwordx4 v20, s[72:75], s14 offen offset:1024 lds
  s_waitcnt vmcnt(26)
  s_barrier
  s_waitcnt vmcnt(20)
  s_barrier
  s_waitcnt vmcnt(14)
  s_barrier
  s_add_u32 s14, s31, 0
  s_sub_u32 s15, s14, 11
  s_cselect_b32 s14, s14, s15
  s_add_u32 m0, s30, 0
  s_lshl_b32 s14, s14, 16
  buffer_load_dwordx4 v19, s[72:75], s14 offen lds
  buffer_load_dwordx4 v20, s[72:75], s14 offen offset:1024 lds
  s_add_u32 s14, s31, 1
  s_sub_u32 s15, s14, 11
  s_cselect_b32 s14, s14, s15
  s_add_u32 m0, s30, 8192
  s_lshl_b32 s14, s14, 16
  buffer_load_dwordx4 v19, s[72:75], s14 offen lds
  buffer_load_dwordx4 v20, s[72:75], s14 offen offset:1024 lds
  s_waitcnt vmcnt(12)
  s_barrier
  s_add_u32 s14, s31, 2
  s_sub_u32 s15, s14, 11
  s_cselect_b32 s14, s14, s15
  s_add_u32 m0, s30, 16384
  s_lshl_b32 s14, s14, 16
  buffer_load_dwordx4 v19, s[72:75], s14 offen lds
  buffer_load_dwordx4 v20, s[72:75], s14 offen offset:1024 lds
  s_add_u32 s14, s31, 3
  s_sub_u32 s15, s14, 11
  s_cselect_b32 s14, s14, s15
  s_add_u32 m0, s30, 24576
  s_lshl_b32 s14, s14, 16
  buffer_load_dwordx4 v19, s[72:75], s14 offen lds
  buffer_load_dwordx4 v20, s[72:75], s14 offen offset:1024 lds
  s_waitcnt vmcnt(10)
  s_barrier
  s_add_u32 s14, s31, 4
  s_sub_u32 s15, s14, 11
  s_cselect_b32 s14, s14, s15
  s_add_u32 m0, s30, 32768
  s_lshl_b32 s14, s14, 16
  buffer_load_dwordx4 v19, s[72:75], s14 offen lds
  buffer_load_dwordx4 v20, s[72:75], s14 offen offset:1024 lds
  s_add_u32 s14, s31, 5
  s_sub_u32 s15, s14, 11
  s_cselect_b32 s14, s14, s15
  s_add_u32 m0, s30, 40960
  s_lshl_b32 s14, s14, 16
  buffer_load_dwordx4 v19, s[72:75], s14 offen lds
  buffer_load_dwordx4 v20, s[72:75], s14 offen offset:1024 lds
  s_barrier
  s_add_u32 s14, s31, 6
  s_sub_u32 s15, s14, 11
  s_cselect_b32 s14, s14, s15
  s_add_u32 m0, s30, 49152
  s_lshl_b32 s14, s14, 16
  buffer_load_dwordx4 v19, s[72:75], s14 offen lds
  buffer_load_dwordx4 v20, s[72:75], s14 offen offset:1024 lds
  s_add_u32 s14, s31, 7
  s_sub_u32 s15, s14, 11
  s_cselect_b32 s14, s14, s15
  s_add_u32 m0, s30, 57344
  s_lshl_b32 s14, s14, 16
  buffer_load_dwordx4 v19, s[72:75], s14 offen lds
  buffer_load_dwordx4 v20, s[72:75], s14 offen offset:1024 lds
  s_branch L_p3load
L_yload:
  s_lshr_b32 s30, s84, 1
  s_load_dwordx2 s[76:77], s[48:49], 0
  s_add_u32 m0, s84, 0
  s_add_u32 s14, s22, 0
  s_and_b32 s14, s14, 0x300
  buffer_load_dwordx4 v14, s[64:67], s14 offen offset:0 lds
  buffer_load_dwordx4 v15, s[64:67], s14 offen offset:1024 lds
  buffer_load_dwordx4 v16, s[64:67], s14 offen offset:2048 lds
  buffer_load_dwordx4 v17, s[64:67], s14 offen offset:3072 lds
  s_add_u32 m0, s84, 16384
  s_add_u32 s14, s22, 256
  s_and_b32 s14, s14, 0x300
  buffer_load_dwordx4 v14, s[64:67], s14 offen offset:0 lds
  buffer_load_dwordx4 v15, s[64:67], s14 offen offset:1024 lds
  buffer_load_dwordx4 v16, s[64:67], s14 offen offset:2048 lds
  buffer_load_dwordx4 v17, s[64:67], s14 offen offset:3072 lds
  s_add_u32 m0, s84, 32768
  s_add_u32 s14, s22, 512
  s_and_b32 s14, s14, 0x300
  buffer_load_dwordx4 v14, s[64:67], s14 offen offset:0 lds
  buffer_load_dwordx4 v15, s[64:67], s14 offen offset:1024 lds
  buffer_load_dwordx4 v16, s[64:67], s14 offen offset:2048 lds
  buffer_load_dwordx4 v17, s[64:67], s14 offen offset:3072 lds
  s_add_u32 m0, s84, 49152
  s_add_u32 s14, s22, 768
  s_and_b32 s14, s14, 0x300
  buffer_load_dwordx4 v14, s[64:67], s14 offen offset:0 lds
  buffer_load_dwordx4 v15, s[64:67], s14 offen offset:1024 lds
  buffer_load_dwordx4 v16, s[64:67], s14 offen offset:2048 lds
  buffer_load_dwordx4 v17, s[64:67], s14 offen offset:3072 lds
  s_add_u32 m0, s84, 65536
  s_add_u32 s14, s22, 1024
  s_and_b32 s14, s14, 0x300
  buffer_load_dwordx4 v14, s[68:71], s14 offen offset:0 lds
  buffer_load_dwordx4 v15, s[68:71], s14 offen offset:1024 lds
  buffer_load_dwordx4 v16, s[68:71], s14 offen offset:2048 lds
  buffer_load_dwordx4 v17, s[68:71], s14 offen offset:3072 lds
  s_add_u32 m0, s84, 81920
  s_add_u32 s14, s22, 1280
  s_and_b32 s14, s14, 0x300
  buffer_load_dwordx4 v14, s[68:71], s14 offen offset:0 lds
  buffer_load_dwordx4 v15, s[68:71], s14 offen offset:1024 lds
  buffer_load_dwordx4 v16, s[68:71], s14 offen offset:2048 lds
  buffer_load_dwordx4 v17, s[68:71], s14 offen offset:3072 lds
  s_mov_b32 s85, 0x40000
  s_waitcnt lgkmcnt(0)
nl_5:
  s_cmp_lg_u32 s77, 0
  s_cbranch_scc1 nok_6
  s_sleep 32
  s_load_dwordx2 s[76:77], s[48:49], 0 glc
  s_waitcnt lgkmcnt(0)
  s_sub_u32 s85, s85, 1
  s_cbranch_scc0 nl_5
nok_6:
  s_lshl_b32 s11, s4, 12
  s_add_u32 s11, s11, 0x1170000
  v_lshl_add_u32 v2, v1, 7, s11
  s_sleep 40
  v_mov_b32 v3, 163832
  s_add_u32 s28, s76, 0
  s_mov_b32 s29, s77
  s_cmp_lg_u32 s3, 0
  s_cbranch_scc1 rw_7
  s_mov_b32 s85, 0x40000
  s_mov_b64 exec, 0xf
fpoll_10:
  buffer_load_dwordx2 v[28:29], v2, s[60:63], 0 offen sc1
fchk_12:
  s_waitcnt vmcnt(0)
  v_cmp_ne_u64 vcc, s[76:77], v[28:29]
  s_and_b64 exec, exec, vcc
  s_cbranch_execz fdone_11
  s_sub_u32 s85, s85, 1
  s_cbranch_scc1 fdone_11
  s_sleep 4
  s_branch fpoll_10
fdone_11:
  s_mov_b64 exec, -1
  v_mov_b32 v28, s28
  v_mov_b32 v29, s29
  ds_write_b64 v3, v[28:29]
  s_branch rd_8
rw_7:
  s_mov_b32 s85, 0x200000
rl_9:
  s_sleep 1
  ds_read_b64 v[28:29], v3
  s_waitcnt lgkmcnt(0)
  v_cmp_eq_u64 vcc, s[28:29], v[28:29]
  s_cbranch_vccnz rd_8
  s_sub_u32 s85, s85, 1
  s_cbranch_scc0 rl_9
rd_8:
  s_add_u32 m0, s84, 98304
  s_add_u32 s14, s22, 0
  s_and_b32 s14, s14, 0x300
  s_lshl_b32 s14, s14, 7
  buffer_load_dwordx4 v18, s[60:63], s14 offen offset:0 sc1 lds
  buffer_load_dwordx4 v18, s[60:63], s14 offen offset:1024 sc1 lds
  buffer_load_dwordx4 v18, s[60:63], s14 offen offset:2048 sc1 lds
  buffer_load_dwordx4 v18, s[60:63], s14 offen offset:3072 sc1 lds
  s_add_u32 m0, s84, 114688
  s_add_u32 s14, s22, 256
  s_and_b32 s14, s14, 0x300
  s_lshl_b32 s14, s14, 7
  buffer_load_dwordx4 v18, s[60:63], s14 offen offset:0 sc1 lds
  buffer_load_dwordx4 v18, s[60:63], s14 offen offset:1024 sc1 lds
  buffer_load_dwordx4 v18, s[60:63], s14 offen offset:2048 sc1 lds
  buffer_load_dwordx4 v18, s[60:63], s14 offen offset:3072 sc1 lds
  s_add_u32 m0, s84, 131072
  s_add_u32 s14, s22, 512
  s_and_b32 s14, s14, 0x300
  s_lshl_b32 s14, s14, 7
  buffer_load_dwordx4 v18, s[60:63], s14 offen offset:0 sc1 lds
  buffer_load_dwordx4 v18, s[60:63], s14 offen offset:1024 sc1 lds
  buffer_load_dwordx4 v18, s[60:63], s14 offen offset:2048 sc1 lds
  buffer_load_dwordx4 v18, s[60:63], s14 offen offset:3072 sc1 lds
  s_waitcnt vmcnt(8)
  s_barrier
  s_add_u32 m0, s84, 147456
  s_add_u32 s14, s22, 768
  s_and_b32 s14, s14, 0x300
  s_lshl_b32 s14, s14, 7
  buffer_load_dwordx4 v18, s[60:63], s14 offen offset:0 sc1 lds
  buffer_load_dwordx4 v18, s[60:63], s14 offen offset:1024 sc1 lds
  buffer_load_dwordx4 v18, s[60:63], s14 offen offset:2048 sc1 lds
  buffer_load_dwordx4 v18, s[60:63], s14 offen offset:3072 sc1 lds
  s_waitcnt vmcnt(8)
  s_barrier
  s_add_u32 m0, s84, 98304
  s_add_u32 s14, s22, 1024
  s_and_b32 s14, s14, 0x300
  s_lshl_b32 s14, s14, 7
  s_add_u32 s14, s14, 131072
  buffer_load_dwordx4 v18, s[60:63], s14 offen offset:0 sc1 lds
  buffer_load_dwordx4 v18, s[60:63], s14 offen offset:1024 sc1 lds
  buffer_load_dwordx4 v18, s[60:63], s14 offen offset:2048 sc1 lds
  buffer_load_dwordx4 v18, s[60:63], s14 offen offset:3072 sc1 lds
  s_add_u32 m0, s84, 0
  s_add_u32 s14, s22, 1536
  s_and_b32 s14, s14, 0x300
  buffer_load_dwordx4 v14, s[68:71], s14 offen offset:0 lds
  buffer_load_dwordx4 v15, s[68:71], s14 offen offset:1024 lds
  buffer_load_dwordx4 v16, s[68:71], s14 offen offset:2048 lds
  buffer_load_dwordx4 v17, s[68:71], s14 offen offset:3072 lds
  s_waitcnt vmcnt(12)
  s_barrier
  s_add_u32 m0, s84, 114688
  s_add_u32 s14, s22, 1280
  s_and_b32 s14, s14, 0x300
  s_lshl_b32 s14, s14, 7
  s_add_u32 s14, s14, 131072
  buffer_load_dwordx4 v18, s[60:63], s14 offen offset:0 sc1 lds
  buffer_load_dwordx4 v18, s[60:63], s14 offen offset:1024 sc1 lds
  buffer_load_dwordx4 v18, s[60:63], s14 offen offset:2048 sc1 lds
  buffer_load_dwordx4 v18, s[60:63], s14 offen offset:3072 sc1 lds
  s_mov_b64 exec, 0xffff0000
  buffer_load_dwordx2 v[28:29], v2, s[60:63], 0 offen sc1
  s_mov_b64 exec, -1
  s_add_u32 m0, s84, 16384
  s_add_u32 s14, s22, 1792
  s_and_b32 s14, s14, 0x300
  buffer_load_dwordx4 v14, s[68:71], s14 offen offset:0 lds
  buffer_load_dwordx4 v15, s[68:71], s14 offen offset:1024 lds
  buffer_load_dwordx4 v16, s[68:71], s14 offen offset:2048 lds
  buffer_load_dwordx4 v17, s[68:71], s14 offen offset:3072 lds
  s_waitcnt vmcnt(17)
  s_barrier
  s_add_u32 m0, s84, 131072
  s_add_u32 s14, s22, 1536
  s_and_b32 s14, s14, 0x300
  s_lshl_b32 s14, s14, 7
  s_add_u32 s14, s14, 131072
  buffer_load_dwordx4 v18, s[60:63], s14 offen offset:0 sc1 lds
  buffer_load_dwordx4 v18, s[60:63], s14 offen offset:1024 sc1 lds
  buffer_load_dwordx4 v18, s[60:63], s14 offen offset:2048 sc1 lds
  buffer_load_dwordx4 v18, s[60:63], s14 offen offset:3072 sc1 lds
  s_add_u32 m0, s84, 32768
  s_add_u32 s14, s22, 2048
  s_and_b32 s14, s14, 0x300
  s_or_b32 s14, s14, 128
  buffer_load_dwordx4 v14, s[64:67], s14 offen offset:0 lds
  buffer_load_dwordx4 v15, s[64:67], s14 offen offset:1024 lds
  buffer_load_dwordx4 v16, s[64:67], s14 offen offset:2048 lds
  buffer_load_dwordx4 v17, s[64:67], s14 offen offset:3072 lds
  s_waitcnt vmcnt(21)
  s_barrier
  s_add_u32 m0, s84, 147456
  s_add_u32 s14, s22, 1792
  s_and_b32 s14, s14, 0x300
  s_lshl_b32 s14, s14, 7
  s_add_u32 s14, s14, 131072
  buffer_load_dwordx4 v18, s[60:63], s14 offen offset:0 sc1 lds
  buffer_load_dwordx4 v18, s[60:63], s14 offen offset:1024 sc1 lds
  buffer_load_dwordx4 v18, s[60:63], s14 offen offset:2048 sc1 lds
  buffer_load_dwordx4 v18, s[60:63], s14 offen offset:3072 sc1 lds
  s_waitcnt vmcnt(16)
  s_mov_b64 exec, 0xffff0000
  v_cmp_ne_u64 vcc, s[76:77], v[28:29]
  s_mov_b64 exec, -1
  s_cbranch_vccz nop1_13
  s_mov_b32 s85, 0x40000
  s_mov_b64 exec, 0xffff0000
fpoll_14:
  buffer_load_dwordx2 v[28:29], v2, s[60:63], 0 offen sc1
fchk_16:
  s_waitcnt vmcnt(0)
  v_cmp_ne_u64 vcc, s[76:77], v[28:29]
  s_and_b64 exec, exec, vcc
  s_cbranch_execz fdone_15
  s_sub_u32 s85, s85, 1
  s_cbranch_scc1 fdone_15
  s_sleep 2
  s_branch fpoll_14
fdone_15:
  s_mov_b64 exec, -1
nop1_13:
  s_add_u32 m0, s84, 49152
  s_add_u32 s14, s22, 2304
  s_and_b32 s14, s14, 0x300
  s_or_b32 s14, s14, 128
  buffer_load_dwordx4 v14, s[64:67], s14 offen offset:0 lds
  buffer_load_dwordx4 v15, s[64:67], s14 offen offset:1024 lds
  buffer_load_dwordx4 v16, s[64:67], s14 offen offset:2048 lds
  buffer_load_dwordx4 v17, s[64:67], s14 offen offset:3072 lds
  s_barrier
  s_add_u32 m0, s84, 98304
  s_add_u32 s14, s22, 2048
  s_and_b32 s14, s14, 0x300
  s_or_b32 s14, s14, 128
  s_lshl_b32 s14, s14, 7
  buffer_load_dwordx4 v18, s[60:63], s14 offen offset:0 sc1 lds
  buffer_load_dwordx4 v18, s[60:63], s14 offen offset:1024 sc1 lds
  buffer_load_dwordx4 v18, s[60:63], s14 offen offset:2048 sc1 lds
  buffer_load_dwordx4 v18, s[60:63], s14 offen offset:3072 sc1 lds
  s_add_u32 m0, s84, 65536
  s_add_u32 s14, s22, 2560
  s_and_b32 s14, s14, 0x300
  s_or_b32 s14, s14, 128
  buffer_load_dwordx4 v14, s[64:67], s14 offen offset:0 lds
  buffer_load_dwordx4 v15, s[64:67], s14 offen offset:1024 lds
  buffer_load_dwordx4 v16, s[64:67], s14 offen offset:2048 lds
  buffer_load_dwordx4 v17, s[64:67], s14 offen offset:3072 lds
  s_waitcnt vmcnt(20)
  s_barrier
  s_add_u32 m0, s84, 114688
  s_add_u32 s14, s22, 2304
  s_and_b32 s14, s14, 0x300
  s_or_b32 s14, s14, 128
  s_lshl_b32 s14, s14, 7
  buffer_load_dwordx4 v18, s[60:63], s14 offen offset:0 sc1 lds
  buffer_load_dwordx4 v18, s[60:63], s14 offen offset:1024 sc1 lds
  buffer_load_dwordx4 v18, s[60:63], s14 offen offset:2048 sc1 lds
  buffer_load_dwordx4 v18, s[60:63], s14 offen offset:3072 sc1 lds
  s_add_u32 m0, s84, 81920
  s_add_u32 s14, s22, 2816
  s_and_b32 s14, s14, 0x300
  s_or_b32 s14, s14, 128
  buffer_load_dwordx4 v14, s[64:67], s14 offen offset:0 lds
  buffer_load_dwordx4 v15, s[64:67], s14 offen offset:1024 lds
  buffer_load_dwordx4 v16, s[64:67], s14 offen offset:2048 lds
  buffer_load_dwordx4 v17, s[64:67], s14 offen offset:3072 lds
  s_waitcnt vmcnt(20)
  s_barrier
  s_add_u32 m0, s84, 131072
  s_add_u32 s14, s22, 2560
  s_and_b32 s14, s14, 0x300
  s_or_b32 s14, s14, 128
  s_lshl_b32 s14, s14, 7
  buffer_load_dwordx4 v18, s[60:63], s14 offen offset:0 sc1 lds
  buffer_load_dwordx4 v18, s[60:63], s14 offen offset:1024 sc1 lds
  buffer_load_dwordx4 v18, s[60:63], s14 offen offset:2048 sc1 lds
  buffer_load_dwordx4 v18, s[60:63], s14 offen offset:3072 sc1 lds
  s_add_u32 m0, s84, 0
  s_add_u32 s14, s22, 3072
  s_and_b32 s14, s14, 0x300
  s_or_b32 s14, s14, 128
  buffer_load_dwordx4 v14, s[68:71], s14 offen offset:0 lds
  buffer_load_dwordx4 v15, s[68:71], s14 offen offset:1024 lds
  buffer_load_dwordx4 v16, s[68:71], s14 offen offset:2048 lds
  buffer_load_dwordx4 v17, s[68:71], s14 offen offset:3072 lds
  s_waitcnt vmcnt(20)
  s_barrier
  s_add_u32 m0, s84, 147456
  s_add_u32 s14, s22, 2816
  s_and_b32 s14, s14, 0x300
  s_or_b32 s14, s14, 128
  s_lshl_b32 s14, s14, 7
  buffer_load_dwordx4 v18, s[60:63], s14 offen offset:0 sc1 lds
  buffer_load_dwordx4 v18, s[60:63], s14 offen offset:1024 sc1 lds
  buffer_load_dwordx4 v18, s[60:63], s14 offen offset:2048 sc1 lds
  buffer_load_dwordx4 v18, s[60:63], s14 offen offset:3072 sc1 lds
  s_add_u32 m0, s84, 16384
  s_add_u32 s14, s22, 3328
  s_and_b32 s14, s14, 0x300
  s_or_b32 s14, s14, 128
  buffer_load_dwordx4 v14, s[68:71], s14 offen offset:0 lds
  buffer_load_dwordx4 v15, s[68:71], s14 offen offset:1024 lds
  buffer_load_dwordx4 v16, s[68:71], s14 offen offset:2048 lds
  buffer_load_dwordx4 v17, s[68:71], s14 offen offset:3072 lds
  s_waitcnt vmcnt(20)
  s_barrier
  s_add_u32 m0, s84, 98304
  s_add_u32 s14, s22, 3072
  s_and_b32 s14, s14, 0x300
  s_or_b32 s14, s14, 128
  s_lshl_b32 s14, s14, 7
  s_add_u32 s14, s14, 131072
  buffer_load_dwordx4 v18, s[60:63], s14 offen offset:0 sc1 lds
  buffer_load_dwordx4 v18, s[60:63], s14 offen offset:1024 sc1 lds
  buffer_load_dwordx4 v18, s[60:63], s14 offen offset:2048 sc1 lds
  buffer_load_dwordx4 v18, s[60:63], s14 offen offset:3072 sc1 lds
  s_add_u32 m0, s84, 32768
  s_add_u32 s14, s22, 3584
  s_and_b32 s14, s14, 0x300
  s_or_b32 s14, s14, 128
  buffer_load_dwordx4 v14, s[68:71], s14 offen offset:0 lds
  buffer_load_dwordx4 v15, s[68:71], s14 offen offset:1024 lds
  buffer_load_dwordx4 v16, s[68:71], s14 offen offset:2048 lds
  buffer_load_dwordx4 v17, s[68:71], s14 offen offset:3072 lds
  s_waitcnt vmcnt(20)
  s_barrier
  s_add_u32 m0, s84, 114688
  s_add_u32 s14, s22, 3328
  s_and_b32 s14, s14, 0x300
  s_or_b32 s14, s14, 128
  s_lshl_b32 s14, s14, 7
  s_add_u32 s14, s14, 131072
  buffer_load_dwordx4 v18, s[60:63], s14 offen offset:0 sc1 lds
  buffer_load_dwordx4 v18, s[60:63], s14 offen offset:1024 sc1 lds
  buffer_load_dwordx4 v18, s[60:63], s14 offen offset:2048 sc1 lds
  buffer_load_dwordx4 v18, s[60:63], s14 offen offset:3072 sc1 lds
  s_add_u32 m0, s84, 49152
  s_add_u32 s14, s22, 3840
  s_and_b32 s14, s14, 0x300
  s_or_b32 s14, s14, 128
  buffer_load_dwordx4 v14, s[68:71], s14 offen offset:0 lds
  buffer_load_dwordx4 v15, s[68:71], s14 offen offset:1024 lds
  buffer_load_dwordx4 v16, s[68:71], s14 offen offset:2048 lds
  buffer_load_dwordx4 v17, s[68:71], s14 offen offset:3072 lds
  s_waitcnt vmcnt(20)
  s_barrier
  s_add_u32 m0, s84, 131072
  s_add_u32 s14, s22, 3584
  s_and_b32 s14, s14, 0x300
  s_or_b32 s14, s14, 128
  s_lshl_b32 s14, s14, 7
  s_add_u32 s14, s14, 131072
  buffer_load_dwordx4 v18, s[60:63], s14 offen offset:0 sc1 lds
  buffer_load_dwordx4 v18, s[60:63], s14 offen offset:1024 sc1 lds
  buffer_load_dwordx4 v18, s[60:63], s14 offen offset:2048 sc1 lds
  buffer_load_dwordx4 v18, s[60:63], s14 offen offset:3072 sc1 lds
  s_add_u32 s14, s31, 8
  s_sub_u32 s15, s14, 11
  s_cselect_b32 s14, s14, s15
  s_add_u32 m0, s30, 65536
  s_lshl_b32 s14, s14, 16
  buffer_load_dwordx4 v19, s[72:75], s14 offen lds
  buffer_load_dwordx4 v20, s[72:75], s14 offen offset:1024 lds
  s_waitcnt vmcnt(18)
  s_barrier
  s_add_u32 m0, s84, 147456
  s_add_u32 s14, s22, 3840
  s_and_b32 s14, s14, 0x300
  s_or_b32 s14, s14, 128
  s_lshl_b32 s14, s14, 7
  s_add_u32 s14, s14, 131072
  buffer_load_dwordx4 v18, s[60:63], s14 offen offset:0 sc1 lds
  buffer_load_dwordx4 v18, s[60:63], s14 offen offset:1024 sc1 lds
  buffer_load_dwordx4 v18, s[60:63], s14 offen offset:2048 sc1 lds
  buffer_load_dwordx4 v18, s[60:63], s14 offen offset:3072 sc1 lds
  s_waitcnt vmcnt(14)
  s_barrier
  s_add_u32 s14, s31, 0
  s_sub_u32 s15, s14, 11
  s_cselect_b32 s14, s14, s15
  s_add_u32 m0, s30, 0
  s_lshl_b32 s14, s14, 16
  buffer_load_dwordx4 v19, s[72:75], s14 offen lds
  buffer_load_dwordx4 v20, s[72:75], s14 offen offset:1024 lds
  s_add_u32 s14, s31, 1
  s_sub_u32 s15, s14, 11
  s_cselect_b32 s14, s14, s15
  s_add_u32 m0, s30, 8192
  s_lshl_b32 s14, s14, 16
  buffer_load_dwordx4 v19, s[72:75], s14 offen lds
  buffer_load_dwordx4 v20, s[72:75], s14 offen offset:1024 lds
  s_waitcnt vmcnt(10)
  s_barrier
  s_add_u32 s14, s31, 2
  s_sub_u32 s15, s14, 11
  s_cselect_b32 s14, s14, s15
  s_add_u32 m0, s30, 16384
  s_lshl_b32 s14, s14, 16
  buffer_load_dwordx4 v19, s[72:75], s14 offen lds
  buffer_load_dwordx4 v20, s[72:75], s14 offen offset:1024 lds
  s_add_u32 s14, s31, 3
  s_sub_u32 s15, s14, 11
  s_cselect_b32 s14, s14, s15
  s_add_u32 m0, s30, 24576
  s_lshl_b32 s14, s14, 16
  buffer_load_dwordx4 v19, s[72:75], s14 offen lds
  buffer_load_dwordx4 v20, s[72:75], s14 offen offset:1024 lds
  s_waitcnt vmcnt(8)
  s_barrier
  s_add_u32 s14, s31, 4
  s_sub_u32 s15, s14, 11
  s_cselect_b32 s14, s14, s15
  s_add_u32 m0, s30, 32768
  s_lshl_b32 s14, s14, 16
  buffer_load_dwordx4 v19, s[72:75], s14 offen lds
  buffer_load_dwordx4 v20, s[72:75], s14 offen offset:1024 lds
  s_add_u32 s14, s31, 5
  s_sub_u32 s15, s14, 11
  s_cselect_b32 s14, s14, s15
  s_add_u32 m0, s30, 40960
  s_lshl_b32 s14, s14, 16
  buffer_load_dwordx4 v19, s[72:75], s14 offen lds
  buffer_load_dwordx4 v20, s[72:75], s14 offen offset:1024 lds
  s_barrier
  s_add_u32 s14, s31, 6
  s_sub_u32 s15, s14, 11
  s_cselect_b32 s14, s14, s15
  s_add_u32 m0, s30, 49152
  s_lshl_b32 s14, s14, 16
  buffer_load_dwordx4 v19, s[72:75], s14 offen lds
  buffer_load_dwordx4 v20, s[72:75], s14 offen offset:1024 lds
  s_add_u32 s14, s31, 7
  s_sub_u32 s15, s14, 11
  s_cselect_b32 s14, s14, s15
  s_add_u32 m0, s30, 57344
  s_lshl_b32 s14, s14, 16
  buffer_load_dwordx4 v19, s[72:75], s14 offen lds
  buffer_load_dwordx4 v20, s[72:75], s14 offen offset:1024 lds
  s_branch L_p3load
L_gateload:
  s_waitcnt lgkmcnt(0)
  s_mov_b32 s52, s16
  s_and_b32 s53, s17, 0xffff
  s_mov_b32 s54, 0x200000
  s_mov_b32 s55, 0x20000
  s_mov_b32 s60, s50
  s_and_b32 s61, s51, 0xffff
  s_mov_b32 s62, 0x1280000
  s_mov_b32 s63, 0x20000
  s_mov_b32 s72, s42
  s_and_b32 s73, s43, 0xffff
  s_mov_b32 s74, 0xac000
  s_mov_b32 s75, 0x20000
  s_mov_b32 s68, s28
  s_and_b32 s69, s29, 0xffff
  s_mov_b32 s70, 0x80000
  s_mov_b32 s71, 0x20000
  v_lshrrev_b32 v2, 3, v1
  s_lshl_b32 s11, s3, 5
  v_add_u32 v2, s11, v2
  s_cmp_ge_u32 s82, 6
  s_cbranch_scc1 ysetup_17
  s_mov_b32 s64, s38
  s_and_b32 s65, s39, 0xffff
  s_mov_b32 s66, 0x800000
  s_mov_b32 s67, 0x20000
  s_lshl_b32 s11, s4, 7
  v_add_u32 v2, s11, v2
  v_lshl_add_u32 v14, v2, 12, v5
  v_xor_b32 v15, 64, v14
  v_add_u32 v16, 63488, v14
  v_add_u32 v17, 95232, v15
  v_add_u32 v15, 31744, v15
  s_movk_i32 s80, 3968
  s_lshr_b32 s22, s82, 0
  s_mul_i32 s22, s22, 512
  s_mul_i32 s12, s82, 0
  s_add_u32 s12, s12, s4
  s_add_u32 s11, s12, 0
  s_and_b32 s11, s11, 3
  s_lshl_b32 s16, s11, 7
  s_add_u32 s11, s12, 1
  s_and_b32 s11, s11, 3
  s_lshl_b32 s17, s11, 7
  s_add_u32 s11, s12, 2
  s_and_b32 s11, s11, 3
  s_lshl_b32 s18, s11, 7
  s_add_u32 s11, s12, 3
  s_and_b32 s11, s11, 3
  s_lshl_b32 s19, s11, 7
  s_lshl_b32 s11, s8, 18
  s_lshl_b32 s12, s3, 11
  s_add_u32 s11, s11, s12
  s_add_u32 s11, s11, 0x300000
  v_lshl_add_u32 v18, v1, 4, s11
  s_branch setupdone_18
ysetup_17:
  s_mov_b32 s64, s26
  s_and_b32 s65, s27, 0xffff
  s_mov_b32 s66, 0x80000
  s_mov_b32 s67, 0x20000
  s_sub_u32 s12, s8, 11
  s_lshl_b32 s11, s12, 7
  v_add_u32 v2, s11, v2
  v_lshl_add_u32 v14, v2, 10, v5
  v_xor_b32 v15, 64, v14
  v_add_u32 v16, 14336, v14
  v_add_u32 v17, 21504, v15
  v_add_u32 v15, 7168, v15
  s_movk_i32 s80, 896
  s_lshl_b32 s22, s10, 9
  s_lshl_b32 s11, s4, 18
  s_add_u32 s11, s11, s84
  s_add_u32 s11, s11, 0x600000
  v_lshl_add_u32 v18, v1, 4, s11
setupdone_18:
  s_mov_b32 s23, s22
  v_lshrrev_b32 v2, 3, v1
  s_lshl_b32 s11, s3, 4
  v_add_u32 v2, s11, v2
  v_and_b32 v3, 7, v1
  v_bfe_u32 v4, v1, 4, 1
  v_lshlrev_b32 v4, 2, v4
  v_xor_b32 v3, v3, v4
  s_lshl_b32 s11, s9, 7
  v_lshl_add_u32 v19, v3, 4, s11
  v_lshl_add_u32 v19, v2, 10, v19
  v_add_u32 v20, 7168, v19
  s_and_b32 s31, s9, 3
  s_mul_i32 s31, s31, 3
  s_lshr_b32 s30, s84, 1
  s_lshl2_add_u32 s11, s4, s3
  s_lshl_b32 s12, s11, 13
  v_lshl_add_u32 v2, v1, 4, s12
  v_add_u32 v3, 4096, v2
  s_sleep 40
  s_lshl_b32 s12, s11, 17
  s_add_u32 s12, s12, 3072
  v_lshlrev_b32 v4, 4, v1
  buffer_load_dwordx4 v[32:35], v4, s[64:67], s12 offen
  s_addk_i32 s12, 0x1000
  buffer_load_dwordx4 v[36:39], v4, s[64:67], s12 offen
  s_addk_i32 s12, 0x1000
  buffer_load_dwordx4 v[40:43], v4, s[64:67], s12 offen
  s_addk_i32 s12, 0x1000
  buffer_load_dwordx4 v[44:47], v4, s[64:67], s12 offen
  s_addk_i32 s12, 0x1000
  buffer_load_dwordx4 v[48:51], v4, s[64:67], s12 offen
  s_addk_i32 s12, 0x1000
  buffer_load_dwordx4 v[52:55], v4, s[64:67], s12 offen
  s_addk_i32 s12, 0x1000
  buffer_load_dwordx4 v[56:59], v4, s[64:67], s12 offen
  s_addk_i32 s12, 0x1000
  buffer_load_dwordx4 v[60:63], v4, s[64:67], s12 offen
  s_addk_i32 s12, 0x1000
  buffer_load_dwordx4 v[32:35], v4, s[64:67], s12 offen
  s_addk_i32 s12, 0x1000
  buffer_load_dwordx4 v[36:39], v4, s[64:67], s12 offen
  s_addk_i32 s12, 0x1000
  buffer_load_dwordx4 v[40:43], v4, s[64:67], s12 offen
  s_addk_i32 s12, 0x1000
  buffer_load_dwordx4 v[44:47], v4, s[64:67], s12 offen
  s_addk_i32 s12, 0x1000
  buffer_load_dwordx4 v[48:51], v4, s[64:67], s12 offen
  s_addk_i32 s12, 0x1000
  buffer_load_dwordx4 v[52:55], v4, s[64:67], s12 offen
  s_addk_i32 s12, 0x1000
  buffer_load_dwordx4 v[56:59], v4, s[64:67], s12 offen
  s_addk_i32 s12, 0x1000
  buffer_load_dwordx4 v[60:63], v4, s[64:67], s12 offen
  s_addk_i32 s12, 0x1000
  buffer_load_dwordx4 v[32:35], v4, s[64:67], s12 offen
  s_addk_i32 s12, 0x1000
  buffer_load_dwordx4 v[36:39], v4, s[64:67], s12 offen
  s_addk_i32 s12, 0x1000
  buffer_load_dwordx4 v[40:43], v4, s[64:67], s12 offen
  s_addk_i32 s12, 0x1000
  buffer_load_dwordx4 v[44:47], v4, s[64:67], s12 offen
  s_addk_i32 s12, 0x1000
  buffer_load_dwordx4 v[48:51], v4, s[64:67], s12 offen
  s_addk_i32 s12, 0x1000
  buffer_load_dwordx4 v[52:55], v4, s[64:67], s12 offen
  s_addk_i32 s12, 0x1000
  buffer_load_dwordx4 v[56:59], v4, s[64:67], s12 offen
  s_addk_i32 s12, 0x1000
  buffer_load_dwordx4 v[60:63], v4, s[64:67], s12 offen
  s_addk_i32 s12, 0x1000
  buffer_load_dwordx4 v[32:35], v4, s[64:67], s12 offen
  s_addk_i32 s12, 0x1000
  buffer_load_dwordx4 v[36:39], v4, s[64:67], s12 offen
  s_addk_i32 s12, 0x1000
  buffer_load_dwordx4 v[40:43], v4, s[64:67], s12 offen
  s_addk_i32 s12, 0x1000
  buffer_load_dwordx4 v[44:47], v4, s[64:67], s12 offen
  s_addk_i32 s12, 0x1000
  buffer_load_dwordx4 v[48:51], v4, s[64:67], s12 offen
  s_addk_i32 s12, 0x1000
  buffer_load_dwordx4 v[52:55], v4, s[64:67], s12 offen
  s_addk_i32 s12, 0x1000
  buffer_load_dwordx4 v[56:59], v4, s[64:67], s12 offen
  s_addk_i32 s12, 0x1000
  buffer_load_dwordx4 v[60:63], v4, s[64:67], s12 offen
  s_addk_i32 s12, 0x1000
  global_load_dwordx4 v[32:35], v2, s[26:27] offset:0
  global_load_dwordx4 v[32:35], v2, s[28:29] offset:0
  global_load_dwordx4 v[36:39], v2, s[26:27] offset:1024
  global_load_dwordx4 v[36:39], v2, s[28:29] offset:1024
  global_load_dwordx4 v[40:43], v2, s[26:27] offset:2048
  global_load_dwordx4 v[40:43], v2, s[28:29] offset:2048
  global_load_dwordx4 v[44:47], v2, s[26:27] offset:3072
  global_load_dwordx4 v[44:47], v2, s[28:29] offset:3072
  global_load_dwordx4 v[48:51], v3, s[26:27] offset:0
  global_load_dwordx4 v[48:51], v3, s[28:29] offset:0
  global_load_dwordx4 v[52:55], v3, s[26:27] offset:1024
  global_load_dwordx4 v[52:55], v3, s[28:29] offset:1024
  global_load_dwordx4 v[56:59], v3, s[26:27] offset:2048
  global_load_dwordx4 v[56:59], v3, s[28:29] offset:2048
  global_load_dwordx4 v[60:63], v3, s[26:27] offset:3072
  global_load_dwordx4 v[60:63], v3, s[28:29] offset:3072
  s_mul_i32 s12, s11, 11264
  v_lshlrev_b32 v2, 4, v1
  buffer_load_dwordx4 v[32:35], v2, s[72:75], s12 offen
  s_addk_i32 s12, 0x400
  buffer_load_dwordx4 v[36:39], v2, s[72:75], s12 offen
  s_addk_i32 s12, 0x400
  buffer_load_dwordx4 v[40:43], v2, s[72:75], s12 offen
  s_addk_i32 s12, 0x400
  buffer_load_dwordx4 v[44:47], v2, s[72:75], s12 offen
  s_addk_i32 s12, 0x400
  buffer_load_dwordx4 v[48:51], v2, s[72:75], s12 offen
  s_addk_i32 s12, 0x400
  buffer_load_dwordx4 v[52:55], v2, s[72:75], s12 offen
  s_addk_i32 s12, 0x400
  buffer_load_dwordx4 v[56:59], v2, s[72:75], s12 offen
  s_addk_i32 s12, 0x400
  buffer_load_dwordx4 v[60:63], v2, s[72:75], s12 offen
  s_addk_i32 s12, 0x400
  buffer_load_dwordx4 v[32:35], v2, s[72:75], s12 offen
  s_addk_i32 s12, 0x400
  buffer_load_dwordx4 v[36:39], v2, s[72:75], s12 offen
  s_addk_i32 s12, 0x400
  buffer_load_dwordx4 v[40:43], v2, s[72:75], s12 offen
  s_addk_i32 s12, 0x400
  s_barrier
  s_add_u32 s14, s31, 0
  s_sub_u32 s15, s14, 11
  s_cselect_b32 s14, s14, s15
  s_add_u32 m0, s30, 0
  s_lshl_b32 s14, s14, 16
  buffer_load_dwordx4 v19, s[72:75], s14 offen lds
  buffer_load_dwordx4 v20, s[72:75], s14 offen offset:1024 lds
  s_add_u32 s14, s31, 1
  s_sub_u32 s15, s14, 11
  s_cselect_b32 s14, s14, s15
  s_add_u32 m0, s30, 8192
  s_lshl_b32 s14, s14, 16
  buffer_load_dwordx4 v19, s[72:75], s14 offen lds
  buffer_load_dwordx4 v20, s[72:75], s14 offen offset:1024 lds
  s_add_u32 s14, s31, 2
  s_sub_u32 s15, s14, 11
  s_cselect_b32 s14, s14, s15
  s_add_u32 m0, s30, 16384
  s_lshl_b32 s14, s14, 16
  buffer_load_dwordx4 v19, s[72:75], s14 offen lds
  buffer_load_dwordx4 v20, s[72:75], s14 offen offset:1024 lds
  s_add_u32 s14, s31, 3
  s_sub_u32 s15, s14, 11
  s_cselect_b32 s14, s14, s15
  s_add_u32 m0, s30, 24576
  s_lshl_b32 s14, s14, 16
  buffer_load_dwordx4 v19, s[72:75], s14 offen lds
  buffer_load_dwordx4 v20, s[72:75], s14 offen offset:1024 lds
  s_add_u32 s14, s31, 4
  s_sub_u32 s15, s14, 11
  s_cselect_b32 s14, s14, s15
  s_add_u32 m0, s30, 32768
  s_lshl_b32 s14, s14, 16
  buffer_load_dwordx4 v19, s[72:75], s14 offen lds
  buffer_load_dwordx4 v20, s[72:75], s14 offen offset:1024 lds
  s_add_u32 s14, s31, 5
  s_sub_u32 s15, s14, 11
  s_cselect_b32 s14, s14, s15
  s_add_u32 m0, s30, 40960
  s_lshl_b32 s14, s14, 16
  buffer_load_dwordx4 v19, s[72:75], s14 offen lds
  buffer_load_dwordx4 v20, s[72:75], s14 offen offset:1024 lds
  s_add_u32 s14, s31, 6
  s_sub_u32 s15, s14, 11
  s_cselect_b32 s14, s14, s15
  s_add_u32 m0, s30, 49152
  s_lshl_b32 s14, s14, 16
  buffer_load_dwordx4 v19, s[72:75], s14 offen lds
  buffer_load_dwordx4 v20, s[72:75], s14 offen offset:1024 lds
  s_add_u32 s14, s31, 7
  s_sub_u32 s15, s14, 11
  s_cselect_b32 s14, s14, s15
  s_add_u32 m0, s30, 57344
  s_lshl_b32 s14, s14, 16
  buffer_load_dwordx4 v19, s[72:75], s14 offen lds
  buffer_load_dwordx4 v20, s[72:75], s14 offen offset:1024 lds
  s_add_u32 s14, s31, 8
  s_sub_u32 s15, s14, 11
  s_cselect_b32 s14, s14, s15
  s_add_u32 m0, s30, 65536
  s_lshl_b32 s14, s14, 16
  buffer_load_dwordx4 v19, s[72:75], s14 offen lds
  buffer_load_dwordx4 v20, s[72:75], s14 offen offset:1024 lds
  s_waitcnt vmcnt(0)
  s_load_dwordx2 s[76:77], s[48:49], 0
L_p3load:
  s_lshl1_add_u32 s11, s4, s10
  s_lshr_b32 s12, s3, 1
  s_lshl1_add_u32 s11, s11, s12
  s_mul_i32 s11, s11, 45056
  s_add_u32 s11, s11, 0xa00000
  s_and_b32 s12, s3, 1
  s_lshl_b32 s12, s12, 11
  s_add_u32 s11, s11, s12
  v_lshl_add_u32 v18, v1, 4, s11
  s_lshl_b32 s23, s31, 12
  s_mov_b32 s24, 45056
  s_mov_b32 s85, 0x40000
  s_waitcnt lgkmcnt(0)
nl_19:
  s_cmp_lg_u32 s77, 0
  s_cbranch_scc1 nok_20
  s_sleep 32
  s_load_dwordx2 s[76:77], s[48:49], 0 glc
  s_waitcnt lgkmcnt(0)
  s_sub_u32 s85, s85, 1
  s_cbranch_scc0 nl_19
nok_20:
  s_lshl_b32 s11, s4, 13
  s_add_u32 s11, s11, 0x11c0000
  v_lshl_add_u32 v2, v1, 7, s11
  s_lshl_b32 s21, s10, 1
  s_lshl_b32 s20, 0x33333333, s21
  s_and_b32 s21, s20, 0xfff
  v_mov_b32 v3, 163832
  s_add_u32 s28, s76, 1
  s_mov_b32 s29, s77
  s_cmp_lg_u32 s3, 0
  s_cbranch_scc1 rw_21
  s_mov_b32 s85, 0x40000
  s_mov_b64 exec, s[20:21]
fpoll_24:
  buffer_load_dwordx2 v[28:29], v2, s[60:63], 0 offen sc1
fchk_26:
  s_waitcnt vmcnt(0)
  v_cmp_ne_u64 vcc, s[76:77], v[28:29]
  s_and_b64 exec, exec, vcc
  s_cbranch_execz fdone_25
  s_sub_u32 s85, s85, 1
  s_cbranch_scc1 fdone_25
  s_sleep 2
  s_branch fpoll_24
fdone_25:
  s_mov_b64 exec, -1
  v_mov_b32 v28, s28
  v_mov_b32 v29, s29
  ds_write_b64 v3, v[28:29]
  s_branch rd_22
rw_21:
  s_mov_b32 s85, 0x200000
rl_23:
  s_sleep 1
  ds_read_b64 v[28:29], v3
  s_waitcnt lgkmcnt(0)
  v_cmp_eq_u64 vcc, s[28:29], v[28:29]
  s_cbranch_vccnz rd_22
  s_sub_u32 s85, s85, 1
  s_cbranch_scc0 rl_23
rd_22:
  s_add_u32 m0, s30, 73728
  s_cmp_eq_u32 s23, s24
  s_cselect_b32 s23, 0, s23
  buffer_load_dwordx4 v18, s[60:63], s23 offen offset:0 sc1 lds
  buffer_load_dwordx4 v18, s[60:63], s23 offen offset:1024 sc1 lds
  s_addk_i32 s23, 0x1000
  s_add_u32 m0, s30, 81920
  s_cmp_eq_u32 s23, s24
  s_cselect_b32 s23, 0, s23
  buffer_load_dwordx4 v18, s[60:63], s23 offen offset:0 sc1 lds
  buffer_load_dwordx4 v18, s[60:63], s23 offen offset:1024 sc1 lds
  s_addk_i32 s23, 0x1000
  s_add_u32 m0, s30, 90112
  s_cmp_eq_u32 s23, s24
  s_cselect_b32 s23, 0, s23
  buffer_load_dwordx4 v18, s[60:63], s23 offen offset:0 sc1 lds
  buffer_load_dwordx4 v18, s[60:63], s23 offen offset:1024 sc1 lds
  s_addk_i32 s23, 0x1000
  s_add_u32 m0, s30, 98304
  s_cmp_eq_u32 s23, s24
  s_cselect_b32 s23, 0, s23
  buffer_load_dwordx4 v18, s[60:63], s23 offen offset:0 sc1 lds
  buffer_load_dwordx4 v18, s[60:63], s23 offen offset:1024 sc1 lds
  s_addk_i32 s23, 0x1000
  s_add_u32 m0, s30, 106496
  s_cmp_eq_u32 s23, s24
  s_cselect_b32 s23, 0, s23
  buffer_load_dwordx4 v18, s[60:63], s23 offen offset:0 sc1 lds
  buffer_load_dwordx4 v18, s[60:63], s23 offen offset:1024 sc1 lds
  s_addk_i32 s23, 0x1000
  s_waitcnt vmcnt(8)
  s_barrier
  s_add_u32 m0, s30, 114688
  s_cmp_eq_u32 s23, s24
  s_cselect_b32 s23, 0, s23
  buffer_load_dwordx4 v18, s[60:63], s23 offen offset:0 sc1 lds
  buffer_load_dwordx4 v18, s[60:63], s23 offen offset:1024 sc1 lds
  s_addk_i32 s23, 0x1000
  s_add_u32 m0, s30, 122880
  s_cmp_eq_u32 s23, s24
  s_cselect_b32 s23, 0, s23
  buffer_load_dwordx4 v18, s[60:63], s23 offen offset:0 sc1 lds
  buffer_load_dwordx4 v18, s[60:63], s23 offen offset:1024 sc1 lds
  s_addk_i32 s23, 0x1000
  s_waitcnt vmcnt(10)
  s_barrier
  s_add_u32 s14, s31, 9
  s_sub_u32 s15, s14, 11
  s_cselect_b32 s14, s14, s15
  s_add_u32 m0, s30, 0
  s_lshl_b32 s14, s14, 16
  buffer_load_dwordx4 v19, s[72:75], s14 offen lds
  buffer_load_dwordx4 v20, s[72:75], s14 offen offset:1024 lds
  s_add_u32 m0, s30, 131072
  s_cmp_eq_u32 s23, s24
  s_cselect_b32 s23, 0, s23
  buffer_load_dwordx4 v18, s[60:63], s23 offen offset:0 sc1 lds
  buffer_load_dwordx4 v18, s[60:63], s23 offen offset:1024 sc1 lds
  s_addk_i32 s23, 0x1000
  s_add_u32 m0, s30, 139264
  s_cmp_eq_u32 s23, s24
  s_cselect_b32 s23, 0, s23
  buffer_load_dwordx4 v18, s[60:63], s23 offen offset:0 sc1 lds
  buffer_load_dwordx4 v18, s[60:63], s23 offen offset:1024 sc1 lds
  s_addk_i32 s23, 0x1000
  s_waitcnt vmcnt(14)
  s_barrier
  s_add_u32 s14, s31, 10
  s_sub_u32 s15, s14, 11
  s_cselect_b32 s14, s14, s15
  s_add_u32 m0, s30, 8192
  s_lshl_b32 s14, s14, 16
  buffer_load_dwordx4 v19, s[72:75], s14 offen lds
  buffer_load_dwordx4 v20, s[72:75], s14 offen offset:1024 lds
  s_add_u32 m0, s30, 147456
  s_cmp_eq_u32 s23, s24
  s_cselect_b32 s23, 0, s23
  buffer_load_dwordx4 v18, s[60:63], s23 offen offset:0 sc1 lds
  buffer_load_dwordx4 v18, s[60:63], s23 offen offset:1024 sc1 lds
  s_addk_i32 s23, 0x1000
  s_waitcnt vmcnt(16)
  s_barrier
  s_add_u32 m0, s30, 155648
  s_cmp_eq_u32 s23, s24
  s_cselect_b32 s23, 0, s23
  buffer_load_dwordx4 v18, s[60:63], s23 offen offset:0 sc1 lds
  buffer_load_dwordx4 v18, s[60:63], s23 offen offset:1024 sc1 lds
  s_addk_i32 s23, 0x1000
  s_waitcnt vmcnt(16)
  s_barrier
  s_waitcnt vmcnt(14)
  s_barrier
  s_waitcnt vmcnt(12)
  s_barrier
  s_waitcnt vmcnt(8)
  s_barrier
  s_waitcnt vmcnt(6)
  s_barrier
  s_waitcnt vmcnt(2)
  s_barrier
  s_waitcnt vmcnt(0)
  s_barrier
  s_endpgm
L_cons:
  v_and_b32 v12, 31, v1
  v_lshrrev_b32 v13, 5, v1
  v_bfe_u32 v2, v1, 1, 3
  v_xor_b32 v2, v2, v13
  v_lshlrev_b32 v2, 4, v2
  v_lshl_add_u32 v14, v12, 7, v2
  s_getpc_b64 s[12:13]
L_pc:
  s_lshr_b32 s11, s2, 3
  s_lshl2_add_u32 s11, s11, s3
  s_lshl_b32 s11, s11, 9
  s_sub_u32 s12, s12, L_pc-gated_mix__ssm_conv_s5__mixer_gmlp__prompt_kernel
  s_subb_u32 s13, s13, 0
  v_lshl_add_u32 v8, v1, 3, s11
  v_min_u32 v8, L_end-gated_mix__ssm_conv_s5__mixer_gmlp__prompt_kernel-8, v8
  global_load_dwordx2 v[254:255], v8, s[12:13]
  v_mov_b32 v9, 0
  s_waitcnt lgkmcnt(0)
  s_and_b32 s34, s3, 1
  s_lshr_b32 s35, s3, 1
  s_or_b32 s11, s2, s3
  s_cmp_lg_u32 s11, 0
  s_cbranch_scc1 nopub_27
  s_or_b32 s77, s77, 0x80000000
  v_mov_b32 v10, s76
  v_mov_b32 v11, s77
  global_store_dwordx2 v9, v[10:11], s[48:49] sc1
nopub_27:
  s_mov_b32 s60, s50
  s_and_b32 s61, s51, 0xffff
  s_mov_b32 s62, 0x1280000
  s_mov_b32 s63, 0x20000
  s_mov_b32 s52, s16
  s_and_b32 s53, s17, 0xffff
  s_mov_b32 s54, 0x200000
  s_mov_b32 s55, 0x20000
  s_mov_b32 s72, s46
  s_and_b32 s73, s47, 0xffff
  s_mov_b32 s74, 0x400000
  s_mov_b32 s75, 0x20000
  s_lshl1_add_u32 s11, s4, s10
  s_lshl1_add_u32 s11, s11, s35
  s_lshl_b32 s11, s11, 16
  s_lshl1_add_u32 s12, s9, s34
  s_lshl_b32 s12, s12, 7
  s_add_u32 s43, s11, s12
  v_lshl_add_u32 v15, v13, 4, s43
  v_lshl_add_u32 v15, v12, 11, v15
  s_lshl4_add_u32 s11, s4, s8
  s_lshl2_add_u32 s11, s11, s3
  s_lshl_b32 s11, s11, 7
  s_add_u32 s83, s11, 0x11c0000
  v_mov_b32 v2, 0x27ff0
  v_mov_b64 v[4:5], 0
  v_mov_b64 v[6:7], 0
  ds_write_b128 v2, v[4:7]
  s_cmp_eq_u32 s8, 15
  s_cbranch_scc1 L_gate
  s_cmp_lt_u32 s8, 11
  s_cbranch_scc1 L_zcons
  s_sub_u32 s5, s8, 11
  v_and_b32 v3, 15, v1
  v_lshrrev_b32 v17, 4, v1
  s_lshl3_add_u32 s12, s5, s3
  s_lshl_b32 s12, s12, 4
  v_add_u32 v16, s12, v3
  v_lshlrev_b32 v2, 1, v16
  global_load_ushort v18, v2, s[18:19] offset:0
  global_load_ushort v19, v2, s[20:21] offset:0
  global_load_ushort v20, v2, s[30:31] offset:0
  global_load_ushort v28, v2, s[18:19] offset:128
  global_load_ushort v29, v2, s[20:21] offset:128
  global_load_ushort v30, v2, s[30:31] offset:128
  v_xor_b32 v2, 0, v14
  v_add_u32 v38, 0, v2
  v_add_u32 v39, 0x10000, v38
  v_add_u32 v40, 0x20000, v38
  v_xor_b32 v2, 32, v14
  v_add_u32 v41, 0, v2
  v_add_u32 v42, 0x10000, v41
  v_add_u32 v43, 0x20000, v41
  v_xor_b32 v2, 64, v14
  v_add_u32 v44, 0, v2
  v_add_u32 v45, 0x10000, v44
  v_add_u32 v46, 0x20000, v44
  v_xor_b32 v2, 96, v14
  v_add_u32 v47, 0, v2
  v_add_u32 v48, 0x10000, v47
  v_add_u32 v49, 0x20000, v47
  v_bfe_u32 v3, v1, 4, 1
  v_mul_u32_u24 v3, 14336, v3
  s_lshl_b32 s11, s3, 11
  v_add_u32 v3, s11, v3
  v_add_u32 v50, v38, v3
  v_add_u32 v51, 0x10000, v50
  v_add_u32 v52, 0x20000, v50
  v_add_u32 v53, v41, v3
  v_add_u32 v54, 0x10000, v53
  v_add_u32 v55, 0x20000, v53
  v_add_u32 v56, v44, v3
  v_add_u32 v57, 0x10000, v56
  v_add_u32 v58, 0x20000, v56
  v_add_u32 v59, v47, v3
  v_add_u32 v60, 0x10000, v59
  v_add_u32 v61, 0x20000, v59
  s_waitcnt vmcnt(0)
  v_lshlrev_b32 v18, 16, v18
  v_lshlrev_b32 v19, 16, v19
  v_lshlrev_b32 v2, 16, v20
  v_mul_f32 v2, 0x3fb8aa3b, v2
  v_exp_f32 v2, v2
  s_nop 0
  v_cvt_pk_bf16_f32 v2, v2, v2
  v_lshlrev_b32 v2, 16, v2
  v_mul_f32 v20, v2, v18
  v_mul_f32 v21, v2, v19
  v_mul_f32 v20, 0x3fb8aa3b, v20
  v_mul_f32 v21, 0x3e22f983, v21
  v_mov_b32 v3, 0x3f800000
  v_mul_f32 v4, v3, v20
  v_mul_f32 v23, v3, v21
  v_exp_f32 v4, v4
  v_fract_f32 v23, v23
  v_cos_f32 v22, v23
  v_sin_f32 v23, v23
  v_mul_f32 v22, v22, v4
  v_mul_f32 v23, v23, v4
  v_mov_b32 v3, 0x41800000
  v_mul_f32 v4, v3, v20
  v_mul_f32 v25, v3, v21
  v_exp_f32 v4, v4
  v_fract_f32 v25, v25
  v_cos_f32 v24, v25
  v_sin_f32 v25, v25
  v_mul_f32 v24, v24, v4
  v_mul_f32 v25, v25, v4
  v_mov_b32 v3, 0x42000000
  v_mul_f32 v4, v3, v20
  v_mul_f32 v27, v3, v21
  v_exp_f32 v4, v4
  v_fract_f32 v27, v27
  v_cos_f32 v26, v27
  v_sin_f32 v27, v27
  v_mul_f32 v26, v26, v4
  v_mul_f32 v27, v27, v4
  v_lshlrev_b32 v28, 16, v28
  v_lshlrev_b32 v29, 16, v29
  v_lshlrev_b32 v2, 16, v30
  v_mul_f32 v2, 0x3fb8aa3b, v2
  v_exp_f32 v2, v2
  s_nop 0
  v_cvt_pk_bf16_f32 v2, v2, v2
  v_lshlrev_b32 v2, 16, v2
  v_mul_f32 v30, v2, v28
  v_mul_f32 v31, v2, v29
  v_mul_f32 v30, 0x3fb8aa3b, v30
  v_mul_f32 v31, 0x3e22f983, v31
  v_mov_b32 v3, 0x3f800000
  v_mul_f32 v4, v3, v30
  v_mul_f32 v33, v3, v31
  v_exp_f32 v4, v4
  v_fract_f32 v33, v33
  v_cos_f32 v32, v33
  v_sin_f32 v33, v33
  v_mul_f32 v32, v32, v4
  v_mul_f32 v33, v33, v4
  v_mov_b32 v3, 0x41800000
  v_mul_f32 v4, v3, v30
  v_mul_f32 v35, v3, v31
  v_exp_f32 v4, v4
  v_fract_f32 v35, v35
  v_cos_f32 v34, v35
  v_sin_f32 v35, v35
  v_mul_f32 v34, v34, v4
  v_mul_f32 v35, v35, v4
  v_mov_b32 v3, 0x42000000
  v_mul_f32 v4, v3, v30
  v_mul_f32 v37, v3, v31
  v_exp_f32 v4, v4
  v_fract_f32 v37, v37
  v_cos_f32 v36, v37
  v_sin_f32 v37, v37
  v_mul_f32 v36, v36, v4
  v_mul_f32 v37, v37, v4
  v_add_u32 v5, 0, v17
  v_cmp_le_u32 s[16:17], s4, v5
  v_add_u32 v5, 4, v17
  v_cmp_le_u32 s[18:19], s4, v5
  v_add_u32 v5, 8, v17
  v_cmp_le_u32 s[20:21], s4, v5
  v_add_u32 v5, 12, v17
  v_cmp_le_u32 s[22:23], s4, v5
  v_cmp_eq_u32 s[24:25], 1, v17
  v_cmp_eq_u32 s[26:27], 2, v17
  v_cmp_eq_u32 s[28:29], 3, v17
  s_barrier
  ds_read_b128 v[96:99], v50 offset:16384
  ds_read_b128 v[64:67], v38 offset:0
  ds_read_b128 v[100:103], v50 offset:24576
  ds_read_b128 v[68:71], v38 offset:4096
  ds_read_b128 v[72:75], v38 offset:8192
  ds_read_b128 v[76:79], v38 offset:12288
  s_waitcnt lgkmcnt(0)
  v_mfma_f32_32x32x16_bf16 v[112:127], v[64:67], v[96:99], 0
  ds_read_b128 v[104:107], v53 offset:16384
  ds_read_b128 v[80:83], v41 offset:0
  v_mfma_f32_32x32x16_bf16 v[176:191], v[64:67], v[100:103], 0
  ds_read_b128 v[108:111], v53 offset:24576
  ds_read_b128 v[84:87], v41 offset:4096
  v_mfma_f32_32x32x16_bf16 v[128:143], v[68:71], v[96:99], 0
  ds_read_b128 v[88:91], v41 offset:8192
  ds_read_b128 v[92:95], v41 offset:12288
  v_mfma_f32_32x32x16_bf16 v[192:207], v[68:71], v[100:103], 0
  v_mfma_f32_32x32x16_bf16 v[144:159], v[72:75], v[96:99], 0
  v_mfma_f32_32x32x16_bf16 v[208:223], v[72:75], v[100:103], 0
  v_mfma_f32_32x32x16_bf16 v[160:175], v[76:79], v[96:99], 0
  v_mfma_f32_32x32x16_bf16 v[224:239], v[76:79], v[100:103], 0
  s_waitcnt lgkmcnt(0)
  v_mfma_f32_32x32x16_bf16 v[112:127], v[80:83], v[104:107], v[112:127]
  ds_read_b128 v[96:99], v56 offset:16384
  ds_read_b128 v[64:67], v44 offset:0
  v_mfma_f32_32x32x16_bf16 v[176:191], v[80:83], v[108:111], v[176:191]
  ds_read_b128 v[100:103], v56 offset:24576
  ds_read_b128 v[68:71], v44 offset:4096
  v_mfma_f32_32x32x16_bf16 v[128:143], v[84:87], v[104:107], v[128:143]
  ds_read_b128 v[72:75], v44 offset:8192
  ds_read_b128 v[76:79], v44 offset:12288
  v_mfma_f32_32x32x16_bf16 v[192:207], v[84:87], v[108:111], v[192:207]
  v_mfma_f32_32x32x16_bf16 v[144:159], v[88:91], v[104:107], v[144:159]
  v_mfma_f32_32x32x16_bf16 v[208:223], v[88:91], v[108:111], v[208:223]
  v_mfma_f32_32x32x16_bf16 v[160:175], v[92:95], v[104:107], v[160:175]
  v_mfma_f32_32x32x16_bf16 v[224:239], v[92:95], v[108:111], v[224:239]
  s_waitcnt lgkmcnt(0)
  v_mfma_f32_32x32x16_bf16 v[112:127], v[64:67], v[96:99], v[112:127]
  ds_read_b128 v[104:107], v59 offset:16384
  ds_read_b128 v[80:83], v47 offset:0
  v_mfma_f32_32x32x16_bf16 v[176:191], v[64:67], v[100:103], v[176:191]
  ds_read_b128 v[108:111], v59 offset:24576
  ds_read_b128 v[84:87], v47 offset:4096
  v_mfma_f32_32x32x16_bf16 v[128:143], v[68:71], v[96:99], v[128:143]
  ds_read_b128 v[88:91], v47 offset:8192
  ds_read_b128 v[92:95], v47 offset:12288
  v_mfma_f32_32x32x16_bf16 v[192:207], v[68:71], v[100:103], v[192:207]
  v_mfma_f32_32x32x16_bf16 v[144:159], v[72:75], v[96:99], v[144:159]
  v_mfma_f32_32x32x16_bf16 v[208:223], v[72:75], v[100:103], v[208:223]
  v_mfma_f32_32x32x16_bf16 v[160:175], v[76:79], v[96:99], v[160:175]
  v_mfma_f32_32x32x16_bf16 v[224:239], v[76:79], v[100:103], v[224:239]
  s_waitcnt lgkmcnt(0)
  s_barrier
  v_mfma_f32_32x32x16_bf16 v[112:127], v[80:83], v[104:107], v[112:127]
  ds_read_b128 v[96:99], v51 offset:0
  ds_read_b128 v[64:67], v38 offset:49152
  v_mfma_f32_32x32x16_bf16 v[176:191], v[80:83], v[108:111], v[176:191]
  ds_read_b128 v[100:103], v51 offset:8192
  ds_read_b128 v[68:71], v38 offset:53248
  v_mfma_f32_32x32x16_bf16 v[128:143], v[84:87], v[104:107], v[128:143]
  ds_read_b128 v[72:75], v38 offset:57344
  ds_read_b128 v[76:79], v38 offset:61440
  v_mfma_f32_32x32x16_bf16 v[192:207], v[84:87], v[108:111], v[192:207]
  v_mfma_f32_32x32x16_bf16 v[144:159], v[88:91], v[104:107], v[144:159]
  v_mfma_f32_32x32x16_bf16 v[208:223], v[88:91], v[108:111], v[208:223]
  v_mfma_f32_32x32x16_bf16 v[160:175], v[92:95], v[104:107], v[160:175]
  v_mfma_f32_32x32x16_bf16 v[224:239], v[92:95], v[108:111], v[224:239]
  s_waitcnt lgkmcnt(0)
  v_mfma_f32_32x32x16_bf16 v[112:127], v[64:67], v[96:99], v[112:127]
  ds_read_b128 v[104:107], v54 offset:0
  ds_read_b128 v[80:83], v41 offset:49152
  v_mfma_f32_32x32x16_bf16 v[176:191], v[64:67], v[100:103], v[176:191]
  ds_read_b128 v[108:111], v54 offset:8192
  ds_read_b128 v[84:87], v41 offset:53248
  v_mfma_f32_32x32x16_bf16 v[128:143], v[68:71], v[96:99], v[128:143]
  ds_read_b128 v[88:91], v41 offset:57344
  ds_read_b128 v[92:95], v41 offset:61440
  v_mfma_f32_32x32x16_bf16 v[192:207], v[68:71], v[100:103], v[192:207]
  v_mfma_f32_32x32x16_bf16 v[144:159], v[72:75], v[96:99], v[144:159]
  v_mfma_f32_32x32x16_bf16 v[208:223], v[72:75], v[100:103], v[208:223]
  v_mfma_f32_32x32x16_bf16 v[160:175], v[76:79], v[96:99], v[160:175]
  v_mfma_f32_32x32x16_bf16 v[224:239], v[76:79], v[100:103], v[224:239]
  s_waitcnt lgkmcnt(0)
  v_mfma_f32_32x32x16_bf16 v[112:127], v[80:83], v[104:107], v[112:127]
  ds_read_b128 v[96:99], v57 offset:0
  ds_read_b128 v[64:67], v44 offset:49152
  v_mfma_f32_32x32x16_bf16 v[176:191], v[80:83], v[108:111], v[176:191]
  ds_read_b128 v[100:103], v57 offset:8192
  ds_read_b128 v[68:71], v44 offset:53248
  v_mfma_f32_32x32x16_bf16 v[128:143], v[84:87], v[104:107], v[128:143]
  ds_read_b128 v[72:75], v44 offset:57344
  ds_read_b128 v[76:79], v44 offset:61440
  v_mfma_f32_32x32x16_bf16 v[192:207], v[84:87], v[108:111], v[192:207]
  v_mfma_f32_32x32x16_bf16 v[144:159], v[88:91], v[104:107], v[144:159]
  v_mfma_f32_32x32x16_bf16 v[208:223], v[88:91], v[108:111], v[208:223]
  v_mfma_f32_32x32x16_bf16 v[160:175], v[92:95], v[104:107], v[160:175]
  v_mfma_f32_32x32x16_bf16 v[224:239], v[92:95], v[108:111], v[224:239]
  s_waitcnt lgkmcnt(0)
  v_mfma_f32_32x32x16_bf16 v[112:127], v[64:67], v[96:99], v[112:127]
  ds_read_b128 v[104:107], v60 offset:0
  ds_read_b128 v[80:83], v47 offset:49152
  v_mfma_f32_32x32x16_bf16 v[176:191], v[64:67], v[100:103], v[176:191]
  ds_read_b128 v[108:111], v60 offset:8192
  ds_read_b128 v[84:87], v47 offset:53248
  v_mfma_f32_32x32x16_bf16 v[128:143], v[68:71], v[96:99], v[128:143]
  ds_read_b128 v[88:91], v47 offset:57344
  ds_read_b128 v[92:95], v47 offset:61440
  v_mfma_f32_32x32x16_bf16 v[192:207], v[68:71], v[100:103], v[192:207]
  v_mfma_f32_32x32x16_bf16 v[144:159], v[72:75], v[96:99], v[144:159]
  v_mfma_f32_32x32x16_bf16 v[208:223], v[72:75], v[100:103], v[208:223]
  v_mfma_f32_32x32x16_bf16 v[160:175], v[76:79], v[96:99], v[160:175]
  v_mfma_f32_32x32x16_bf16 v[224:239], v[76:79], v[100:103], v[224:239]
  s_waitcnt lgkmcnt(0)
  s_barrier
  v_mfma_f32_32x32x16_bf16 v[112:127], v[80:83], v[104:107], v[112:127]
  ds_read_b128 v[96:99], v51 offset:49152
  ds_read_b128 v[64:67], v39 offset:32768
  v_mfma_f32_32x32x16_bf16 v[176:191], v[80:83], v[108:111], v[176:191]
  ds_read_b128 v[100:103], v51 offset:57344
  ds_read_b128 v[68:71], v39 offset:36864
  v_mfma_f32_32x32x16_bf16 v[128:143], v[84:87], v[104:107], v[128:143]
  ds_read_b128 v[72:75], v39 offset:40960
  ds_read_b128 v[76:79], v39 offset:45056
  v_mfma_f32_32x32x16_bf16 v[192:207], v[84:87], v[108:111], v[192:207]
  v_mfma_f32_32x32x16_bf16 v[144:159], v[88:91], v[104:107], v[144:159]
  v_mfma_f32_32x32x16_bf16 v[208:223], v[88:91], v[108:111], v[208:223]
  v_mfma_f32_32x32x16_bf16 v[160:175], v[92:95], v[104:107], v[160:175]
  v_mfma_f32_32x32x16_bf16 v[224:239], v[92:95], v[108:111], v[224:239]
  s_waitcnt lgkmcnt(0)
  v_mfma_f32_32x32x16_bf16 v[112:127], v[64:67], v[96:99], v[112:127]
  ds_read_b128 v[104:107], v54 offset:49152
  ds_read_b128 v[80:83], v42 offset:32768
  v_mfma_f32_32x32x16_bf16 v[176:191], v[64:67], v[100:103], v[176:191]
  ds_read_b128 v[108:111], v54 offset:57344
  ds_read_b128 v[84:87], v42 offset:36864
  v_mfma_f32_32x32x16_bf16 v[128:143], v[68:71], v[96:99], v[128:143]
  ds_read_b128 v[88:91], v42 offset:40960
  ds_read_b128 v[92:95], v42 offset:45056
  v_mfma_f32_32x32x16_bf16 v[192:207], v[68:71], v[100:103], v[192:207]
  v_mfma_f32_32x32x16_bf16 v[144:159], v[72:75], v[96:99], v[144:159]
  v_mfma_f32_32x32x16_bf16 v[208:223], v[72:75], v[100:103], v[208:223]
  v_mfma_f32_32x32x16_bf16 v[160:175], v[76:79], v[96:99], v[160:175]
  v_mfma_f32_32x32x16_bf16 v[224:239], v[76:79], v[100:103], v[224:239]
  s_waitcnt lgkmcnt(0)
  v_mfma_f32_32x32x16_bf16 v[112:127], v[80:83], v[104:107], v[112:127]
  ds_read_b128 v[96:99], v57 offset:49152
  ds_read_b128 v[64:67], v45 offset:32768
  v_mfma_f32_32x32x16_bf16 v[176:191], v[80:83], v[108:111], v[176:191]
  ds_read_b128 v[100:103], v57 offset:57344
  ds_read_b128 v[68:71], v45 offset:36864
  v_mfma_f32_32x32x16_bf16 v[128:143], v[84:87], v[104:107], v[128:143]
  ds_read_b128 v[72:75], v45 offset:40960
  ds_read_b128 v[76:79], v45 offset:45056
  v_mfma_f32_32x32x16_bf16 v[192:207], v[84:87], v[108:111], v[192:207]
  v_mfma_f32_32x32x16_bf16 v[144:159], v[88:91], v[104:107], v[144:159]
  v_mfma_f32_32x32x16_bf16 v[208:223], v[88:91], v[108:111], v[208:223]
  v_mfma_f32_32x32x16_bf16 v[160:175], v[92:95], v[104:107], v[160:175]
  v_mfma_f32_32x32x16_bf16 v[224:239], v[92:95], v[108:111], v[224:239]
  s_waitcnt lgkmcnt(0)
  v_mfma_f32_32x32x16_bf16 v[112:127], v[64:67], v[96:99], v[112:127]
  ds_read_b128 v[104:107], v60 offset:49152
  ds_read_b128 v[80:83], v48 offset:32768
  v_mfma_f32_32x32x16_bf16 v[176:191], v[64:67], v[100:103], v[176:191]
  ds_read_b128 v[108:111], v60 offset:57344
  ds_read_b128 v[84:87], v48 offset:36864
  v_mfma_f32_32x32x16_bf16 v[128:143], v[68:71], v[96:99], v[128:143]
  ds_read_b128 v[88:91], v48 offset:40960
  ds_read_b128 v[92:95], v48 offset:45056
  v_mfma_f32_32x32x16_bf16 v[192:207], v[68:71], v[100:103], v[192:207]
  v_mfma_f32_32x32x16_bf16 v[144:159], v[72:75], v[96:99], v[144:159]
  v_mfma_f32_32x32x16_bf16 v[208:223], v[72:75], v[100:103], v[208:223]
  v_mfma_f32_32x32x16_bf16 v[160:175], v[76:79], v[96:99], v[160:175]
  v_mfma_f32_32x32x16_bf16 v[224:239], v[76:79], v[100:103], v[224:239]
  s_waitcnt lgkmcnt(0)
  s_barrier
  v_mfma_f32_32x32x16_bf16 v[112:127], v[80:83], v[104:107], v[112:127]
  ds_read_b128 v[96:99], v50 offset:16384
  ds_read_b128 v[64:67], v38 offset:0
  v_mfma_f32_32x32x16_bf16 v[176:191], v[80:83], v[108:111], v[176:191]
  ds_read_b128 v[100:103], v50 offset:24576
  ds_read_b128 v[68:71], v38 offset:4096
  v_mfma_f32_32x32x16_bf16 v[128:143], v[84:87], v[104:107], v[128:143]
  ds_read_b128 v[72:75], v38 offset:8192
  ds_read_b128 v[76:79], v38 offset:12288
  v_mfma_f32_32x32x16_bf16 v[192:207], v[84:87], v[108:111], v[192:207]
  v_mfma_f32_32x32x16_bf16 v[144:159], v[88:91], v[104:107], v[144:159]
  v_mfma_f32_32x32x16_bf16 v[208:223], v[88:91], v[108:111], v[208:223]
  v_mfma_f32_32x32x16_bf16 v[160:175], v[92:95], v[104:107], v[160:175]
  v_mfma_f32_32x32x16_bf16 v[224:239], v[92:95], v[108:111], v[224:239]
  s_waitcnt lgkmcnt(0)
  v_mfma_f32_32x32x16_bf16 v[112:127], v[64:67], v[96:99], v[112:127]
  ds_read_b128 v[104:107], v53 offset:16384
  ds_read_b128 v[80:83], v41 offset:0
  v_mfma_f32_32x32x16_bf16 v[176:191], v[64:67], v[100:103], v[176:191]
  ds_read_b128 v[108:111], v53 offset:24576
  ds_read_b128 v[84:87], v41 offset:4096
  v_mfma_f32_32x32x16_bf16 v[128:143], v[68:71], v[96:99], v[128:143]
  ds_read_b128 v[88:91], v41 offset:8192
  ds_read_b128 v[92:95], v41 offset:12288
  v_mfma_f32_32x32x16_bf16 v[192:207], v[68:71], v[100:103], v[192:207]
  v_mfma_f32_32x32x16_bf16 v[144:159], v[72:75], v[96:99], v[144:159]
  v_mfma_f32_32x32x16_bf16 v[208:223], v[72:75], v[100:103], v[208:223]
  v_mfma_f32_32x32x16_bf16 v[160:175], v[76:79], v[96:99], v[160:175]
  v_mfma_f32_32x32x16_bf16 v[224:239], v[76:79], v[100:103], v[224:239]
  s_waitcnt lgkmcnt(0)
  v_mfma_f32_32x32x16_bf16 v[112:127], v[80:83], v[104:107], v[112:127]
  ds_read_b128 v[96:99], v56 offset:16384
  ds_read_b128 v[64:67], v44 offset:0
  v_mfma_f32_32x32x16_bf16 v[176:191], v[80:83], v[108:111], v[176:191]
  ds_read_b128 v[100:103], v56 offset:24576
  ds_read_b128 v[68:71], v44 offset:4096
  v_mfma_f32_32x32x16_bf16 v[128:143], v[84:87], v[104:107], v[128:143]
  ds_read_b128 v[72:75], v44 offset:8192
  ds_read_b128 v[76:79], v44 offset:12288
  v_mfma_f32_32x32x16_bf16 v[192:207], v[84:87], v[108:111], v[192:207]
  v_mfma_f32_32x32x16_bf16 v[144:159], v[88:91], v[104:107], v[144:159]
  v_mfma_f32_32x32x16_bf16 v[208:223], v[88:91], v[108:111], v[208:223]
  v_mfma_f32_32x32x16_bf16 v[160:175], v[92:95], v[104:107], v[160:175]
  v_mfma_f32_32x32x16_bf16 v[224:239], v[92:95], v[108:111], v[224:239]
  s_waitcnt lgkmcnt(0)
  v_mfma_f32_32x32x16_bf16 v[112:127], v[64:67], v[96:99], v[112:127]
  ds_read_b128 v[104:107], v59 offset:16384
  ds_read_b128 v[80:83], v47 offset:0
  v_mfma_f32_32x32x16_bf16 v[176:191], v[64:67], v[100:103], v[176:191]
  ds_read_b128 v[108:111], v59 offset:24576
  ds_read_b128 v[84:87], v47 offset:4096
  v_mfma_f32_32x32x16_bf16 v[128:143], v[68:71], v[96:99], v[128:143]
  ds_read_b128 v[88:91], v47 offset:8192
  ds_read_b128 v[92:95], v47 offset:12288
  v_mfma_f32_32x32x16_bf16 v[192:207], v[68:71], v[100:103], v[192:207]
  v_mfma_f32_32x32x16_bf16 v[144:159], v[72:75], v[96:99], v[144:159]
  v_mfma_f32_32x32x16_bf16 v[208:223], v[72:75], v[100:103], v[208:223]
  v_mfma_f32_32x32x16_bf16 v[160:175], v[76:79], v[96:99], v[160:175]
  v_mfma_f32_32x32x16_bf16 v[224:239], v[76:79], v[100:103], v[224:239]
  s_waitcnt lgkmcnt(0)
  s_barrier
  v_mfma_f32_32x32x16_bf16 v[112:127], v[80:83], v[104:107], v[112:127]
  ds_read_b128 v[96:99], v51 offset:0
  ds_read_b128 v[64:67], v38 offset:49152
  v_mfma_f32_32x32x16_bf16 v[176:191], v[80:83], v[108:111], v[176:191]
  ds_read_b128 v[100:103], v51 offset:8192
  ds_read_b128 v[68:71], v38 offset:53248
  v_mfma_f32_32x32x16_bf16 v[128:143], v[84:87], v[104:107], v[128:143]
  ds_read_b128 v[72:75], v38 offset:57344
  ds_read_b128 v[76:79], v38 offset:61440
  v_mfma_f32_32x32x16_bf16 v[192:207], v[84:87], v[108:111], v[192:207]
  v_mfma_f32_32x32x16_bf16 v[144:159], v[88:91], v[104:107], v[144:159]
  v_mfma_f32_32x32x16_bf16 v[208:223], v[88:91], v[108:111], v[208:223]
  v_mfma_f32_32x32x16_bf16 v[160:175], v[92:95], v[104:107], v[160:175]
  v_mfma_f32_32x32x16_bf16 v[224:239], v[92:95], v[108:111], v[224:239]
  s_waitcnt lgkmcnt(0)
  v_mfma_f32_32x32x16_bf16 v[112:127], v[64:67], v[96:99], v[112:127]
  ds_read_b128 v[104:107], v54 offset:0
  ds_read_b128 v[80:83], v41 offset:49152
  v_mfma_f32_32x32x16_bf16 v[176:191], v[64:67], v[100:103], v[176:191]
  ds_read_b128 v[108:111], v54 offset:8192
  ds_read_b128 v[84:87], v41 offset:53248
  v_mfma_f32_32x32x16_bf16 v[128:143], v[68:71], v[96:99], v[128:143]
  ds_read_b128 v[88:91], v41 offset:57344
  ds_read_b128 v[92:95], v41 offset:61440
  v_mfma_f32_32x32x16_bf16 v[192:207], v[68:71], v[100:103], v[192:207]
  v_mfma_f32_32x32x16_bf16 v[144:159], v[72:75], v[96:99], v[144:159]
  v_mfma_f32_32x32x16_bf16 v[208:223], v[72:75], v[100:103], v[208:223]
  v_mfma_f32_32x32x16_bf16 v[160:175], v[76:79], v[96:99], v[160:175]
  v_mfma_f32_32x32x16_bf16 v[224:239], v[76:79], v[100:103], v[224:239]
  s_waitcnt lgkmcnt(0)
  v_mov_b32 v9, 0
  global_load_dwordx2 v[10:11], v9, s[48:49] sc1
  v_mfma_f32_32x32x16_bf16 v[112:127], v[80:83], v[104:107], v[112:127]
  ds_read_b128 v[96:99], v57 offset:0
  ds_read_b128 v[64:67], v44 offset:49152
  v_mfma_f32_32x32x16_bf16 v[176:191], v[80:83], v[108:111], v[176:191]
  ds_read_b128 v[100:103], v57 offset:8192
  ds_read_b128 v[68:71], v44 offset:53248
  v_mfma_f32_32x32x16_bf16 v[128:143], v[84:87], v[104:107], v[128:143]
  ds_read_b128 v[72:75], v44 offset:57344
  ds_read_b128 v[76:79], v44 offset:61440
  v_mfma_f32_32x32x16_bf16 v[192:207], v[84:87], v[108:111], v[192:207]
  v_mfma_f32_32x32x16_bf16 v[144:159], v[88:91], v[104:107], v[144:159]
  v_mfma_f32_32x32x16_bf16 v[208:223], v[88:91], v[108:111], v[208:223]
  v_mfma_f32_32x32x16_bf16 v[160:175], v[92:95], v[104:107], v[160:175]
  v_mfma_f32_32x32x16_bf16 v[224:239], v[92:95], v[108:111], v[224:239]
  s_waitcnt lgkmcnt(0)
  v_mfma_f32_32x32x16_bf16 v[112:127], v[64:67], v[96:99], v[112:127]
  ds_read_b128 v[104:107], v60 offset:0
  ds_read_b128 v[80:83], v47 offset:49152
  v_mfma_f32_32x32x16_bf16 v[176:191], v[64:67], v[100:103], v[176:191]
  ds_read_b128 v[108:111], v60 offset:8192
  ds_read_b128 v[84:87], v47 offset:53248
  v_mfma_f32_32x32x16_bf16 v[128:143], v[68:71], v[96:99], v[128:143]
  ds_read_b128 v[88:91], v47 offset:57344
  ds_read_b128 v[92:95], v47 offset:61440
  v_mfma_f32_32x32x16_bf16 v[192:207], v[68:71], v[100:103], v[192:207]
  v_mfma_f32_32x32x16_bf16 v[144:159], v[72:75], v[96:99], v[144:159]
  v_mfma_f32_32x32x16_bf16 v[208:223], v[72:75], v[100:103], v[208:223]
  v_mfma_f32_32x32x16_bf16 v[160:175], v[76:79], v[96:99], v[160:175]
  v_mfma_f32_32x32x16_bf16 v[224:239], v[76:79], v[100:103], v[224:239]
  s_waitcnt lgkmcnt(0)
  s_barrier
  v_mfma_f32_32x32x16_bf16 v[112:127], v[80:83], v[104:107], v[112:127]
  ds_read_b128 v[96:99], v51 offset:49152
  ds_read_b128 v[64:67], v39 offset:32768
  v_mfma_f32_32x32x16_bf16 v[176:191], v[80:83], v[108:111], v[176:191]
  ds_read_b128 v[100:103], v51 offset:57344
  ds_read_b128 v[68:71], v39 offset:36864
  v_mfma_f32_32x32x16_bf16 v[128:143], v[84:87], v[104:107], v[128:143]
  ds_read_b128 v[72:75], v39 offset:40960
  ds_read_b128 v[76:79], v39 offset:45056
  v_mfma_f32_32x32x16_bf16 v[192:207], v[84:87], v[108:111], v[192:207]
  v_mfma_f32_32x32x16_bf16 v[144:159], v[88:91], v[104:107], v[144:159]
  v_mfma_f32_32x32x16_bf16 v[208:223], v[88:91], v[108:111], v[208:223]
  v_mfma_f32_32x32x16_bf16 v[160:175], v[92:95], v[104:107], v[160:175]
  v_mfma_f32_32x32x16_bf16 v[224:239], v[92:95], v[108:111], v[224:239]
  s_waitcnt lgkmcnt(0)
  v_mfma_f32_32x32x16_bf16 v[112:127], v[64:67], v[96:99], v[112:127]
  ds_read_b128 v[104:107], v54 offset:49152
  ds_read_b128 v[80:83], v42 offset:32768
  v_mfma_f32_32x32x16_bf16 v[176:191], v[64:67], v[100:103], v[176:191]
  ds_read_b128 v[108:111], v54 offset:57344
  ds_read_b128 v[84:87], v42 offset:36864
  v_mfma_f32_32x32x16_bf16 v[128:143], v[68:71], v[96:99], v[128:143]
  ds_read_b128 v[88:91], v42 offset:40960
  ds_read_b128 v[92:95], v42 offset:45056
  v_mfma_f32_32x32x16_bf16 v[192:207], v[68:71], v[100:103], v[192:207]
  v_mfma_f32_32x32x16_bf16 v[144:159], v[72:75], v[96:99], v[144:159]
  v_mfma_f32_32x32x16_bf16 v[208:223], v[72:75], v[100:103], v[208:223]
  v_mfma_f32_32x32x16_bf16 v[160:175], v[76:79], v[96:99], v[160:175]
  v_mfma_f32_32x32x16_bf16 v[224:239], v[76:79], v[100:103], v[224:239]
  s_waitcnt lgkmcnt(0)
  v_mfma_f32_32x32x16_bf16 v[112:127], v[80:83], v[104:107], v[112:127]
  ds_read_b128 v[96:99], v57 offset:49152
  ds_read_b128 v[64:67], v45 offset:32768
  v_mfma_f32_32x32x16_bf16 v[176:191], v[80:83], v[108:111], v[176:191]
  ds_read_b128 v[100:103], v57 offset:57344
  ds_read_b128 v[68:71], v45 offset:36864
  v_mfma_f32_32x32x16_bf16 v[128:143], v[84:87], v[104:107], v[128:143]
  ds_read_b128 v[72:75], v45 offset:40960
  ds_read_b128 v[76:79], v45 offset:45056
  v_mfma_f32_32x32x16_bf16 v[192:207], v[84:87], v[108:111], v[192:207]
  v_mfma_f32_32x32x16_bf16 v[144:159], v[88:91], v[104:107], v[144:159]
  v_mfma_f32_32x32x16_bf16 v[208:223], v[88:91], v[108:111], v[208:223]
  v_mfma_f32_32x32x16_bf16 v[160:175], v[92:95], v[104:107], v[160:175]
  v_mfma_f32_32x32x16_bf16 v[224:239], v[92:95], v[108:111], v[224:239]
  s_waitcnt lgkmcnt(0)
  v_mfma_f32_32x32x16_bf16 v[112:127], v[64:67], v[96:99], v[112:127]
  ds_read_b128 v[104:107], v60 offset:49152
  ds_read_b128 v[80:83], v48 offset:32768
  v_mfma_f32_32x32x16_bf16 v[176:191], v[64:67], v[100:103], v[176:191]
  ds_read_b128 v[108:111], v60 offset:57344
  ds_read_b128 v[84:87], v48 offset:36864
  v_mfma_f32_32x32x16_bf16 v[128:143], v[68:71], v[96:99], v[128:143]
  ds_read_b128 v[88:91], v48 offset:40960
  ds_read_b128 v[92:95], v48 offset:45056
  v_mfma_f32_32x32x16_bf16 v[192:207], v[68:71], v[100:103], v[192:207]
  v_mfma_f32_32x32x16_bf16 v[144:159], v[72:75], v[96:99], v[144:159]
  v_mfma_f32_32x32x16_bf16 v[208:223], v[72:75], v[100:103], v[208:223]
  v_mfma_f32_32x32x16_bf16 v[160:175], v[76:79], v[96:99], v[160:175]
  v_mfma_f32_32x32x16_bf16 v[224:239], v[76:79], v[100:103], v[224:239]
  s_waitcnt lgkmcnt(0)
  s_barrier
  v_mfma_f32_32x32x16_bf16 v[112:127], v[80:83], v[104:107], v[112:127]
  ds_read_b128 v[96:99], v50 offset:16384
  ds_read_b128 v[64:67], v38 offset:0
  v_mfma_f32_32x32x16_bf16 v[176:191], v[80:83], v[108:111], v[176:191]
  ds_read_b128 v[100:103], v50 offset:24576
  ds_read_b128 v[68:71], v38 offset:4096
  v_mfma_f32_32x32x16_bf16 v[128:143], v[84:87], v[104:107], v[128:143]
  ds_read_b128 v[72:75], v38 offset:8192
  ds_read_b128 v[76:79], v38 offset:12288
  v_mfma_f32_32x32x16_bf16 v[192:207], v[84:87], v[108:111], v[192:207]
  v_mfma_f32_32x32x16_bf16 v[144:159], v[88:91], v[104:107], v[144:159]
  v_mfma_f32_32x32x16_bf16 v[208:223], v[88:91], v[108:111], v[208:223]
  v_mfma_f32_32x32x16_bf16 v[160:175], v[92:95], v[104:107], v[160:175]
  v_mfma_f32_32x32x16_bf16 v[224:239], v[92:95], v[108:111], v[224:239]
  s_waitcnt lgkmcnt(0)
  v_mfma_f32_32x32x16_bf16 v[112:127], v[64:67], v[96:99], v[112:127]
  ds_read_b128 v[104:107], v53 offset:16384
  ds_read_b128 v[80:83], v41 offset:0
  v_mfma_f32_32x32x16_bf16 v[176:191], v[64:67], v[100:103], v[176:191]
  ds_read_b128 v[108:111], v53 offset:24576
  ds_read_b128 v[84:87], v41 offset:4096
  v_mfma_f32_32x32x16_bf16 v[128:143], v[68:71], v[96:99], v[128:143]
  ds_read_b128 v[88:91], v41 offset:8192
  ds_read_b128 v[92:95], v41 offset:12288
  v_mfma_f32_32x32x16_bf16 v[192:207], v[68:71], v[100:103], v[192:207]
  v_mfma_f32_32x32x16_bf16 v[144:159], v[72:75], v[96:99], v[144:159]
  v_mfma_f32_32x32x16_bf16 v[208:223], v[72:75], v[100:103], v[208:223]
  v_mfma_f32_32x32x16_bf16 v[160:175], v[76:79], v[96:99], v[160:175]
  v_mfma_f32_32x32x16_bf16 v[224:239], v[76:79], v[100:103], v[224:239]
  s_waitcnt lgkmcnt(0)
  v_mfma_f32_32x32x16_bf16 v[112:127], v[80:83], v[104:107], v[112:127]
  ds_read_b128 v[96:99], v56 offset:16384
  ds_read_b128 v[64:67], v44 offset:0
  v_mfma_f32_32x32x16_bf16 v[176:191], v[80:83], v[108:111], v[176:191]
  ds_read_b128 v[100:103], v56 offset:24576
  ds_read_b128 v[68:71], v44 offset:4096
  v_mfma_f32_32x32x16_bf16 v[128:143], v[84:87], v[104:107], v[128:143]
  ds_read_b128 v[72:75], v44 offset:8192
  ds_read_b128 v[76:79], v44 offset:12288
  v_mfma_f32_32x32x16_bf16 v[192:207], v[84:87], v[108:111], v[192:207]
  v_mfma_f32_32x32x16_bf16 v[144:159], v[88:91], v[104:107], v[144:159]
  v_mfma_f32_32x32x16_bf16 v[208:223], v[88:91], v[108:111], v[208:223]
  v_mfma_f32_32x32x16_bf16 v[160:175], v[92:95], v[104:107], v[160:175]
  v_mfma_f32_32x32x16_bf16 v[224:239], v[92:95], v[108:111], v[224:239]
  s_waitcnt lgkmcnt(0)
  v_mfma_f32_32x32x16_bf16 v[112:127], v[64:67], v[96:99], v[112:127]
  ds_read_b128 v[104:107], v59 offset:16384
  ds_read_b128 v[80:83], v47 offset:0
  v_mfma_f32_32x32x16_bf16 v[176:191], v[64:67], v[100:103], v[176:191]
  ds_read_b128 v[108:111], v59 offset:24576
  ds_read_b128 v[84:87], v47 offset:4096
  v_mfma_f32_32x32x16_bf16 v[128:143], v[68:71], v[96:99], v[128:143]
  ds_read_b128 v[88:91], v47 offset:8192
  ds_read_b128 v[92:95], v47 offset:12288
  v_mfma_f32_32x32x16_bf16 v[192:207], v[68:71], v[100:103], v[192:207]
  v_mfma_f32_32x32x16_bf16 v[144:159], v[72:75], v[96:99], v[144:159]
  v_mfma_f32_32x32x16_bf16 v[208:223], v[72:75], v[100:103], v[208:223]
  v_mfma_f32_32x32x16_bf16 v[160:175], v[76:79], v[96:99], v[160:175]
  v_mfma_f32_32x32x16_bf16 v[224:239], v[76:79], v[100:103], v[224:239]
  s_waitcnt lgkmcnt(0)
  s_barrier
  v_mfma_f32_32x32x16_bf16 v[112:127], v[80:83], v[104:107], v[112:127]
  ds_read_b128 v[96:99], v51 offset:0
  ds_read_b128 v[64:67], v38 offset:49152
  v_mfma_f32_32x32x16_bf16 v[176:191], v[80:83], v[108:111], v[176:191]
  ds_read_b128 v[100:103], v51 offset:8192
  ds_read_b128 v[68:71], v38 offset:53248
  v_mfma_f32_32x32x16_bf16 v[128:143], v[84:87], v[104:107], v[128:143]
  ds_read_b128 v[72:75], v38 offset:57344
  ds_read_b128 v[76:79], v38 offset:61440
  v_mfma_f32_32x32x16_bf16 v[192:207], v[84:87], v[108:111], v[192:207]
  v_mfma_f32_32x32x16_bf16 v[144:159], v[88:91], v[104:107], v[144:159]
  v_mfma_f32_32x32x16_bf16 v[208:223], v[88:91], v[108:111], v[208:223]
  v_mfma_f32_32x32x16_bf16 v[160:175], v[92:95], v[104:107], v[160:175]
  v_mfma_f32_32x32x16_bf16 v[224:239], v[92:95], v[108:111], v[224:239]
  s_waitcnt lgkmcnt(0)
  v_mfma_f32_32x32x16_bf16 v[112:127], v[64:67], v[96:99], v[112:127]
  ds_read_b128 v[104:107], v54 offset:0
  ds_read_b128 v[80:83], v41 offset:49152
  v_mfma_f32_32x32x16_bf16 v[176:191], v[64:67], v[100:103], v[176:191]
  ds_read_b128 v[108:111], v54 offset:8192
  ds_read_b128 v[84:87], v41 offset:53248
  v_mfma_f32_32x32x16_bf16 v[128:143], v[68:71], v[96:99], v[128:143]
  ds_read_b128 v[88:91], v41 offset:57344
  ds_read_b128 v[92:95], v41 offset:61440
  v_mfma_f32_32x32x16_bf16 v[192:207], v[68:71], v[100:103], v[192:207]
  v_mfma_f32_32x32x16_bf16 v[144:159], v[72:75], v[96:99], v[144:159]
  v_mfma_f32_32x32x16_bf16 v[208:223], v[72:75], v[100:103], v[208:223]
  v_mfma_f32_32x32x16_bf16 v[160:175], v[76:79], v[96:99], v[160:175]
  v_mfma_f32_32x32x16_bf16 v[224:239], v[76:79], v[100:103], v[224:239]
  s_waitcnt lgkmcnt(0)
  v_mfma_f32_32x32x16_bf16 v[112:127], v[80:83], v[104:107], v[112:127]
  ds_read_b128 v[96:99], v57 offset:0
  ds_read_b128 v[64:67], v44 offset:49152
  v_mfma_f32_32x32x16_bf16 v[176:191], v[80:83], v[108:111], v[176:191]
  ds_read_b128 v[100:103], v57 offset:8192
  ds_read_b128 v[68:71], v44 offset:53248
  v_mfma_f32_32x32x16_bf16 v[128:143], v[84:87], v[104:107], v[128:143]
  ds_read_b128 v[72:75], v44 offset:57344
  ds_read_b128 v[76:79], v44 offset:61440
  v_mfma_f32_32x32x16_bf16 v[192:207], v[84:87], v[108:111], v[192:207]
  v_mfma_f32_32x32x16_bf16 v[144:159], v[88:91], v[104:107], v[144:159]
  v_mfma_f32_32x32x16_bf16 v[208:223], v[88:91], v[108:111], v[208:223]
  v_mfma_f32_32x32x16_bf16 v[160:175], v[92:95], v[104:107], v[160:175]
  v_mfma_f32_32x32x16_bf16 v[224:239], v[92:95], v[108:111], v[224:239]
  s_waitcnt lgkmcnt(0)
  v_mfma_f32_32x32x16_bf16 v[112:127], v[64:67], v[96:99], v[112:127]
  ds_read_b128 v[104:107], v60 offset:0
  ds_read_b128 v[80:83], v47 offset:49152
  v_mfma_f32_32x32x16_bf16 v[176:191], v[64:67], v[100:103], v[176:191]
  ds_read_b128 v[108:111], v60 offset:8192
  ds_read_b128 v[84:87], v47 offset:53248
  v_mfma_f32_32x32x16_bf16 v[128:143], v[68:71], v[96:99], v[128:143]
  ds_read_b128 v[88:91], v47 offset:57344
  ds_read_b128 v[92:95], v47 offset:61440
  v_mfma_f32_32x32x16_bf16 v[192:207], v[68:71], v[100:103], v[192:207]
  v_mfma_f32_32x32x16_bf16 v[144:159], v[72:75], v[96:99], v[144:159]
  v_mfma_f32_32x32x16_bf16 v[208:223], v[72:75], v[100:103], v[208:223]
  v_mfma_f32_32x32x16_bf16 v[160:175], v[76:79], v[96:99], v[160:175]
  v_mfma_f32_32x32x16_bf16 v[224:239], v[76:79], v[100:103], v[224:239]
  s_waitcnt lgkmcnt(0)
  s_barrier
  v_mfma_f32_32x32x16_bf16 v[112:127], v[80:83], v[104:107], v[112:127]
  v_mfma_f32_32x32x16_bf16 v[176:191], v[80:83], v[108:111], v[176:191]
  v_mfma_f32_32x32x16_bf16 v[128:143], v[84:87], v[104:107], v[128:143]
  v_mfma_f32_32x32x16_bf16 v[192:207], v[84:87], v[108:111], v[192:207]
  v_mfma_f32_32x32x16_bf16 v[144:159], v[88:91], v[104:107], v[144:159]
  v_mfma_f32_32x32x16_bf16 v[208:223], v[88:91], v[108:111], v[208:223]
  v_mfma_f32_32x32x16_bf16 v[160:175], v[92:95], v[104:107], v[160:175]
  v_mfma_f32_32x32x16_bf16 v[224:239], v[92:95], v[108:111], v[224:239]
  s_mov_b32 s85, 0x40000
nonce_28:
  s_waitcnt vmcnt(0)
  v_readfirstlane_b32 s76, v10
  v_readfirstlane_b32 s77, v11
  s_cmp_lg_u32 s77, 0
  s_cbranch_scc1 nonce_ok_29
  s_sub_u32 s85, s85, 1
  s_cbranch_scc1 nonce_ok_29
  s_sleep 1
  v_mov_b32 v9, 0
  global_load_dwordx2 v[10:11], v9, s[48:49] sc1
  s_branch nonce_28
nonce_ok_29:
  s_nop 3
  s_lshl_b32 s36, s4, 10
  s_add_u32 s37, s36, 16384
  v_lshrrev_b32 v2, 6, v16
  v_and_b32 v3, 63, v16
  v_lshlrev_b32 v3, 4, v3
  v_lshl_add_u32 v2, v2, 14, v3
  v_add_u32 v6, 0x1110000, v2
  v_permlane16_swap_b32 v112, v128
  v_permlane16_swap_b32 v113, v129
  v_permlane16_swap_b32 v114, v130
  v_permlane16_swap_b32 v115, v131
  v_permlane16_swap_b32 v116, v132
  v_permlane16_swap_b32 v117, v133
  v_permlane16_swap_b32 v118, v134
  v_permlane16_swap_b32 v119, v135
  v_permlane16_swap_b32 v120, v136
  v_permlane16_swap_b32 v121, v137
  v_permlane16_swap_b32 v122, v138
  v_permlane16_swap_b32 v123, v139
  v_permlane16_swap_b32 v124, v140
  v_permlane16_swap_b32 v125, v141
  v_permlane16_swap_b32 v126, v142
  v_permlane16_swap_b32 v127, v143
  v_permlane16_swap_b32 v144, v160
  v_permlane16_swap_b32 v145, v161
  v_permlane16_swap_b32 v146, v162
  v_permlane16_swap_b32 v147, v163
  v_permlane16_swap_b32 v148, v164
  v_permlane16_swap_b32 v149, v165
  v_permlane16_swap_b32 v150, v166
  v_permlane16_swap_b32 v151, v167
  v_permlane16_swap_b32 v152, v168
  v_permlane16_swap_b32 v153, v169
  v_permlane16_swap_b32 v154, v170
  v_permlane16_swap_b32 v155, v171
  v_permlane16_swap_b32 v156, v172
  v_permlane16_swap_b32 v157, v173
  v_permlane16_swap_b32 v158, v174
  v_permlane16_swap_b32 v159, v175
  v_pk_fma_f32 v[68:69], v[22:23], v[112:113], v[114:115] op_sel:[0,0,0] op_sel_hi:[0,1,1]
  v_pk_fma_f32 v[70:71], v[22:23], v[128:129], v[130:131] op_sel:[0,0,0] op_sel_hi:[0,1,1]
  v_pk_fma_f32 v[68:69], v[22:23], v[128:129], v[68:69] op_sel:[1,0,0] op_sel_hi:[1,1,1] neg_lo:[1,0,0] neg_hi:[1,0,0]
  v_pk_fma_f32 v[70:71], v[22:23], v[112:113], v[70:71] op_sel:[1,0,0] op_sel_hi:[1,1,1]
  v_pk_fma_f32 v[64:65], v[22:23], v[68:69], v[116:117] op_sel:[0,0,0] op_sel_hi:[0,1,1]
  v_pk_fma_f32 v[66:67], v[22:23], v[70:71], v[132:133] op_sel:[0,0,0] op_sel_hi:[0,1,1]
  v_pk_fma_f32 v[64:65], v[22:23], v[70:71], v[64:65] op_sel:[1,0,0] op_sel_hi:[1,1,1] neg_lo:[1,0,0] neg_hi:[1,0,0]
  v_pk_fma_f32 v[66:67], v[22:23], v[68:69], v[66:67] op_sel:[1,0,0] op_sel_hi:[1,1,1]
  v_pk_fma_f32 v[68:69], v[22:23], v[64:65], v[118:119] op_sel:[0,0,0] op_sel_hi:[0,1,1]
  v_pk_fma_f32 v[70:71], v[22:23], v[66:67], v[134:135] op_sel:[0,0,0] op_sel_hi:[0,1,1]
  v_pk_fma_f32 v[68:69], v[22:23], v[66:67], v[68:69] op_sel:[1,0,0] op_sel_hi:[1,1,1] neg_lo:[1,0,0] neg_hi:[1,0,0]
  v_pk_fma_f32 v[70:71], v[22:23], v[64:65], v[70:71] op_sel:[1,0,0] op_sel_hi:[1,1,1]
  v_pk_fma_f32 v[64:65], v[22:23], v[68:69], v[120:121] op_sel:[0,0,0] op_sel_hi:[0,1,1]
  v_pk_fma_f32 v[66:67], v[22:23], v[70:71], v[136:137] op_sel:[0,0,0] op_sel_hi:[0,1,1]
  v_pk_fma_f32 v[64:65], v[22:23], v[70:71], v[64:65] op_sel:[1,0,0] op_sel_hi:[1,1,1] neg_lo:[1,0,0] neg_hi:[1,0,0]
  v_pk_fma_f32 v[66:67], v[22:23], v[68:69], v[66:67] op_sel:[1,0,0] op_sel_hi:[1,1,1]
  v_pk_fma_f32 v[68:69], v[22:23], v[64:65], v[122:123] op_sel:[0,0,0] op_sel_hi:[0,1,1]
  v_pk_fma_f32 v[70:71], v[22:23], v[66:67], v[138:139] op_sel:[0,0,0] op_sel_hi:[0,1,1]
  v_pk_fma_f32 v[68:69], v[22:23], v[66:67], v[68:69] op_sel:[1,0,0] op_sel_hi:[1,1,1] neg_lo:[1,0,0] neg_hi:[1,0,0]
  v_pk_fma_f32 v[70:71], v[22:23], v[64:65], v[70:71] op_sel:[1,0,0] op_sel_hi:[1,1,1]
  v_pk_fma_f32 v[64:65], v[22:23], v[68:69], v[124:125] op_sel:[0,0,0] op_sel_hi:[0,1,1]
  v_pk_fma_f32 v[66:67], v[22:23], v[70:71], v[140:141] op_sel:[0,0,0] op_sel_hi:[0,1,1]
  v_pk_fma_f32 v[64:65], v[22:23], v[70:71], v[64:65] op_sel:[1,0,0] op_sel_hi:[1,1,1] neg_lo:[1,0,0] neg_hi:[1,0,0]
  v_pk_fma_f32 v[66:67], v[22:23], v[68:69], v[66:67] op_sel:[1,0,0] op_sel_hi:[1,1,1]
  v_pk_fma_f32 v[68:69], v[22:23], v[64:65], v[126:127] op_sel:[0,0,0] op_sel_hi:[0,1,1]
  v_pk_fma_f32 v[70:71], v[22:23], v[66:67], v[142:143] op_sel:[0,0,0] op_sel_hi:[0,1,1]
  v_pk_fma_f32 v[68:69], v[22:23], v[66:67], v[68:69] op_sel:[1,0,0] op_sel_hi:[1,1,1] neg_lo:[1,0,0] neg_hi:[1,0,0]
  v_pk_fma_f32 v[70:71], v[22:23], v[64:65], v[70:71] op_sel:[1,0,0] op_sel_hi:[1,1,1]
  v_pk_fma_f32 v[64:65], v[22:23], v[68:69], v[144:145] op_sel:[0,0,0] op_sel_hi:[0,1,1]
  v_pk_fma_f32 v[66:67], v[22:23], v[70:71], v[160:161] op_sel:[0,0,0] op_sel_hi:[0,1,1]
  v_pk_fma_f32 v[64:65], v[22:23], v[70:71], v[64:65] op_sel:[1,0,0] op_sel_hi:[1,1,1] neg_lo:[1,0,0] neg_hi:[1,0,0]
  v_pk_fma_f32 v[66:67], v[22:23], v[68:69], v[66:67] op_sel:[1,0,0] op_sel_hi:[1,1,1]
  v_pk_fma_f32 v[68:69], v[22:23], v[64:65], v[146:147] op_sel:[0,0,0] op_sel_hi:[0,1,1]
  v_pk_fma_f32 v[70:71], v[22:23], v[66:67], v[162:163] op_sel:[0,0,0] op_sel_hi:[0,1,1]
  v_pk_fma_f32 v[68:69], v[22:23], v[66:67], v[68:69] op_sel:[1,0,0] op_sel_hi:[1,1,1] neg_lo:[1,0,0] neg_hi:[1,0,0]
  v_pk_fma_f32 v[70:71], v[22:23], v[64:65], v[70:71] op_sel:[1,0,0] op_sel_hi:[1,1,1]
  v_pk_fma_f32 v[64:65], v[22:23], v[68:69], v[148:149] op_sel:[0,0,0] op_sel_hi:[0,1,1]
  v_pk_fma_f32 v[66:67], v[22:23], v[70:71], v[164:165] op_sel:[0,0,0] op_sel_hi:[0,1,1]
  v_pk_fma_f32 v[64:65], v[22:23], v[70:71], v[64:65] op_sel:[1,0,0] op_sel_hi:[1,1,1] neg_lo:[1,0,0] neg_hi:[1,0,0]
  v_pk_fma_f32 v[66:67], v[22:23], v[68:69], v[66:67] op_sel:[1,0,0] op_sel_hi:[1,1,1]
  v_pk_fma_f32 v[68:69], v[22:23], v[64:65], v[150:151] op_sel:[0,0,0] op_sel_hi:[0,1,1]
  v_pk_fma_f32 v[70:71], v[22:23], v[66:67], v[166:167] op_sel:[0,0,0] op_sel_hi:[0,1,1]
  v_pk_fma_f32 v[68:69], v[22:23], v[66:67], v[68:69] op_sel:[1,0,0] op_sel_hi:[1,1,1] neg_lo:[1,0,0] neg_hi:[1,0,0]
  v_pk_fma_f32 v[70:71], v[22:23], v[64:65], v[70:71] op_sel:[1,0,0] op_sel_hi:[1,1,1]
  v_pk_fma_f32 v[64:65], v[22:23], v[68:69], v[152:153] op_sel:[0,0,0] op_sel_hi:[0,1,1]
  v_pk_fma_f32 v[66:67], v[22:23], v[70:71], v[168:169] op_sel:[0,0,0] op_sel_hi:[0,1,1]
  v_pk_fma_f32 v[64:65], v[22:23], v[70:71], v[64:65] op_sel:[1,0,0] op_sel_hi:[1,1,1] neg_lo:[1,0,0] neg_hi:[1,0,0]
  v_pk_fma_f32 v[66:67], v[22:23], v[68:69], v[66:67] op_sel:[1,0,0] op_sel_hi:[1,1,1]
  v_pk_fma_f32 v[68:69], v[22:23], v[64:65], v[154:155] op_sel:[0,0,0] op_sel_hi:[0,1,1]
  v_pk_fma_f32 v[70:71], v[22:23], v[66:67], v[170:171] op_sel:[0,0,0] op_sel_hi:[0,1,1]
  v_pk_fma_f32 v[68:69], v[22:23], v[66:67], v[68:69] op_sel:[1,0,0] op_sel_hi:[1,1,1] neg_lo:[1,0,0] neg_hi:[1,0,0]
  v_pk_fma_f32 v[70:71], v[22:23], v[64:65], v[70:71] op_sel:[1,0,0] op_sel_hi:[1,1,1]
  v_pk_fma_f32 v[64:65], v[22:23], v[68:69], v[156:157] op_sel:[0,0,0] op_sel_hi:[0,1,1]
  v_pk_fma_f32 v[66:67], v[22:23], v[70:71], v[172:173] op_sel:[0,0,0] op_sel_hi:[0,1,1]
  v_pk_fma_f32 v[64:65], v[22:23], v[70:71], v[64:65] op_sel:[1,0,0] op_sel_hi:[1,1,1] neg_lo:[1,0,0] neg_hi:[1,0,0]
  v_pk_fma_f32 v[66:67], v[22:23], v[68:69], v[66:67] op_sel:[1,0,0] op_sel_hi:[1,1,1]
  v_pk_fma_f32 v[68:69], v[22:23], v[64:65], v[158:159] op_sel:[0,0,0] op_sel_hi:[0,1,1]
  v_pk_fma_f32 v[70:71], v[22:23], v[66:67], v[174:175] op_sel:[0,0,0] op_sel_hi:[0,1,1]
  v_pk_fma_f32 v[68:69], v[22:23], v[66:67], v[68:69] op_sel:[1,0,0] op_sel_hi:[1,1,1] neg_lo:[1,0,0] neg_hi:[1,0,0]
  v_pk_fma_f32 v[70:71], v[22:23], v[64:65], v[70:71] op_sel:[1,0,0] op_sel_hi:[1,1,1]
  v_mov_b32 v72, v68
  v_mov_b32 v73, v70
  v_mov_b32 v80, v69
  v_mov_b32 v81, v71
  v_fma_f32 v80, v24, v72, v80
  v_fma_f32 v81, v24, v73, v81
  v_fma_f32 v80, -v25, v73, v80
  v_fma_f32 v81, v25, v72, v81
  v_mov_b32 v82, v80
  v_mov_b32 v86, v80
  v_mov_b32 v83, v81
  v_mov_b32 v87, v81
  s_nop 0
  v_permlane32_swap_b32 v82, v86
  v_permlane32_swap_b32 v83, v87
  v_mov_b32 v84, v82
  v_mov_b32 v88, v86
  v_mov_b32 v85, v83
  v_mov_b32 v89, v87
  s_nop 0
  v_permlane16_swap_b32 v82, v84
  v_permlane16_swap_b32 v86, v88
  v_permlane16_swap_b32 v83, v85
  v_permlane16_swap_b32 v87, v89
  v_fma_f32 v84, v26, v82, v84
  v_fma_f32 v85, v26, v83, v85
  v_fma_f32 v84, -v27, v83, v84
  v_fma_f32 v85, v27, v82, v85
  v_fma_f32 v86, v26, v84, v86
  v_fma_f32 v87, v26, v85, v87
  v_fma_f32 v86, -v27, v85, v86
  v_fma_f32 v87, v27, v84, v87
  v_fma_f32 v92, v26, v86, v88
  v_fma_f32 v93, v26, v87, v89
  v_fma_f32 v92, -v27, v87, v92
  v_fma_f32 v93, v27, v86, v93
  v_mov_b32 v94, s76
  v_mov_b32 v95, s77
  s_mov_b64 exec, 0xffff
  buffer_store_dwordx4 v[92:95], v6, s[60:63], s36 offen sc1
  s_mov_b64 exec, -1
  v_cndmask_b32 v76, 0, v82, s[24:25]
  v_cndmask_b32 v77, 0, v83, s[24:25]
  v_cndmask_b32 v76, v76, v84, s[26:27]
  v_cndmask_b32 v77, v77, v85, s[26:27]
  v_cndmask_b32 v76, v76, v86, s[28:29]
  v_cndmask_b32 v77, v77, v87, s[28:29]
  v_permlane16_swap_b32 v176, v192
  v_permlane16_swap_b32 v177, v193
  v_permlane16_swap_b32 v178, v194
  v_permlane16_swap_b32 v179, v195
  v_permlane16_swap_b32 v180, v196
  v_permlane16_swap_b32 v181, v197
  v_permlane16_swap_b32 v182, v198
  v_permlane16_swap_b32 v183, v199
  v_permlane16_swap_b32 v184, v200
  v_permlane16_swap_b32 v185, v201
  v_permlane16_swap_b32 v186, v202
  v_permlane16_swap_b32 v187, v203
  v_permlane16_swap_b32 v188, v204
  v_permlane16_swap_b32 v189, v205
  v_permlane16_swap_b32 v190, v206
  v_permlane16_swap_b32 v191, v207
  v_permlane16_swap_b32 v208, v224
  v_permlane16_swap_b32 v209, v225
  v_permlane16_swap_b32 v210, v226
  v_permlane16_swap_b32 v211, v227
  v_permlane16_swap_b32 v212, v228
  v_permlane16_swap_b32 v213, v229
  v_permlane16_swap_b32 v214, v230
  v_permlane16_swap_b32 v215, v231
  v_permlane16_swap_b32 v216, v232
  v_permlane16_swap_b32 v217, v233
  v_permlane16_swap_b32 v218, v234
  v_permlane16_swap_b32 v219, v235
  v_permlane16_swap_b32 v220, v236
  v_permlane16_swap_b32 v221, v237
  v_permlane16_swap_b32 v222, v238
  v_permlane16_swap_b32 v223, v239
  v_pk_fma_f32 v[68:69], v[32:33], v[176:177], v[178:179] op_sel:[0,0,0] op_sel_hi:[0,1,1]
  v_pk_fma_f32 v[70:71], v[32:33], v[192:193], v[194:195] op_sel:[0,0,0] op_sel_hi:[0,1,1]
  v_pk_fma_f32 v[68:69], v[32:33], v[192:193], v[68:69] op_sel:[1,0,0] op_sel_hi:[1,1,1] neg_lo:[1,0,0] neg_hi:[1,0,0]
  v_pk_fma_f32 v[70:71], v[32:33], v[176:177], v[70:71] op_sel:[1,0,0] op_sel_hi:[1,1,1]
  v_pk_fma_f32 v[64:65], v[32:33], v[68:69], v[180:181] op_sel:[0,0,0] op_sel_hi:[0,1,1]
  v_pk_fma_f32 v[66:67], v[32:33], v[70:71], v[196:197] op_sel:[0,0,0] op_sel_hi:[0,1,1]
  v_pk_fma_f32 v[64:65], v[32:33], v[70:71], v[64:65] op_sel:[1,0,0] op_sel_hi:[1,1,1] neg_lo:[1,0,0] neg_hi:[1,0,0]
  v_pk_fma_f32 v[66:67], v[32:33], v[68:69], v[66:67] op_sel:[1,0,0] op_sel_hi:[1,1,1]
  v_pk_fma_f32 v[68:69], v[32:33], v[64:65], v[182:183] op_sel:[0,0,0] op_sel_hi:[0,1,1]
  v_pk_fma_f32 v[70:71], v[32:33], v[66:67], v[198:199] op_sel:[0,0,0] op_sel_hi:[0,1,1]
  v_pk_fma_f32 v[68:69], v[32:33], v[66:67], v[68:69] op_sel:[1,0,0] op_sel_hi:[1,1,1] neg_lo:[1,0,0] neg_hi:[1,0,0]
  v_pk_fma_f32 v[70:71], v[32:33], v[64:65], v[70:71] op_sel:[1,0,0] op_sel_hi:[1,1,1]
  v_pk_fma_f32 v[64:65], v[32:33], v[68:69], v[184:185] op_sel:[0,0,0] op_sel_hi:[0,1,1]
  v_pk_fma_f32 v[66:67], v[32:33], v[70:71], v[200:201] op_sel:[0,0,0] op_sel_hi:[0,1,1]
  v_pk_fma_f32 v[64:65], v[32:33], v[70:71], v[64:65] op_sel:[1,0,0] op_sel_hi:[1,1,1] neg_lo:[1,0,0] neg_hi:[1,0,0]
  v_pk_fma_f32 v[66:67], v[32:33], v[68:69], v[66:67] op_sel:[1,0,0] op_sel_hi:[1,1,1]
  v_pk_fma_f32 v[68:69], v[32:33], v[64:65], v[186:187] op_sel:[0,0,0] op_sel_hi:[0,1,1]
  v_pk_fma_f32 v[70:71], v[32:33], v[66:67], v[202:203] op_sel:[0,0,0] op_sel_hi:[0,1,1]
  v_pk_fma_f32 v[68:69], v[32:33], v[66:67], v[68:69] op_sel:[1,0,0] op_sel_hi:[1,1,1] neg_lo:[1,0,0] neg_hi:[1,0,0]
  v_pk_fma_f32 v[70:71], v[32:33], v[64:65], v[70:71] op_sel:[1,0,0] op_sel_hi:[1,1,1]
  v_pk_fma_f32 v[64:65], v[32:33], v[68:69], v[188:189] op_sel:[0,0,0] op_sel_hi:[0,1,1]
  v_pk_fma_f32 v[66:67], v[32:33], v[70:71], v[204:205] op_sel:[0,0,0] op_sel_hi:[0,1,1]
  v_pk_fma_f32 v[64:65], v[32:33], v[70:71], v[64:65] op_sel:[1,0,0] op_sel_hi:[1,1,1] neg_lo:[1,0,0] neg_hi:[1,0,0]
  v_pk_fma_f32 v[66:67], v[32:33], v[68:69], v[66:67] op_sel:[1,0,0] op_sel_hi:[1,1,1]
  v_pk_fma_f32 v[68:69], v[32:33], v[64:65], v[190:191] op_sel:[0,0,0] op_sel_hi:[0,1,1]
  v_pk_fma_f32 v[70:71], v[32:33], v[66:67], v[206:207] op_sel:[0,0,0] op_sel_hi:[0,1,1]
  v_pk_fma_f32 v[68:69], v[32:33], v[66:67], v[68:69] op_sel:[1,0,0] op_sel_hi:[1,1,1] neg_lo:[1,0,0] neg_hi:[1,0,0]
  v_pk_fma_f32 v[70:71], v[32:33], v[64:65], v[70:71] op_sel:[1,0,0] op_sel_hi:[1,1,1]
  v_pk_fma_f32 v[64:65], v[32:33], v[68:69], v[208:209] op_sel:[0,0,0] op_sel_hi:[0,1,1]
  v_pk_fma_f32 v[66:67], v[32:33], v[70:71], v[224:225] op_sel:[0,0,0] op_sel_hi:[0,1,1]
  v_pk_fma_f32 v[64:65], v[32:33], v[70:71], v[64:65] op_sel:[1,0,0] op_sel_hi:[1,1,1] neg_lo:[1,0,0] neg_hi:[1,0,0]
  v_pk_fma_f32 v[66:67], v[32:33], v[68:69], v[66:67] op_sel:[1,0,0] op_sel_hi:[1,1,1]
  v_pk_fma_f32 v[68:69], v[32:33], v[64:65], v[210:211] op_sel:[0,0,0] op_sel_hi:[0,1,1]
  v_pk_fma_f32 v[70:71], v[32:33], v[66:67], v[226:227] op_sel:[0,0,0] op_sel_hi:[0,1,1]
  v_pk_fma_f32 v[68:69], v[32:33], v[66:67], v[68:69] op_sel:[1,0,0] op_sel_hi:[1,1,1] neg_lo:[1,0,0] neg_hi:[1,0,0]
  v_pk_fma_f32 v[70:71], v[32:33], v[64:65], v[70:71] op_sel:[1,0,0] op_sel_hi:[1,1,1]
  v_pk_fma_f32 v[64:65], v[32:33], v[68:69], v[212:213] op_sel:[0,0,0] op_sel_hi:[0,1,1]
  v_pk_fma_f32 v[66:67], v[32:33], v[70:71], v[228:229] op_sel:[0,0,0] op_sel_hi:[0,1,1]
  v_pk_fma_f32 v[64:65], v[32:33], v[70:71], v[64:65] op_sel:[1,0,0] op_sel_hi:[1,1,1] neg_lo:[1,0,0] neg_hi:[1,0,0]
  v_pk_fma_f32 v[66:67], v[32:33], v[68:69], v[66:67] op_sel:[1,0,0] op_sel_hi:[1,1,1]
  v_pk_fma_f32 v[68:69], v[32:33], v[64:65], v[214:215] op_sel:[0,0,0] op_sel_hi:[0,1,1]
  v_pk_fma_f32 v[70:71], v[32:33], v[66:67], v[230:231] op_sel:[0,0,0] op_sel_hi:[0,1,1]
  v_pk_fma_f32 v[68:69], v[32:33], v[66:67], v[68:69] op_sel:[1,0,0] op_sel_hi:[1,1,1] neg_lo:[1,0,0] neg_hi:[1,0,0]
  v_pk_fma_f32 v[70:71], v[32:33], v[64:65], v[70:71] op_sel:[1,0,0] op_sel_hi:[1,1,1]
  v_pk_fma_f32 v[64:65], v[32:33], v[68:69], v[216:217] op_sel:[0,0,0] op_sel_hi:[0,1,1]
  v_pk_fma_f32 v[66:67], v[32:33], v[70:71], v[232:233] op_sel:[0,0,0] op_sel_hi:[0,1,1]
  v_pk_fma_f32 v[64:65], v[32:33], v[70:71], v[64:65] op_sel:[1,0,0] op_sel_hi:[1,1,1] neg_lo:[1,0,0] neg_hi:[1,0,0]
  v_pk_fma_f32 v[66:67], v[32:33], v[68:69], v[66:67] op_sel:[1,0,0] op_sel_hi:[1,1,1]
  v_pk_fma_f32 v[68:69], v[32:33], v[64:65], v[218:219] op_sel:[0,0,0] op_sel_hi:[0,1,1]
  v_pk_fma_f32 v[70:71], v[32:33], v[66:67], v[234:235] op_sel:[0,0,0] op_sel_hi:[0,1,1]
  v_pk_fma_f32 v[68:69], v[32:33], v[66:67], v[68:69] op_sel:[1,0,0] op_sel_hi:[1,1,1] neg_lo:[1,0,0] neg_hi:[1,0,0]
  v_pk_fma_f32 v[70:71], v[32:33], v[64:65], v[70:71] op_sel:[1,0,0] op_sel_hi:[1,1,1]
  v_pk_fma_f32 v[64:65], v[32:33], v[68:69], v[220:221] op_sel:[0,0,0] op_sel_hi:[0,1,1]
  v_pk_fma_f32 v[66:67], v[32:33], v[70:71], v[236:237] op_sel:[0,0,0] op_sel_hi:[0,1,1]
  v_pk_fma_f32 v[64:65], v[32:33], v[70:71], v[64:65] op_sel:[1,0,0] op_sel_hi:[1,1,1] neg_lo:[1,0,0] neg_hi:[1,0,0]
  v_pk_fma_f32 v[66:67], v[32:33], v[68:69], v[66:67] op_sel:[1,0,0] op_sel_hi:[1,1,1]
  v_pk_fma_f32 v[68:69], v[32:33], v[64:65], v[222:223] op_sel:[0,0,0] op_sel_hi:[0,1,1]
  v_pk_fma_f32 v[70:71], v[32:33], v[66:67], v[238:239] op_sel:[0,0,0] op_sel_hi:[0,1,1]
  v_pk_fma_f32 v[68:69], v[32:33], v[66:67], v[68:69] op_sel:[1,0,0] op_sel_hi:[1,1,1] neg_lo:[1,0,0] neg_hi:[1,0,0]
  v_pk_fma_f32 v[70:71], v[32:33], v[64:65], v[70:71] op_sel:[1,0,0] op_sel_hi:[1,1,1]
  v_mov_b32 v74, v68
  v_mov_b32 v75, v70
  v_mov_b32 v80, v69
  v_mov_b32 v81, v71
  v_fma_f32 v80, v34, v74, v80
  v_fma_f32 v81, v34, v75, v81
  v_fma_f32 v80, -v35, v75, v80
  v_fma_f32 v81, v35, v74, v81
  v_mov_b32 v82, v80
  v_mov_b32 v86, v80
  v_mov_b32 v83, v81
  v_mov_b32 v87, v81
  s_nop 0
  v_permlane32_swap_b32 v82, v86
  v_permlane32_swap_b32 v83, v87
  v_mov_b32 v84, v82
  v_mov_b32 v88, v86
  v_mov_b32 v85, v83
  v_mov_b32 v89, v87
  s_nop 0
  v_permlane16_swap_b32 v82, v84
  v_permlane16_swap_b32 v86, v88
  v_permlane16_swap_b32 v83, v85
  v_permlane16_swap_b32 v87, v89
  v_fma_f32 v84, v36, v82, v84
  v_fma_f32 v85, v36, v83, v85
  v_fma_f32 v84, -v37, v83, v84
  v_fma_f32 v85, v37, v82, v85
  v_fma_f32 v86, v36, v84, v86
  v_fma_f32 v87, v36, v85, v87
  v_fma_f32 v86, -v37, v85, v86
  v_fma_f32 v87, v37, v84, v87
  v_fma_f32 v96, v36, v86, v88
  v_fma_f32 v97, v36, v87, v89
  v_fma_f32 v96, -v37, v87, v96
  v_fma_f32 v97, v37, v86, v97
  v_mov_b32 v98, s76
  v_mov_b32 v99, s77
  s_mov_b64 exec, 0xffff
  buffer_store_dwordx4 v[96:99], v6, s[60:63], s37 offen sc1
  s_mov_b64 exec, -1
  v_cndmask_b32 v78, 0, v82, s[24:25]
  v_cndmask_b32 v79, 0, v83, s[24:25]
  v_cndmask_b32 v78, v78, v84, s[26:27]
  v_cndmask_b32 v79, v79, v85, s[26:27]
  v_cndmask_b32 v78, v78, v86, s[28:29]
  v_cndmask_b32 v79, v79, v87, s[28:29]
  v_mul_f32 v4, v18, v18
  v_fma_f32 v4, v19, v19, v4
  v_rcp_f32 v4, v4
  v_add_f32 v5, -1.0, v22
  v_add_f32 v4, v4, v4
  v_mul_f32 v38, v5, v18
  v_fma_f32 v38, v23, v19, v38
  v_mul_f32 v39, v23, v18
  v_fma_f32 v39, -v5, v19, v39
  v_mul_f32 v38, v38, v4
  v_mul_f32 v39, v39, v4
  v_lshlrev_b32 v3, 5, v17
  v_cvt_f32_u32 v3, v3
  v_mul_f32 v4, v3, v20
  v_mul_f32 v43, v3, v21
  v_exp_f32 v4, v4
  v_fract_f32 v43, v43
  v_cos_f32 v42, v43
  v_sin_f32 v43, v43
  v_mul_f32 v42, v42, v4
  v_mul_f32 v43, v43, v4
  v_mul_f32 v4, v28, v28
  v_fma_f32 v4, v29, v29, v4
  v_rcp_f32 v4, v4
  v_add_f32 v5, -1.0, v32
  v_add_f32 v4, v4, v4
  v_mul_f32 v40, v5, v28
  v_fma_f32 v40, v33, v29, v40
  v_mul_f32 v41, v33, v28
  v_fma_f32 v41, -v5, v29, v41
  v_mul_f32 v40, v40, v4
  v_mul_f32 v41, v41, v4
  v_lshlrev_b32 v3, 5, v17
  v_cvt_f32_u32 v3, v3
  v_mul_f32 v4, v3, v30
  v_mul_f32 v45, v3, v31
  v_exp_f32 v4, v4
  v_fract_f32 v45, v45
  v_cos_f32 v44, v45
  v_sin_f32 v45, v45
  v_mul_f32 v44, v44, v4
  v_mul_f32 v45, v45, v4
  s_sub_i32 s11, s4, 1
  v_sub_u32 v5, s11, v17
  v_max_i32 v3, 0, v5
  v_lshlrev_b32 v3, 7, v3
  v_cvt_f32_u32 v3, v3
  v_mul_f32 v4, v3, v20
  v_mul_f32 v81, v3, v21
  v_exp_f32 v4, v4
  v_fract_f32 v81, v81
  v_cos_f32 v80, v81
  v_sin_f32 v81, v81
  v_mul_f32 v80, v80, v4
  v_mul_f32 v81, v81, v4
  v_mul_f32 v4, v3, v30
  v_mul_f32 v47, v3, v31
  v_exp_f32 v4, v4
  v_fract_f32 v47, v47
  v_cos_f32 v46, v47
  v_sin_f32 v47, v47
  v_mul_f32 v46, v46, v4
  v_mul_f32 v47, v47, v4
  s_sub_i32 s11, s4, 5
  v_sub_u32 v5, s11, v17
  v_max_i32 v3, 0, v5
  v_lshlrev_b32 v3, 7, v3
  v_cvt_f32_u32 v3, v3
  v_mul_f32 v4, v3, v20
  v_mul_f32 v83, v3, v21
  v_exp_f32 v4, v4
  v_fract_f32 v83, v83
  v_cos_f32 v82, v83
  v_sin_f32 v83, v83
  v_mul_f32 v82, v82, v4
  v_mul_f32 v83, v83, v4
  v_mul_f32 v4, v3, v30
  v_mul_f32 v49, v3, v31
  v_exp_f32 v4, v4
  v_fract_f32 v49, v49
  v_cos_f32 v48, v49
  v_sin_f32 v49, v49
  v_mul_f32 v48, v48, v4
  v_mul_f32 v49, v49, v4
  s_sub_i32 s11, s4, 9
  v_sub_u32 v5, s11, v17
  v_max_i32 v3, 0, v5
  v_lshlrev_b32 v3, 7, v3
  v_cvt_f32_u32 v3, v3
  v_mul_f32 v4, v3, v20
  v_mul_f32 v85, v3, v21
  v_exp_f32 v4, v4
  v_fract_f32 v85, v85
  v_cos_f32 v84, v85
  v_sin_f32 v85, v85
  v_mul_f32 v84, v84, v4
  v_mul_f32 v85, v85, v4
  v_mul_f32 v4, v3, v30
  v_mul_f32 v51, v3, v31
  v_exp_f32 v4, v4
  v_fract_f32 v51, v51
  v_cos_f32 v50, v51
  v_sin_f32 v51, v51
  v_mul_f32 v50, v50, v4
  v_mul_f32 v51, v51, v4
  s_sub_i32 s11, s4, 13
  v_sub_u32 v5, s11, v17
  v_max_i32 v3, 0, v5
  v_lshlrev_b32 v3, 7, v3
  v_cvt_f32_u32 v3, v3
  v_mul_f32 v4, v3, v20
  v_mul_f32 v87, v3, v21
  v_exp_f32 v4, v4
  v_fract_f32 v87, v87
  v_cos_f32 v86, v87
  v_sin_f32 v87, v87
  v_mul_f32 v86, v86, v4
  v_mul_f32 v87, v87, v4
  v_mul_f32 v4, v3, v30
  v_mul_f32 v53, v3, v31
  v_exp_f32 v4, v4
  v_fract_f32 v53, v53
  v_cos_f32 v52, v53
  v_sin_f32 v53, v53
  v_mul_f32 v52, v52, v4
  v_mul_f32 v53, v53, v4
  v_lshl_add_u32 v7, v17, 10, v6
  s_mov_b32 s30, 4096
  s_mov_b32 s31, 8192
  s_mov_b32 s11, 12288
  v_lshlrev_b32 v8, 4, v1
  s_lshl_b32 s36, s4, 18
  s_lshl_b32 s37, s5, 15
  s_add_u32 s36, s36, s37
  s_lshl_b32 s37, s3, 12
  s_add_u32 s36, s36, s37
  s_add_u32 s36, s36, 0x600000
  buffer_load_dwordx4 v[96:99], v7, s[60:63], 0 offen sc1
  buffer_load_dwordx4 v[100:103], v7, s[60:63], s30 offen sc1
  buffer_load_dwordx4 v[104:107], v7, s[60:63], s31 offen sc1
  buffer_load_dwordx4 v[108:111], v7, s[60:63], s11 offen sc1
  v_pk_mul_f32 v[66:67], v[38:39], v[112:113] op_sel:[1,0] op_sel_hi:[1,1]
  v_pk_mul_f32 v[64:65], v[38:39], v[128:129] op_sel:[1,0] op_sel_hi:[1,1]
  v_pk_fma_f32 v[128:129], v[38:39], v[128:129], v[66:67] op_sel:[0,0,0] op_sel_hi:[0,1,1]
  v_pk_fma_f32 v[112:113], v[38:39], v[112:113], v[64:65] op_sel:[0,0,0] op_sel_hi:[0,1,1] neg_lo:[0,0,1] neg_hi:[0,0,1]
  v_pk_mul_f32 v[70:71], v[38:39], v[114:115] op_sel:[1,0] op_sel_hi:[1,1]
  v_pk_mul_f32 v[68:69], v[38:39], v[130:131] op_sel:[1,0] op_sel_hi:[1,1]
  v_pk_fma_f32 v[130:131], v[38:39], v[130:131], v[70:71] op_sel:[0,0,0] op_sel_hi:[0,1,1]
  v_pk_fma_f32 v[114:115], v[38:39], v[114:115], v[68:69] op_sel:[0,0,0] op_sel_hi:[0,1,1] neg_lo:[0,0,1] neg_hi:[0,0,1]
  v_pk_mul_f32 v[66:67], v[38:39], v[116:117] op_sel:[1,0] op_sel_hi:[1,1]
  v_pk_mul_f32 v[64:65], v[38:39], v[132:133] op_sel:[1,0] op_sel_hi:[1,1]
  v_pk_fma_f32 v[132:133], v[38:39], v[132:133], v[66:67] op_sel:[0,0,0] op_sel_hi:[0,1,1]
  v_pk_fma_f32 v[116:117], v[38:39], v[116:117], v[64:65] op_sel:[0,0,0] op_sel_hi:[0,1,1] neg_lo:[0,0,1] neg_hi:[0,0,1]
  v_pk_mul_f32 v[70:71], v[38:39], v[118:119] op_sel:[1,0] op_sel_hi:[1,1]
  v_pk_mul_f32 v[68:69], v[38:39], v[134:135] op_sel:[1,0] op_sel_hi:[1,1]
  v_pk_fma_f32 v[134:135], v[38:39], v[134:135], v[70:71] op_sel:[0,0,0] op_sel_hi:[0,1,1]
  v_pk_fma_f32 v[118:119], v[38:39], v[118:119], v[68:69] op_sel:[0,0,0] op_sel_hi:[0,1,1] neg_lo:[0,0,1] neg_hi:[0,0,1]
  v_pk_mul_f32 v[66:67], v[38:39], v[120:121] op_sel:[1,0] op_sel_hi:[1,1]
  v_pk_mul_f32 v[64:65], v[38:39], v[136:137] op_sel:[1,0] op_sel_hi:[1,1]
  v_pk_fma_f32 v[136:137], v[38:39], v[136:137], v[66:67] op_sel:[0,0,0] op_sel_hi:[0,1,1]
  v_pk_fma_f32 v[120:121], v[38:39], v[120:121], v[64:65] op_sel:[0,0,0] op_sel_hi:[0,1,1] neg_lo:[0,0,1] neg_hi:[0,0,1]
  v_pk_mul_f32 v[70:71], v[38:39], v[122:123] op_sel:[1,0] op_sel_hi:[1,1]
  v_pk_mul_f32 v[68:69], v[38:39], v[138:139] op_sel:[1,0] op_sel_hi:[1,1]
  v_pk_fma_f32 v[138:139], v[38:39], v[138:139], v[70:71] op_sel:[0,0,0] op_sel_hi:[0,1,1]
  v_pk_fma_f32 v[122:123], v[38:39], v[122:123], v[68:69] op_sel:[0,0,0] op_sel_hi:[0,1,1] neg_lo:[0,0,1] neg_hi:[0,0,1]
  v_pk_mul_f32 v[66:67], v[38:39], v[124:125] op_sel:[1,0] op_sel_hi:[1,1]
  v_pk_mul_f32 v[64:65], v[38:39], v[140:141] op_sel:[1,0] op_sel_hi:[1,1]
  v_pk_fma_f32 v[140:141], v[38:39], v[140:141], v[66:67] op_sel:[0,0,0] op_sel_hi:[0,1,1]
  v_pk_fma_f32 v[124:125], v[38:39], v[124:125], v[64:65] op_sel:[0,0,0] op_sel_hi:[0,1,1] neg_lo:[0,0,1] neg_hi:[0,0,1]
  v_pk_mul_f32 v[70:71], v[38:39], v[126:127] op_sel:[1,0] op_sel_hi:[1,1]
  v_pk_mul_f32 v[68:69], v[38:39], v[142:143] op_sel:[1,0] op_sel_hi:[1,1]
  v_pk_fma_f32 v[142:143], v[38:39], v[142:143], v[70:71] op_sel:[0,0,0] op_sel_hi:[0,1,1]
  v_pk_fma_f32 v[126:127], v[38:39], v[126:127], v[68:69] op_sel:[0,0,0] op_sel_hi:[0,1,1] neg_lo:[0,0,1] neg_hi:[0,0,1]
  v_pk_mul_f32 v[66:67], v[38:39], v[144:145] op_sel:[1,0] op_sel_hi:[1,1]
  v_pk_mul_f32 v[64:65], v[38:39], v[160:161] op_sel:[1,0] op_sel_hi:[1,1]
  v_pk_fma_f32 v[160:161], v[38:39], v[160:161], v[66:67] op_sel:[0,0,0] op_sel_hi:[0,1,1]
  v_pk_fma_f32 v[144:145], v[38:39], v[144:145], v[64:65] op_sel:[0,0,0] op_sel_hi:[0,1,1] neg_lo:[0,0,1] neg_hi:[0,0,1]
  v_pk_mul_f32 v[70:71], v[38:39], v[146:147] op_sel:[1,0] op_sel_hi:[1,1]
  v_pk_mul_f32 v[68:69], v[38:39], v[162:163] op_sel:[1,0] op_sel_hi:[1,1]
  v_pk_fma_f32 v[162:163], v[38:39], v[162:163], v[70:71] op_sel:[0,0,0] op_sel_hi:[0,1,1]
  v_pk_fma_f32 v[146:147], v[38:39], v[146:147], v[68:69] op_sel:[0,0,0] op_sel_hi:[0,1,1] neg_lo:[0,0,1] neg_hi:[0,0,1]
  v_pk_mul_f32 v[66:67], v[38:39], v[148:149] op_sel:[1,0] op_sel_hi:[1,1]
  v_pk_mul_f32 v[64:65], v[38:39], v[164:165] op_sel:[1,0] op_sel_hi:[1,1]
  v_pk_fma_f32 v[164:165], v[38:39], v[164:165], v[66:67] op_sel:[0,0,0] op_sel_hi:[0,1,1]
  v_pk_fma_f32 v[148:149], v[38:39], v[148:149], v[64:65] op_sel:[0,0,0] op_sel_hi:[0,1,1] neg_lo:[0,0,1] neg_hi:[0,0,1]
  v_pk_mul_f32 v[70:71], v[38:39], v[150:151] op_sel:[1,0] op_sel_hi:[1,1]
  v_pk_mul_f32 v[68:69], v[38:39], v[166:167] op_sel:[1,0] op_sel_hi:[1,1]
  v_pk_fma_f32 v[166:167], v[38:39], v[166:167], v[70:71] op_sel:[0,0,0] op_sel_hi:[0,1,1]
  v_pk_fma_f32 v[150:151], v[38:39], v[150:151], v[68:69] op_sel:[0,0,0] op_sel_hi:[0,1,1] neg_lo:[0,0,1] neg_hi:[0,0,1]
  v_pk_mul_f32 v[66:67], v[38:39], v[152:153] op_sel:[1,0] op_sel_hi:[1,1]
  v_pk_mul_f32 v[64:65], v[38:39], v[168:169] op_sel:[1,0] op_sel_hi:[1,1]
  v_pk_fma_f32 v[168:169], v[38:39], v[168:169], v[66:67] op_sel:[0,0,0] op_sel_hi:[0,1,1]
  v_pk_fma_f32 v[152:153], v[38:39], v[152:153], v[64:65] op_sel:[0,0,0] op_sel_hi:[0,1,1] neg_lo:[0,0,1] neg_hi:[0,0,1]
  v_pk_mul_f32 v[70:71], v[38:39], v[154:155] op_sel:[1,0] op_sel_hi:[1,1]
  v_pk_mul_f32 v[68:69], v[38:39], v[170:171] op_sel:[1,0] op_sel_hi:[1,1]
  v_pk_fma_f32 v[170:171], v[38:39], v[170:171], v[70:71] op_sel:[0,0,0] op_sel_hi:[0,1,1]
  v_pk_fma_f32 v[154:155], v[38:39], v[154:155], v[68:69] op_sel:[0,0,0] op_sel_hi:[0,1,1] neg_lo:[0,0,1] neg_hi:[0,0,1]
  v_pk_mul_f32 v[66:67], v[38:39], v[156:157] op_sel:[1,0] op_sel_hi:[1,1]
  v_pk_mul_f32 v[64:65], v[38:39], v[172:173] op_sel:[1,0] op_sel_hi:[1,1]
  v_pk_fma_f32 v[172:173], v[38:39], v[172:173], v[66:67] op_sel:[0,0,0] op_sel_hi:[0,1,1]
  v_pk_fma_f32 v[156:157], v[38:39], v[156:157], v[64:65] op_sel:[0,0,0] op_sel_hi:[0,1,1] neg_lo:[0,0,1] neg_hi:[0,0,1]
  v_pk_mul_f32 v[70:71], v[38:39], v[158:159] op_sel:[1,0] op_sel_hi:[1,1]
  v_pk_mul_f32 v[68:69], v[38:39], v[174:175] op_sel:[1,0] op_sel_hi:[1,1]
  v_pk_fma_f32 v[174:175], v[38:39], v[174:175], v[70:71] op_sel:[0,0,0] op_sel_hi:[0,1,1]
  v_pk_fma_f32 v[158:159], v[38:39], v[158:159], v[68:69] op_sel:[0,0,0] op_sel_hi:[0,1,1] neg_lo:[0,0,1] neg_hi:[0,0,1]
  s_mov_b32 s85, 0x40000
  s_branch pollchk_32
poll_30:
  buffer_load_dwordx4 v[96:99], v7, s[60:63], 0 offen sc1
  buffer_load_dwordx4 v[100:103], v7, s[60:63], s30 offen sc1
  buffer_load_dwordx4 v[104:107], v7, s[60:63], s31 offen sc1
  buffer_load_dwordx4 v[108:111], v7, s[60:63], s11 offen sc1
pollchk_32:
  s_mov_b64 s[14:15], -1
  s_waitcnt vmcnt(0)
  v_cmp_eq_u32 vcc, s76, v98
  v_cmp_eq_u32 s[12:13], s77, v99
  s_and_b64 vcc, vcc, s[12:13]
  s_or_b64 vcc, vcc, s[16:17]
  s_and_b64 s[14:15], s[14:15], vcc
  v_cmp_eq_u32 vcc, s76, v102
  v_cmp_eq_u32 s[12:13], s77, v103
  s_and_b64 vcc, vcc, s[12:13]
  s_or_b64 vcc, vcc, s[18:19]
  s_and_b64 s[14:15], s[14:15], vcc
  v_cmp_eq_u32 vcc, s76, v106
  v_cmp_eq_u32 s[12:13], s77, v107
  s_and_b64 vcc, vcc, s[12:13]
  s_or_b64 vcc, vcc, s[20:21]
  s_and_b64 s[14:15], s[14:15], vcc
  v_cmp_eq_u32 vcc, s76, v110
  v_cmp_eq_u32 s[12:13], s77, v111
  s_and_b64 vcc, vcc, s[12:13]
  s_or_b64 vcc, vcc, s[22:23]
  s_and_b64 s[14:15], s[14:15], vcc
  s_cmp_eq_u64 s[14:15], -1
  s_cbranch_scc1 polled_31
  s_sub_u32 s85, s85, 1
  s_cbranch_scc1 polled_31
  s_sleep 2
  s_branch poll_30
polled_31:
  v_cndmask_b32 v96, v96, 0, s[16:17]
  v_cndmask_b32 v97, v97, 0, s[16:17]
  v_cndmask_b32 v100, v100, 0, s[18:19]
  v_cndmask_b32 v101, v101, 0, s[18:19]
  v_cndmask_b32 v104, v104, 0, s[20:21]
  v_cndmask_b32 v105, v105, 0, s[20:21]
  v_cndmask_b32 v108, v108, 0, s[22:23]
  v_cndmask_b32 v109, v109, 0, s[22:23]
  v_mul_f32 v2, v80, v96
  v_mul_f32 v3, v80, v97
  v_fma_f32 v2, -v81, v97, v2
  v_fma_f32 v3, v81, v96, v3
  v_fma_f32 v2, v82, v100, v2
  v_fma_f32 v3, v82, v101, v3
  v_fma_f32 v2, -v83, v101, v2
  v_fma_f32 v3, v83, v100, v3
  v_fma_f32 v2, v84, v104, v2
  v_fma_f32 v3, v84, v105, v3
  v_fma_f32 v2, -v85, v105, v2
  v_fma_f32 v3, v85, v104, v3
  v_fma_f32 v2, v86, v108, v2
  v_fma_f32 v3, v86, v109, v3
  v_fma_f32 v2, -v87, v109, v2
  v_fma_f32 v3, v87, v108, v3
  v_add_u32 v7, 16384, v7
  buffer_load_dwordx4 v[96:99], v7, s[60:63], 0 offen sc1
  buffer_load_dwordx4 v[100:103], v7, s[60:63], s30 offen sc1
  buffer_load_dwordx4 v[104:107], v7, s[60:63], s31 offen sc1
  buffer_load_dwordx4 v[108:111], v7, s[60:63], s11 offen sc1
  v_mov_b64 v[4:5], v[2:3]
  s_nop 1
  v_permlane16_swap_b32 v2, v4
  v_permlane16_swap_b32 v3, v5
  v_pk_add_f32 v[2:3], v[2:3], v[4:5]
  v_mov_b64 v[4:5], v[2:3]
  s_nop 1
  v_permlane32_swap_b32 v2, v4
  v_permlane32_swap_b32 v3, v5
  v_pk_add_f32 v[2:3], v[2:3], v[4:5]
  v_fma_f32 v76, v42, v2, v76
  v_fma_f32 v77, v42, v3, v77
  v_fma_f32 v76, -v43, v3, v76
  v_fma_f32 v77, v43, v2, v77
  v_fma_f32 v72, v24, v76, v72
  v_fma_f32 v73, v24, v77, v73
  v_fma_f32 v72, -v25, v77, v72
  v_fma_f32 v73, v25, v76, v73
  v_mul_f32 v2, v38, v76
  v_mul_f32 v3, v38, v77
  v_fma_f32 v2, -v39, v77, v2
  v_fma_f32 v3, v39, v76, v3
  v_mul_f32 v4, v38, v72
  v_mul_f32 v5, v38, v73
  v_fma_f32 v4, -v39, v73, v4
  v_fma_f32 v5, v39, v72, v5
  v_mov_b32 v76, v2
  v_mov_b32 v77, v4
  v_mov_b32 v72, v3
  v_mov_b32 v73, v5
  v_pk_fma_f32 v[112:113], v[22:23], v[76:77], v[112:113] op_sel:[0,0,0] op_sel_hi:[0,1,1]
  v_pk_fma_f32 v[128:129], v[22:23], v[72:73], v[128:129] op_sel:[0,0,0] op_sel_hi:[0,1,1]
  v_pk_fma_f32 v[112:113], v[22:23], v[72:73], v[112:113] op_sel:[1,0,0] op_sel_hi:[1,1,1] neg_lo:[1,0,0] neg_hi:[1,0,0]
  v_pk_fma_f32 v[128:129], v[22:23], v[76:77], v[128:129] op_sel:[1,0,0] op_sel_hi:[1,1,1]
  v_pk_fma_f32 v[114:115], v[22:23], v[112:113], v[114:115] op_sel:[0,0,0] op_sel_hi:[0,1,1]
  v_pk_fma_f32 v[130:131], v[22:23], v[128:129], v[130:131] op_sel:[0,0,0] op_sel_hi:[0,1,1]
  v_pk_fma_f32 v[114:115], v[22:23], v[128:129], v[114:115] op_sel:[1,0,0] op_sel_hi:[1,1,1] neg_lo:[1,0,0] neg_hi:[1,0,0]
  v_pk_fma_f32 v[130:131], v[22:23], v[112:113], v[130:131] op_sel:[1,0,0] op_sel_hi:[1,1,1]
  v_pk_fma_f32 v[116:117], v[22:23], v[114:115], v[116:117] op_sel:[0,0,0] op_sel_hi:[0,1,1]
  v_pk_fma_f32 v[132:133], v[22:23], v[130:131], v[132:133] op_sel:[0,0,0] op_sel_hi:[0,1,1]
  v_pk_fma_f32 v[116:117], v[22:23], v[130:131], v[116:117] op_sel:[1,0,0] op_sel_hi:[1,1,1] neg_lo:[1,0,0] neg_hi:[1,0,0]
  v_pk_fma_f32 v[132:133], v[22:23], v[114:115], v[132:133] op_sel:[1,0,0] op_sel_hi:[1,1,1]
  v_pk_fma_f32 v[118:119], v[22:23], v[116:117], v[118:119] op_sel:[0,0,0] op_sel_hi:[0,1,1]
  v_pk_fma_f32 v[134:135], v[22:23], v[132:133], v[134:135] op_sel:[0,0,0] op_sel_hi:[0,1,1]
  v_pk_fma_f32 v[118:119], v[22:23], v[132:133], v[118:119] op_sel:[1,0,0] op_sel_hi:[1,1,1] neg_lo:[1,0,0] neg_hi:[1,0,0]
  v_pk_fma_f32 v[134:135], v[22:23], v[116:117], v[134:135] op_sel:[1,0,0] op_sel_hi:[1,1,1]
  v_pk_fma_f32 v[120:121], v[22:23], v[118:119], v[120:121] op_sel:[0,0,0] op_sel_hi:[0,1,1]
  v_pk_fma_f32 v[136:137], v[22:23], v[134:135], v[136:137] op_sel:[0,0,0] op_sel_hi:[0,1,1]
  v_pk_fma_f32 v[120:121], v[22:23], v[134:135], v[120:121] op_sel:[1,0,0] op_sel_hi:[1,1,1] neg_lo:[1,0,0] neg_hi:[1,0,0]
  v_pk_fma_f32 v[136:137], v[22:23], v[118:119], v[136:137] op_sel:[1,0,0] op_sel_hi:[1,1,1]
  v_pk_fma_f32 v[122:123], v[22:23], v[120:121], v[122:123] op_sel:[0,0,0] op_sel_hi:[0,1,1]
  v_pk_fma_f32 v[138:139], v[22:23], v[136:137], v[138:139] op_sel:[0,0,0] op_sel_hi:[0,1,1]
  v_pk_fma_f32 v[122:123], v[22:23], v[136:137], v[122:123] op_sel:[1,0,0] op_sel_hi:[1,1,1] neg_lo:[1,0,0] neg_hi:[1,0,0]
  v_pk_fma_f32 v[138:139], v[22:23], v[120:121], v[138:139] op_sel:[1,0,0] op_sel_hi:[1,1,1]
  v_pk_fma_f32 v[124:125], v[22:23], v[122:123], v[124:125] op_sel:[0,0,0] op_sel_hi:[0,1,1]
  v_pk_fma_f32 v[140:141], v[22:23], v[138:139], v[140:141] op_sel:[0,0,0] op_sel_hi:[0,1,1]
  v_pk_fma_f32 v[124:125], v[22:23], v[138:139], v[124:125] op_sel:[1,0,0] op_sel_hi:[1,1,1] neg_lo:[1,0,0] neg_hi:[1,0,0]
  v_pk_fma_f32 v[140:141], v[22:23], v[122:123], v[140:141] op_sel:[1,0,0] op_sel_hi:[1,1,1]
  v_pk_fma_f32 v[126:127], v[22:23], v[124:125], v[126:127] op_sel:[0,0,0] op_sel_hi:[0,1,1]
  v_pk_fma_f32 v[142:143], v[22:23], v[140:141], v[142:143] op_sel:[0,0,0] op_sel_hi:[0,1,1]
  v_pk_fma_f32 v[126:127], v[22:23], v[140:141], v[126:127] op_sel:[1,0,0] op_sel_hi:[1,1,1] neg_lo:[1,0,0] neg_hi:[1,0,0]
  v_pk_fma_f32 v[142:143], v[22:23], v[124:125], v[142:143] op_sel:[1,0,0] op_sel_hi:[1,1,1]
  v_pk_fma_f32 v[144:145], v[22:23], v[126:127], v[144:145] op_sel:[0,0,0] op_sel_hi:[0,1,1]
  v_pk_fma_f32 v[160:161], v[22:23], v[142:143], v[160:161] op_sel:[0,0,0] op_sel_hi:[0,1,1]
  v_pk_fma_f32 v[144:145], v[22:23], v[142:143], v[144:145] op_sel:[1,0,0] op_sel_hi:[1,1,1] neg_lo:[1,0,0] neg_hi:[1,0,0]
  v_pk_fma_f32 v[160:161], v[22:23], v[126:127], v[160:161] op_sel:[1,0,0] op_sel_hi:[1,1,1]
  v_pk_fma_f32 v[146:147], v[22:23], v[144:145], v[146:147] op_sel:[0,0,0] op_sel_hi:[0,1,1]
  v_pk_fma_f32 v[162:163], v[22:23], v[160:161], v[162:163] op_sel:[0,0,0] op_sel_hi:[0,1,1]
  v_pk_fma_f32 v[146:147], v[22:23], v[160:161], v[146:147] op_sel:[1,0,0] op_sel_hi:[1,1,1] neg_lo:[1,0,0] neg_hi:[1,0,0]
  v_pk_fma_f32 v[162:163], v[22:23], v[144:145], v[162:163] op_sel:[1,0,0] op_sel_hi:[1,1,1]
  v_pk_fma_f32 v[148:149], v[22:23], v[146:147], v[148:149] op_sel:[0,0,0] op_sel_hi:[0,1,1]
  v_pk_fma_f32 v[164:165], v[22:23], v[162:163], v[164:165] op_sel:[0,0,0] op_sel_hi:[0,1,1]
  v_pk_fma_f32 v[148:149], v[22:23], v[162:163], v[148:149] op_sel:[1,0,0] op_sel_hi:[1,1,1] neg_lo:[1,0,0] neg_hi:[1,0,0]
  v_pk_fma_f32 v[164:165], v[22:23], v[146:147], v[164:165] op_sel:[1,0,0] op_sel_hi:[1,1,1]
  v_pk_fma_f32 v[150:151], v[22:23], v[148:149], v[150:151] op_sel:[0,0,0] op_sel_hi:[0,1,1]
  v_pk_fma_f32 v[166:167], v[22:23], v[164:165], v[166:167] op_sel:[0,0,0] op_sel_hi:[0,1,1]
  v_pk_fma_f32 v[150:151], v[22:23], v[164:165], v[150:151] op_sel:[1,0,0] op_sel_hi:[1,1,1] neg_lo:[1,0,0] neg_hi:[1,0,0]
  v_pk_fma_f32 v[166:167], v[22:23], v[148:149], v[166:167] op_sel:[1,0,0] op_sel_hi:[1,1,1]
  v_pk_fma_f32 v[152:153], v[22:23], v[150:151], v[152:153] op_sel:[0,0,0] op_sel_hi:[0,1,1]
  v_pk_fma_f32 v[168:169], v[22:23], v[166:167], v[168:169] op_sel:[0,0,0] op_sel_hi:[0,1,1]
  v_pk_fma_f32 v[152:153], v[22:23], v[166:167], v[152:153] op_sel:[1,0,0] op_sel_hi:[1,1,1] neg_lo:[1,0,0] neg_hi:[1,0,0]
  v_pk_fma_f32 v[168:169], v[22:23], v[150:151], v[168:169] op_sel:[1,0,0] op_sel_hi:[1,1,1]
  v_pk_fma_f32 v[154:155], v[22:23], v[152:153], v[154:155] op_sel:[0,0,0] op_sel_hi:[0,1,1]
  v_pk_fma_f32 v[170:171], v[22:23], v[168:169], v[170:171] op_sel:[0,0,0] op_sel_hi:[0,1,1]
  v_pk_fma_f32 v[154:155], v[22:23], v[168:169], v[154:155] op_sel:[1,0,0] op_sel_hi:[1,1,1] neg_lo:[1,0,0] neg_hi:[1,0,0]
  v_pk_fma_f32 v[170:171], v[22:23], v[152:153], v[170:171] op_sel:[1,0,0] op_sel_hi:[1,1,1]
  v_pk_fma_f32 v[156:157], v[22:23], v[154:155], v[156:157] op_sel:[0,0,0] op_sel_hi:[0,1,1]
  v_pk_fma_f32 v[172:173], v[22:23], v[170:171], v[172:173] op_sel:[0,0,0] op_sel_hi:[0,1,1]
  v_pk_fma_f32 v[156:157], v[22:23], v[170:171], v[156:157] op_sel:[1,0,0] op_sel_hi:[1,1,1] neg_lo:[1,0,0] neg_hi:[1,0,0]
  v_pk_fma_f32 v[172:173], v[22:23], v[154:155], v[172:173] op_sel:[1,0,0] op_sel_hi:[1,1,1]
  v_pk_fma_f32 v[158:159], v[22:23], v[156:157], v[158:159] op_sel:[0,0,0] op_sel_hi:[0,1,1]
  v_pk_fma_f32 v[174:175], v[22:23], v[172:173], v[174:175] op_sel:[0,0,0] op_sel_hi:[0,1,1]
  v_pk_fma_f32 v[158:159], v[22:23], v[172:173], v[158:159] op_sel:[1,0,0] op_sel_hi:[1,1,1] neg_lo:[1,0,0] neg_hi:[1,0,0]
  v_pk_fma_f32 v[174:175], v[22:23], v[156:157], v[174:175] op_sel:[1,0,0] op_sel_hi:[1,1,1]
  s_mov_b32 s85, 0x40000
  s_branch pollchk_35
poll_33:
  buffer_load_dwordx4 v[96:99], v7, s[60:63], 0 offen sc1
  buffer_load_dwordx4 v[100:103], v7, s[60:63], s30 offen sc1
  buffer_load_dwordx4 v[104:107], v7, s[60:63], s31 offen sc1
  buffer_load_dwordx4 v[108:111], v7, s[60:63], s11 offen sc1
pollchk_35:
  s_mov_b64 s[14:15], -1
  s_waitcnt vmcnt(0)
  v_cmp_eq_u32 vcc, s76, v98
  v_cmp_eq_u32 s[12:13], s77, v99
  s_and_b64 vcc, vcc, s[12:13]
  s_or_b64 vcc, vcc, s[16:17]
  s_and_b64 s[14:15], s[14:15], vcc
  v_cmp_eq_u32 vcc, s76, v102
  v_cmp_eq_u32 s[12:13], s77, v103
  s_and_b64 vcc, vcc, s[12:13]
  s_or_b64 vcc, vcc, s[18:19]
  s_and_b64 s[14:15], s[14:15], vcc
  v_cmp_eq_u32 vcc, s76, v106
  v_cmp_eq_u32 s[12:13], s77, v107
  s_and_b64 vcc, vcc, s[12:13]
  s_or_b64 vcc, vcc, s[20:21]
  s_and_b64 s[14:15], s[14:15], vcc
  v_cmp_eq_u32 vcc, s76, v110
  v_cmp_eq_u32 s[12:13], s77, v111
  s_and_b64 vcc, vcc, s[12:13]
  s_or_b64 vcc, vcc, s[22:23]
  s_and_b64 s[14:15], s[14:15], vcc
  s_cmp_eq_u64 s[14:15], -1
  s_cbranch_scc1 polled_34
  s_sub_u32 s85, s85, 1
  s_cbranch_scc1 polled_34
  s_sleep 2
  s_branch poll_33
polled_34:
  s_add_u32 s38, s36, 0
  s_add_u32 s39, s38, 131072
  v_cvt_pk_bf16_f32 v88, v112, v114
  v_cvt_pk_bf16_f32 v89, v116, v118
  v_cvt_pk_bf16_f32 v90, v120, v122
  v_cvt_pk_bf16_f32 v91, v124, v126
  v_xor_b32 v2, 0, v8
  buffer_store_dwordx4 v[88:91], v2, s[60:63], s38 offen offset:0 sc1
  v_cvt_pk_bf16_f32 v92, v113, v115
  v_cvt_pk_bf16_f32 v93, v117, v119
  v_cvt_pk_bf16_f32 v94, v121, v123
  v_cvt_pk_bf16_f32 v95, v125, v127
  v_xor_b32 v3, 128, v8
  buffer_store_dwordx4 v[92:95], v3, s[60:63], s38 offen offset:2048 sc1
  v_cvt_pk_bf16_f32 v64, v144, v146
  v_cvt_pk_bf16_f32 v65, v148, v150
  v_cvt_pk_bf16_f32 v66, v152, v154
  v_cvt_pk_bf16_f32 v67, v156, v158
  v_xor_b32 v2, 64, v8
  buffer_store_dwordx4 v[64:67], v2, s[60:63], s38 offen offset:1024 sc1
  v_cvt_pk_bf16_f32 v68, v145, v147
  v_cvt_pk_bf16_f32 v69, v149, v151
  v_cvt_pk_bf16_f32 v70, v153, v155
  v_cvt_pk_bf16_f32 v71, v157, v159
  v_xor_b32 v3, 192, v8
  buffer_store_dwordx4 v[68:71], v3, s[60:63], s38 offen offset:3072 sc1
  v_cvt_pk_bf16_f32 v88, -v128, -v130
  v_cvt_pk_bf16_f32 v89, -v132, -v134
  v_cvt_pk_bf16_f32 v90, -v136, -v138
  v_cvt_pk_bf16_f32 v91, -v140, -v142
  v_xor_b32 v2, 0, v8
  buffer_store_dwordx4 v[88:91], v2, s[60:63], s39 offen offset:0 sc1
  v_cvt_pk_bf16_f32 v92, -v129, -v131
  v_cvt_pk_bf16_f32 v93, -v133, -v135
  v_cvt_pk_bf16_f32 v94, -v137, -v139
  v_cvt_pk_bf16_f32 v95, -v141, -v143
  v_xor_b32 v3, 128, v8
  buffer_store_dwordx4 v[92:95], v3, s[60:63], s39 offen offset:2048 sc1
  v_cvt_pk_bf16_f32 v64, -v160, -v162
  v_cvt_pk_bf16_f32 v65, -v164, -v166
  v_cvt_pk_bf16_f32 v66, -v168, -v170
  v_cvt_pk_bf16_f32 v67, -v172, -v174
  v_xor_b32 v2, 64, v8
  buffer_store_dwordx4 v[64:67], v2, s[60:63], s39 offen offset:1024 sc1
  v_cvt_pk_bf16_f32 v68, -v161, -v163
  v_cvt_pk_bf16_f32 v69, -v165, -v167
  v_cvt_pk_bf16_f32 v70, -v169, -v171
  v_cvt_pk_bf16_f32 v71, -v173, -v175
  v_xor_b32 v3, 192, v8
  buffer_store_dwordx4 v[68:71], v3, s[60:63], s39 offen offset:3072 sc1
  s_nop 1
  v_pk_mul_f32 v[66:67], v[40:41], v[176:177] op_sel:[1,0] op_sel_hi:[1,1]
  v_pk_mul_f32 v[64:65], v[40:41], v[192:193] op_sel:[1,0] op_sel_hi:[1,1]
  v_pk_fma_f32 v[192:193], v[40:41], v[192:193], v[66:67] op_sel:[0,0,0] op_sel_hi:[0,1,1]
  v_pk_fma_f32 v[176:177], v[40:41], v[176:177], v[64:65] op_sel:[0,0,0] op_sel_hi:[0,1,1] neg_lo:[0,0,1] neg_hi:[0,0,1]
  v_pk_mul_f32 v[70:71], v[40:41], v[178:179] op_sel:[1,0] op_sel_hi:[1,1]
  v_pk_mul_f32 v[68:69], v[40:41], v[194:195] op_sel:[1,0] op_sel_hi:[1,1]
  v_pk_fma_f32 v[194:195], v[40:41], v[194:195], v[70:71] op_sel:[0,0,0] op_sel_hi:[0,1,1]
  v_pk_fma_f32 v[178:179], v[40:41], v[178:179], v[68:69] op_sel:[0,0,0] op_sel_hi:[0,1,1] neg_lo:[0,0,1] neg_hi:[0,0,1]
  v_pk_mul_f32 v[66:67], v[40:41], v[180:181] op_sel:[1,0] op_sel_hi:[1,1]
  v_pk_mul_f32 v[64:65], v[40:41], v[196:197] op_sel:[1,0] op_sel_hi:[1,1]
  v_pk_fma_f32 v[196:197], v[40:41], v[196:197], v[66:67] op_sel:[0,0,0] op_sel_hi:[0,1,1]
  v_pk_fma_f32 v[180:181], v[40:41], v[180:181], v[64:65] op_sel:[0,0,0] op_sel_hi:[0,1,1] neg_lo:[0,0,1] neg_hi:[0,0,1]
  v_pk_mul_f32 v[70:71], v[40:41], v[182:183] op_sel:[1,0] op_sel_hi:[1,1]
  v_pk_mul_f32 v[68:69], v[40:41], v[198:199] op_sel:[1,0] op_sel_hi:[1,1]
  v_pk_fma_f32 v[198:199], v[40:41], v[198:199], v[70:71] op_sel:[0,0,0] op_sel_hi:[0,1,1]
  v_pk_fma_f32 v[182:183], v[40:41], v[182:183], v[68:69] op_sel:[0,0,0] op_sel_hi:[0,1,1] neg_lo:[0,0,1] neg_hi:[0,0,1]
  v_pk_mul_f32 v[66:67], v[40:41], v[184:185] op_sel:[1,0] op_sel_hi:[1,1]
  v_pk_mul_f32 v[64:65], v[40:41], v[200:201] op_sel:[1,0] op_sel_hi:[1,1]
  v_pk_fma_f32 v[200:201], v[40:41], v[200:201], v[66:67] op_sel:[0,0,0] op_sel_hi:[0,1,1]
  v_pk_fma_f32 v[184:185], v[40:41], v[184:185], v[64:65] op_sel:[0,0,0] op_sel_hi:[0,1,1] neg_lo:[0,0,1] neg_hi:[0,0,1]
  v_pk_mul_f32 v[70:71], v[40:41], v[186:187] op_sel:[1,0] op_sel_hi:[1,1]
  v_pk_mul_f32 v[68:69], v[40:41], v[202:203] op_sel:[1,0] op_sel_hi:[1,1]
  v_pk_fma_f32 v[202:203], v[40:41], v[202:203], v[70:71] op_sel:[0,0,0] op_sel_hi:[0,1,1]
  v_pk_fma_f32 v[186:187], v[40:41], v[186:187], v[68:69] op_sel:[0,0,0] op_sel_hi:[0,1,1] neg_lo:[0,0,1] neg_hi:[0,0,1]
  v_pk_mul_f32 v[66:67], v[40:41], v[188:189] op_sel:[1,0] op_sel_hi:[1,1]
  v_pk_mul_f32 v[64:65], v[40:41], v[204:205] op_sel:[1,0] op_sel_hi:[1,1]
  v_pk_fma_f32 v[204:205], v[40:41], v[204:205], v[66:67] op_sel:[0,0,0] op_sel_hi:[0,1,1]
  v_pk_fma_f32 v[188:189], v[40:41], v[188:189], v[64:65] op_sel:[0,0,0] op_sel_hi:[0,1,1] neg_lo:[0,0,1] neg_hi:[0,0,1]
  v_pk_mul_f32 v[70:71], v[40:41], v[190:191] op_sel:[1,0] op_sel_hi:[1,1]
  v_pk_mul_f32 v[68:69], v[40:41], v[206:207] op_sel:[1,0] op_sel_hi:[1,1]
  v_pk_fma_f32 v[206:207], v[40:41], v[206:207], v[70:71] op_sel:[0,0,0] op_sel_hi:[0,1,1]
  v_pk_fma_f32 v[190:191], v[40:41], v[190:191], v[68:69] op_sel:[0,0,0] op_sel_hi:[0,1,1] neg_lo:[0,0,1] neg_hi:[0,0,1]
  v_pk_mul_f32 v[66:67], v[40:41], v[208:209] op_sel:[1,0] op_sel_hi:[1,1]
  v_pk_mul_f32 v[64:65], v[40:41], v[224:225] op_sel:[1,0] op_sel_hi:[1,1]
  v_pk_fma_f32 v[224:225], v[40:41], v[224:225], v[66:67] op_sel:[0,0,0] op_sel_hi:[0,1,1]
  v_pk_fma_f32 v[208:209], v[40:41], v[208:209], v[64:65] op_sel:[0,0,0] op_sel_hi:[0,1,1] neg_lo:[0,0,1] neg_hi:[0,0,1]
  v_pk_mul_f32 v[70:71], v[40:41], v[210:211] op_sel:[1,0] op_sel_hi:[1,1]
  v_pk_mul_f32 v[68:69], v[40:41], v[226:227] op_sel:[1,0] op_sel_hi:[1,1]
  v_pk_fma_f32 v[226:227], v[40:41], v[226:227], v[70:71] op_sel:[0,0,0] op_sel_hi:[0,1,1]
  v_pk_fma_f32 v[210:211], v[40:41], v[210:211], v[68:69] op_sel:[0,0,0] op_sel_hi:[0,1,1] neg_lo:[0,0,1] neg_hi:[0,0,1]
  v_pk_mul_f32 v[66:67], v[40:41], v[212:213] op_sel:[1,0] op_sel_hi:[1,1]
  v_pk_mul_f32 v[64:65], v[40:41], v[228:229] op_sel:[1,0] op_sel_hi:[1,1]
  v_pk_fma_f32 v[228:229], v[40:41], v[228:229], v[66:67] op_sel:[0,0,0] op_sel_hi:[0,1,1]
  v_pk_fma_f32 v[212:213], v[40:41], v[212:213], v[64:65] op_sel:[0,0,0] op_sel_hi:[0,1,1] neg_lo:[0,0,1] neg_hi:[0,0,1]
  v_pk_mul_f32 v[70:71], v[40:41], v[214:215] op_sel:[1,0] op_sel_hi:[1,1]
  v_pk_mul_f32 v[68:69], v[40:41], v[230:231] op_sel:[1,0] op_sel_hi:[1,1]
  v_pk_fma_f32 v[230:231], v[40:41], v[230:231], v[70:71] op_sel:[0,0,0] op_sel_hi:[0,1,1]
  v_pk_fma_f32 v[214:215], v[40:41], v[214:215], v[68:69] op_sel:[0,0,0] op_sel_hi:[0,1,1] neg_lo:[0,0,1] neg_hi:[0,0,1]
  v_pk_mul_f32 v[66:67], v[40:41], v[216:217] op_sel:[1,0] op_sel_hi:[1,1]
  v_pk_mul_f32 v[64:65], v[40:41], v[232:233] op_sel:[1,0] op_sel_hi:[1,1]
  v_pk_fma_f32 v[232:233], v[40:41], v[232:233], v[66:67] op_sel:[0,0,0] op_sel_hi:[0,1,1]
  v_pk_fma_f32 v[216:217], v[40:41], v[216:217], v[64:65] op_sel:[0,0,0] op_sel_hi:[0,1,1] neg_lo:[0,0,1] neg_hi:[0,0,1]
  v_pk_mul_f32 v[70:71], v[40:41], v[218:219] op_sel:[1,0] op_sel_hi:[1,1]
  v_pk_mul_f32 v[68:69], v[40:41], v[234:235] op_sel:[1,0] op_sel_hi:[1,1]
  v_pk_fma_f32 v[234:235], v[40:41], v[234:235], v[70:71] op_sel:[0,0,0] op_sel_hi:[0,1,1]
  v_pk_fma_f32 v[218:219], v[40:41], v[218:219], v[68:69] op_sel:[0,0,0] op_sel_hi:[0,1,1] neg_lo:[0,0,1] neg_hi:[0,0,1]
  v_pk_mul_f32 v[66:67], v[40:41], v[220:221] op_sel:[1,0] op_sel_hi:[1,1]
  v_pk_mul_f32 v[64:65], v[40:41], v[236:237] op_sel:[1,0] op_sel_hi:[1,1]
  v_pk_fma_f32 v[236:237], v[40:41], v[236:237], v[66:67] op_sel:[0,0,0] op_sel_hi:[0,1,1]
  v_pk_fma_f32 v[220:221], v[40:41], v[220:221], v[64:65] op_sel:[0,0,0] op_sel_hi:[0,1,1] neg_lo:[0,0,1] neg_hi:[0,0,1]
  v_pk_mul_f32 v[70:71], v[40:41], v[222:223] op_sel:[1,0] op_sel_hi:[1,1]
  v_pk_mul_f32 v[68:69], v[40:41], v[238:239] op_sel:[1,0] op_sel_hi:[1,1]
  v_pk_fma_f32 v[238:239], v[40:41], v[238:239], v[70:71] op_sel:[0,0,0] op_sel_hi:[0,1,1]
  v_pk_fma_f32 v[222:223], v[40:41], v[222:223], v[68:69] op_sel:[0,0,0] op_sel_hi:[0,1,1] neg_lo:[0,0,1] neg_hi:[0,0,1]
  v_cndmask_b32 v96, v96, 0, s[16:17]
  v_cndmask_b32 v97, v97, 0, s[16:17]
  v_cndmask_b32 v100, v100, 0, s[18:19]
  v_cndmask_b32 v101, v101, 0, s[18:19]
  v_cndmask_b32 v104, v104, 0, s[20:21]
  v_cndmask_b32 v105, v105, 0, s[20:21]
  v_cndmask_b32 v108, v108, 0, s[22:23]
  v_cndmask_b32 v109, v109, 0, s[22:23]
  v_mul_f32 v2, v46, v96
  v_mul_f32 v3, v46, v97
  v_fma_f32 v2, -v47, v97, v2
  v_fma_f32 v3, v47, v96, v3
  v_fma_f32 v2, v48, v100, v2
  v_fma_f32 v3, v48, v101, v3
  v_fma_f32 v2, -v49, v101, v2
  v_fma_f32 v3, v49, v100, v3
  v_fma_f32 v2, v50, v104, v2
  v_fma_f32 v3, v50, v105, v3
  v_fma_f32 v2, -v51, v105, v2
  v_fma_f32 v3, v51, v104, v3
  v_fma_f32 v2, v52, v108, v2
  v_fma_f32 v3, v52, v109, v3
  v_fma_f32 v2, -v53, v109, v2
  v_fma_f32 v3, v53, v108, v3
  v_mov_b64 v[4:5], v[2:3]
  s_nop 1
  v_permlane16_swap_b32 v2, v4
  v_permlane16_swap_b32 v3, v5
  v_pk_add_f32 v[2:3], v[2:3], v[4:5]
  v_mov_b64 v[4:5], v[2:3]
  s_nop 1
  v_permlane32_swap_b32 v2, v4
  v_permlane32_swap_b32 v3, v5
  v_pk_add_f32 v[2:3], v[2:3], v[4:5]
  v_fma_f32 v78, v44, v2, v78
  v_fma_f32 v79, v44, v3, v79
  v_fma_f32 v78, -v45, v3, v78
  v_fma_f32 v79, v45, v2, v79
  v_fma_f32 v74, v34, v78, v74
  v_fma_f32 v75, v34, v79, v75
  v_fma_f32 v74, -v35, v79, v74
  v_fma_f32 v75, v35, v78, v75
  v_mul_f32 v2, v40, v78
  v_mul_f32 v3, v40, v79
  v_fma_f32 v2, -v41, v79, v2
  v_fma_f32 v3, v41, v78, v3
  v_mul_f32 v4, v40, v74
  v_mul_f32 v5, v40, v75
  v_fma_f32 v4, -v41, v75, v4
  v_fma_f32 v5, v41, v74, v5
  v_mov_b32 v78, v2
  v_mov_b32 v79, v4
  v_mov_b32 v74, v3
  v_mov_b32 v75, v5
  v_pk_fma_f32 v[176:177], v[32:33], v[78:79], v[176:177] op_sel:[0,0,0] op_sel_hi:[0,1,1]
  v_pk_fma_f32 v[192:193], v[32:33], v[74:75], v[192:193] op_sel:[0,0,0] op_sel_hi:[0,1,1]
  v_pk_fma_f32 v[176:177], v[32:33], v[74:75], v[176:177] op_sel:[1,0,0] op_sel_hi:[1,1,1] neg_lo:[1,0,0] neg_hi:[1,0,0]
  v_pk_fma_f32 v[192:193], v[32:33], v[78:79], v[192:193] op_sel:[1,0,0] op_sel_hi:[1,1,1]
  v_pk_fma_f32 v[178:179], v[32:33], v[176:177], v[178:179] op_sel:[0,0,0] op_sel_hi:[0,1,1]
  v_pk_fma_f32 v[194:195], v[32:33], v[192:193], v[194:195] op_sel:[0,0,0] op_sel_hi:[0,1,1]
  v_pk_fma_f32 v[178:179], v[32:33], v[192:193], v[178:179] op_sel:[1,0,0] op_sel_hi:[1,1,1] neg_lo:[1,0,0] neg_hi:[1,0,0]
  v_pk_fma_f32 v[194:195], v[32:33], v[176:177], v[194:195] op_sel:[1,0,0] op_sel_hi:[1,1,1]
  v_pk_fma_f32 v[180:181], v[32:33], v[178:179], v[180:181] op_sel:[0,0,0] op_sel_hi:[0,1,1]
  v_pk_fma_f32 v[196:197], v[32:33], v[194:195], v[196:197] op_sel:[0,0,0] op_sel_hi:[0,1,1]
  v_pk_fma_f32 v[180:181], v[32:33], v[194:195], v[180:181] op_sel:[1,0,0] op_sel_hi:[1,1,1] neg_lo:[1,0,0] neg_hi:[1,0,0]
  v_pk_fma_f32 v[196:197], v[32:33], v[178:179], v[196:197] op_sel:[1,0,0] op_sel_hi:[1,1,1]
  v_pk_fma_f32 v[182:183], v[32:33], v[180:181], v[182:183] op_sel:[0,0,0] op_sel_hi:[0,1,1]
  v_pk_fma_f32 v[198:199], v[32:33], v[196:197], v[198:199] op_sel:[0,0,0] op_sel_hi:[0,1,1]
  v_pk_fma_f32 v[182:183], v[32:33], v[196:197], v[182:183] op_sel:[1,0,0] op_sel_hi:[1,1,1] neg_lo:[1,0,0] neg_hi:[1,0,0]
  v_pk_fma_f32 v[198:199], v[32:33], v[180:181], v[198:199] op_sel:[1,0,0] op_sel_hi:[1,1,1]
  v_pk_fma_f32 v[184:185], v[32:33], v[182:183], v[184:185] op_sel:[0,0,0] op_sel_hi:[0,1,1]
  v_pk_fma_f32 v[200:201], v[32:33], v[198:199], v[200:201] op_sel:[0,0,0] op_sel_hi:[0,1,1]
  v_pk_fma_f32 v[184:185], v[32:33], v[198:199], v[184:185] op_sel:[1,0,0] op_sel_hi:[1,1,1] neg_lo:[1,0,0] neg_hi:[1,0,0]
  v_pk_fma_f32 v[200:201], v[32:33], v[182:183], v[200:201] op_sel:[1,0,0] op_sel_hi:[1,1,1]
  v_pk_fma_f32 v[186:187], v[32:33], v[184:185], v[186:187] op_sel:[0,0,0] op_sel_hi:[0,1,1]
  v_pk_fma_f32 v[202:203], v[32:33], v[200:201], v[202:203] op_sel:[0,0,0] op_sel_hi:[0,1,1]
  v_pk_fma_f32 v[186:187], v[32:33], v[200:201], v[186:187] op_sel:[1,0,0] op_sel_hi:[1,1,1] neg_lo:[1,0,0] neg_hi:[1,0,0]
  v_pk_fma_f32 v[202:203], v[32:33], v[184:185], v[202:203] op_sel:[1,0,0] op_sel_hi:[1,1,1]
  v_pk_fma_f32 v[188:189], v[32:33], v[186:187], v[188:189] op_sel:[0,0,0] op_sel_hi:[0,1,1]
  v_pk_fma_f32 v[204:205], v[32:33], v[202:203], v[204:205] op_sel:[0,0,0] op_sel_hi:[0,1,1]
  v_pk_fma_f32 v[188:189], v[32:33], v[202:203], v[188:189] op_sel:[1,0,0] op_sel_hi:[1,1,1] neg_lo:[1,0,0] neg_hi:[1,0,0]
  v_pk_fma_f32 v[204:205], v[32:33], v[186:187], v[204:205] op_sel:[1,0,0] op_sel_hi:[1,1,1]
  v_pk_fma_f32 v[190:191], v[32:33], v[188:189], v[190:191] op_sel:[0,0,0] op_sel_hi:[0,1,1]
  v_pk_fma_f32 v[206:207], v[32:33], v[204:205], v[206:207] op_sel:[0,0,0] op_sel_hi:[0,1,1]
  v_pk_fma_f32 v[190:191], v[32:33], v[204:205], v[190:191] op_sel:[1,0,0] op_sel_hi:[1,1,1] neg_lo:[1,0,0] neg_hi:[1,0,0]
  v_pk_fma_f32 v[206:207], v[32:33], v[188:189], v[206:207] op_sel:[1,0,0] op_sel_hi:[1,1,1]
  v_pk_fma_f32 v[208:209], v[32:33], v[190:191], v[208:209] op_sel:[0,0,0] op_sel_hi:[0,1,1]
  v_pk_fma_f32 v[224:225], v[32:33], v[206:207], v[224:225] op_sel:[0,0,0] op_sel_hi:[0,1,1]
  v_pk_fma_f32 v[208:209], v[32:33], v[206:207], v[208:209] op_sel:[1,0,0] op_sel_hi:[1,1,1] neg_lo:[1,0,0] neg_hi:[1,0,0]
  v_pk_fma_f32 v[224:225], v[32:33], v[190:191], v[224:225] op_sel:[1,0,0] op_sel_hi:[1,1,1]
  v_pk_fma_f32 v[210:211], v[32:33], v[208:209], v[210:211] op_sel:[0,0,0] op_sel_hi:[0,1,1]
  v_pk_fma_f32 v[226:227], v[32:33], v[224:225], v[226:227] op_sel:[0,0,0] op_sel_hi:[0,1,1]
  v_pk_fma_f32 v[210:211], v[32:33], v[224:225], v[210:211] op_sel:[1,0,0] op_sel_hi:[1,1,1] neg_lo:[1,0,0] neg_hi:[1,0,0]
  v_pk_fma_f32 v[226:227], v[32:33], v[208:209], v[226:227] op_sel:[1,0,0] op_sel_hi:[1,1,1]
  v_pk_fma_f32 v[212:213], v[32:33], v[210:211], v[212:213] op_sel:[0,0,0] op_sel_hi:[0,1,1]
  v_pk_fma_f32 v[228:229], v[32:33], v[226:227], v[228:229] op_sel:[0,0,0] op_sel_hi:[0,1,1]
  v_pk_fma_f32 v[212:213], v[32:33], v[226:227], v[212:213] op_sel:[1,0,0] op_sel_hi:[1,1,1] neg_lo:[1,0,0] neg_hi:[1,0,0]
  v_pk_fma_f32 v[228:229], v[32:33], v[210:211], v[228:229] op_sel:[1,0,0] op_sel_hi:[1,1,1]
  v_pk_fma_f32 v[214:215], v[32:33], v[212:213], v[214:215] op_sel:[0,0,0] op_sel_hi:[0,1,1]
  v_pk_fma_f32 v[230:231], v[32:33], v[228:229], v[230:231] op_sel:[0,0,0] op_sel_hi:[0,1,1]
  v_pk_fma_f32 v[214:215], v[32:33], v[228:229], v[214:215] op_sel:[1,0,0] op_sel_hi:[1,1,1] neg_lo:[1,0,0] neg_hi:[1,0,0]
  v_pk_fma_f32 v[230:231], v[32:33], v[212:213], v[230:231] op_sel:[1,0,0] op_sel_hi:[1,1,1]
  v_pk_fma_f32 v[216:217], v[32:33], v[214:215], v[216:217] op_sel:[0,0,0] op_sel_hi:[0,1,1]
  v_pk_fma_f32 v[232:233], v[32:33], v[230:231], v[232:233] op_sel:[0,0,0] op_sel_hi:[0,1,1]
  v_pk_fma_f32 v[216:217], v[32:33], v[230:231], v[216:217] op_sel:[1,0,0] op_sel_hi:[1,1,1] neg_lo:[1,0,0] neg_hi:[1,0,0]
  v_pk_fma_f32 v[232:233], v[32:33], v[214:215], v[232:233] op_sel:[1,0,0] op_sel_hi:[1,1,1]
  v_pk_fma_f32 v[218:219], v[32:33], v[216:217], v[218:219] op_sel:[0,0,0] op_sel_hi:[0,1,1]
  v_pk_fma_f32 v[234:235], v[32:33], v[232:233], v[234:235] op_sel:[0,0,0] op_sel_hi:[0,1,1]
  v_pk_fma_f32 v[218:219], v[32:33], v[232:233], v[218:219] op_sel:[1,0,0] op_sel_hi:[1,1,1] neg_lo:[1,0,0] neg_hi:[1,0,0]
  v_pk_fma_f32 v[234:235], v[32:33], v[216:217], v[234:235] op_sel:[1,0,0] op_sel_hi:[1,1,1]
  v_pk_fma_f32 v[220:221], v[32:33], v[218:219], v[220:221] op_sel:[0,0,0] op_sel_hi:[0,1,1]
  v_pk_fma_f32 v[236:237], v[32:33], v[234:235], v[236:237] op_sel:[0,0,0] op_sel_hi:[0,1,1]
  v_pk_fma_f32 v[220:221], v[32:33], v[234:235], v[220:221] op_sel:[1,0,0] op_sel_hi:[1,1,1] neg_lo:[1,0,0] neg_hi:[1,0,0]
  v_pk_fma_f32 v[236:237], v[32:33], v[218:219], v[236:237] op_sel:[1,0,0] op_sel_hi:[1,1,1]
  v_pk_fma_f32 v[222:223], v[32:33], v[220:221], v[222:223] op_sel:[0,0,0] op_sel_hi:[0,1,1]
  v_pk_fma_f32 v[238:239], v[32:33], v[236:237], v[238:239] op_sel:[0,0,0] op_sel_hi:[0,1,1]
  v_pk_fma_f32 v[222:223], v[32:33], v[236:237], v[222:223] op_sel:[1,0,0] op_sel_hi:[1,1,1] neg_lo:[1,0,0] neg_hi:[1,0,0]
  v_pk_fma_f32 v[238:239], v[32:33], v[220:221], v[238:239] op_sel:[1,0,0] op_sel_hi:[1,1,1]
  s_lshl_b32 s40, s4, 12
  s_add_u32 s40, s40, 0x1170000
  s_lshl_b32 s37, s5, 7
  s_add_u32 s37, s37, s40
  s_lshl2_add_u32 s41, s5, s3
  s_lshl_b32 s41, s41, 7
  s_add_u32 s40, s40, s41
  s_add_u32 s40, s40, 2048
  v_mov_b32 v96, s76
  v_mov_b32 v97, s77
  v_mov_b32 v98, 0x27ff0
  v_mov_b32 v99, 1
  s_mov_b64 exec, 1
  s_waitcnt vmcnt(0)
  ds_add_rtn_u32 v99, v98, v99
  s_mov_b64 exec, 0xffff
  v_lshlrev_b32 v98, 3, v1
  s_waitcnt lgkmcnt(0)
  v_readfirstlane_b32 s15, v99
  s_cmp_lg_u32 s15, 3
  s_cbranch_scc1 notlast_36
  buffer_store_dwordx2 v[96:97], v98, s[60:63], s37 offen sc1
notlast_36:
  s_mov_b64 exec, -1
  s_add_u32 s38, s36, 16384
  s_add_u32 s39, s38, 131072
  v_cvt_pk_bf16_f32 v88, v176, v178
  v_cvt_pk_bf16_f32 v89, v180, v182
  v_cvt_pk_bf16_f32 v90, v184, v186
  v_cvt_pk_bf16_f32 v91, v188, v190
  v_xor_b32 v2, 0, v8
  buffer_store_dwordx4 v[88:91], v2, s[60:63], s38 offen offset:0 sc1
  v_cvt_pk_bf16_f32 v92, v177, v179
  v_cvt_pk_bf16_f32 v93, v181, v183
  v_cvt_pk_bf16_f32 v94, v185, v187
  v_cvt_pk_bf16_f32 v95, v189, v191
  v_xor_b32 v3, 128, v8
  buffer_store_dwordx4 v[92:95], v3, s[60:63], s38 offen offset:2048 sc1
  v_cvt_pk_bf16_f32 v64, v208, v210
  v_cvt_pk_bf16_f32 v65, v212, v214
  v_cvt_pk_bf16_f32 v66, v216, v218
  v_cvt_pk_bf16_f32 v67, v220, v222
  v_xor_b32 v2, 64, v8
  buffer_store_dwordx4 v[64:67], v2, s[60:63], s38 offen offset:1024 sc1
  v_cvt_pk_bf16_f32 v68, v209, v211
  v_cvt_pk_bf16_f32 v69, v213, v215
  v_cvt_pk_bf16_f32 v70, v217, v219
  v_cvt_pk_bf16_f32 v71, v221, v223
  v_xor_b32 v3, 192, v8
  buffer_store_dwordx4 v[68:71], v3, s[60:63], s38 offen offset:3072 sc1
  v_cvt_pk_bf16_f32 v88, -v192, -v194
  v_cvt_pk_bf16_f32 v89, -v196, -v198
  v_cvt_pk_bf16_f32 v90, -v200, -v202
  v_cvt_pk_bf16_f32 v91, -v204, -v206
  v_xor_b32 v2, 0, v8
  buffer_store_dwordx4 v[88:91], v2, s[60:63], s39 offen offset:0 sc1
  v_cvt_pk_bf16_f32 v92, -v193, -v195
  v_cvt_pk_bf16_f32 v93, -v197, -v199
  v_cvt_pk_bf16_f32 v94, -v201, -v203
  v_cvt_pk_bf16_f32 v95, -v205, -v207
  v_xor_b32 v3, 128, v8
  buffer_store_dwordx4 v[92:95], v3, s[60:63], s39 offen offset:2048 sc1
  v_cvt_pk_bf16_f32 v64, -v224, -v226
  v_cvt_pk_bf16_f32 v65, -v228, -v230
  v_cvt_pk_bf16_f32 v66, -v232, -v234
  v_cvt_pk_bf16_f32 v67, -v236, -v238
  v_xor_b32 v2, 64, v8
  buffer_store_dwordx4 v[64:67], v2, s[60:63], s39 offen offset:1024 sc1
  v_cvt_pk_bf16_f32 v68, -v225, -v227
  v_cvt_pk_bf16_f32 v69, -v229, -v231
  v_cvt_pk_bf16_f32 v70, -v233, -v235
  v_cvt_pk_bf16_f32 v71, -v237, -v239
  v_xor_b32 v3, 192, v8
  buffer_store_dwordx4 v[68:71], v3, s[60:63], s39 offen offset:3072 sc1
  s_branch L_ycons
L_zcons:
  s_lshl_b32 s11, s3, 12
  v_xor_b32 v2, 0, v14
  v_add_u32 v52, s11, v2
  v_add_u32 v53, 0x10000, v52
  v_xor_b32 v2, 32, v14
  v_add_u32 v54, s11, v2
  v_add_u32 v55, 0x10000, v54
  v_xor_b32 v2, 64, v14
  v_add_u32 v56, s11, v2
  v_add_u32 v57, 0x10000, v56
  v_xor_b32 v2, 96, v14
  v_add_u32 v58, s11, v2
  v_add_u32 v59, 0x10000, v58
  v_bfe_u32 v2, v1, 2, 2
  v_lshl_add_u32 v3, v13, 3, v2
  v_lshlrev_b32 v3, 7, v3
  v_lshrrev_b32 v2, 1, v2
  v_lshl_add_u32 v3, v2, 6, v3
  v_bfe_u32 v2, v1, 4, 1
  v_lshl_add_u32 v3, v2, 5, v3
  v_and_b32 v2, 1, v1
  v_lshl_add_u32 v3, v2, 4, v3
  v_bfe_u32 v2, v1, 1, 1
  v_lshl_add_u32 v60, v2, 3, v3
  v_xor_b32 v61, 64, v60
  v_add_u32 v62, 0x10000, v60
  v_add_u32 v63, 0x20000, v60
  v_add_u32 v64, 0x10000, v61
  v_add_u32 v65, 0x20000, v61
  v_mov_b32 v48, 0xbdd2d3e8
  v_mov_b32 v49, 0xc0135761
  v_mov_b32 v50, 1.0
  v_mov_b32 v51, 1.0
  s_cmp_lt_u32 s8, 10
  s_cselect_b32 s16, 1.0, 0
  s_cselect_b32 s17, 1.0, 0
  v_lshl_add_u32 v2, v12, 1, v13
  v_lshlrev_b32 v226, 4, v2
  v_xor_b32 v227, 128, v226
  s_lshl1_add_u32 s11, s4, s35
  s_lshl3_add_u32 s11, s11, s34
  s_lshl_b32 s11, s11, 10
  s_lshl_b32 s12, s8, 18
  s_add_u32 s11, s11, s12
  s_add_u32 s24, s11, 0x300000
  s_add_u32 s25, s24, 4096
  s_lshl_b32 s11, s4, 15
  s_lshl_b32 s12, s3, 9
  s_add_u32 s11, s11, s12
  s_add_u32 s11, s11, 0x1200000
  v_lshl_add_u32 v224, v12, 4, s11
  v_mul_u32_u24 v2, 10240, v13
  v_add_u32 v225, v224, v2
  s_movk_i32 s20, 0x1000
  s_movk_i32 s22, 0x2000
  s_lshl_b32 s21, s8, 11
  s_lshl4_add_u32 s11, s8, s4
  s_lshl_b32 s11, s11, 7
  s_add_u32 s23, s11, 0x1140000
  s_barrier
  ds_read_b128 v[68:71], v52 offset:0
  ds_read_b64_tr_b16 v[100:101], v63 offset:0
  ds_read_b64_tr_b16 v[102:103], v63 offset:512
  ds_read_b64_tr_b16 v[104:105], v65 offset:0
  ds_read_b64_tr_b16 v[106:107], v65 offset:512
  ds_read_b128 v[72:75], v54 offset:0
  ds_read_b64_tr_b16 v[108:109], v63 offset:2048
  ds_read_b64_tr_b16 v[110:111], v63 offset:2560
  ds_read_b64_tr_b16 v[112:113], v65 offset:2048
  ds_read_b64_tr_b16 v[114:115], v65 offset:2560
  ds_read_b128 v[76:79], v56 offset:0
  ds_read_b64_tr_b16 v[116:117], v63 offset:4096
  ds_read_b64_tr_b16 v[118:119], v63 offset:4608
  ds_read_b64_tr_b16 v[120:121], v65 offset:4096
  ds_read_b64_tr_b16 v[122:123], v65 offset:4608
  ds_read_b128 v[80:83], v58 offset:0
  ds_read_b64_tr_b16 v[124:125], v63 offset:6144
  ds_read_b64_tr_b16 v[126:127], v63 offset:6656
  ds_read_b64_tr_b16 v[128:129], v65 offset:6144
  ds_read_b64_tr_b16 v[130:131], v65 offset:6656
  s_waitcnt lgkmcnt(0)
  s_barrier
  v_mfma_f32_32x32x16_bf16 v[164:179], v[100:103], v[68:71], 0
  ds_read_b128 v[84:87], v52 offset:16384
  ds_read_b64_tr_b16 v[132:133], v63 offset:8192
  ds_read_b64_tr_b16 v[134:135], v63 offset:8704
  v_mfma_f32_32x32x16_bf16 v[180:195], v[104:107], v[68:71], 0
  ds_read_b64_tr_b16 v[136:137], v65 offset:8192
  ds_read_b64_tr_b16 v[138:139], v65 offset:8704
  ds_read_b128 v[88:91], v54 offset:16384
  v_mfma_f32_32x32x16_bf16 v[164:179], v[108:111], v[72:75], v[164:179]
  ds_read_b64_tr_b16 v[140:141], v63 offset:10240
  ds_read_b64_tr_b16 v[142:143], v63 offset:10752
  ds_read_b64_tr_b16 v[144:145], v65 offset:10240
  v_mfma_f32_32x32x16_bf16 v[180:195], v[112:115], v[72:75], v[180:195]
  ds_read_b64_tr_b16 v[146:147], v65 offset:10752
  ds_read_b128 v[92:95], v56 offset:16384
  ds_read_b64_tr_b16 v[148:149], v63 offset:12288
  v_mfma_f32_32x32x16_bf16 v[164:179], v[116:119], v[76:79], v[164:179]
  ds_read_b64_tr_b16 v[150:151], v63 offset:12800
  ds_read_b64_tr_b16 v[152:153], v65 offset:12288
  ds_read_b64_tr_b16 v[154:155], v65 offset:12800
  v_mfma_f32_32x32x16_bf16 v[180:195], v[120:123], v[76:79], v[180:195]
  ds_read_b128 v[96:99], v58 offset:16384
  ds_read_b64_tr_b16 v[156:157], v63 offset:14336
  ds_read_b64_tr_b16 v[158:159], v63 offset:14848
  v_mfma_f32_32x32x16_bf16 v[164:179], v[124:127], v[80:83], v[164:179]
  ds_read_b64_tr_b16 v[160:161], v65 offset:14336
  ds_read_b64_tr_b16 v[162:163], v65 offset:14848
  v_mfma_f32_32x32x16_bf16 v[180:195], v[128:131], v[80:83], v[180:195]
  s_waitcnt lgkmcnt(0)
  s_barrier
  v_mfma_f32_32x32x16_bf16 v[164:179], v[132:135], v[84:87], v[164:179]
  ds_read_b128 v[68:71], v52 offset:32768
  ds_read_b64_tr_b16 v[100:101], v63 offset:16384
  ds_read_b64_tr_b16 v[102:103], v63 offset:16896
  v_mfma_f32_32x32x16_bf16 v[180:195], v[136:139], v[84:87], v[180:195]
  ds_read_b64_tr_b16 v[104:105], v65 offset:16384
  ds_read_b64_tr_b16 v[106:107], v65 offset:16896
  ds_read_b128 v[72:75], v54 offset:32768
  v_mfma_f32_32x32x16_bf16 v[164:179], v[140:143], v[88:91], v[164:179]
  ds_read_b64_tr_b16 v[108:109], v63 offset:18432
  ds_read_b64_tr_b16 v[110:111], v63 offset:18944
  ds_read_b64_tr_b16 v[112:113], v65 offset:18432
  v_mfma_f32_32x32x16_bf16 v[180:195], v[144:147], v[88:91], v[180:195]
  ds_read_b64_tr_b16 v[114:115], v65 offset:18944
  ds_read_b128 v[76:79], v56 offset:32768
  ds_read_b64_tr_b16 v[116:117], v63 offset:20480
  v_mfma_f32_32x32x16_bf16 v[164:179], v[148:151], v[92:95], v[164:179]
  ds_read_b64_tr_b16 v[118:119], v63 offset:20992
  ds_read_b64_tr_b16 v[120:121], v65 offset:20480
  ds_read_b64_tr_b16 v[122:123], v65 offset:20992
  v_mfma_f32_32x32x16_bf16 v[180:195], v[152:155], v[92:95], v[180:195]
  ds_read_b128 v[80:83], v58 offset:32768
  ds_read_b64_tr_b16 v[124:125], v63 offset:22528
  ds_read_b64_tr_b16 v[126:127], v63 offset:23040
  v_mfma_f32_32x32x16_bf16 v[164:179], v[156:159], v[96:99], v[164:179]
  ds_read_b64_tr_b16 v[128:129], v65 offset:22528
  ds_read_b64_tr_b16 v[130:131], v65 offset:23040
  v_mfma_f32_32x32x16_bf16 v[180:195], v[160:163], v[96:99], v[180:195]
  s_waitcnt lgkmcnt(0)
  s_barrier
  v_mfma_f32_32x32x16_bf16 v[164:179], v[100:103], v[68:71], v[164:179]
  ds_read_b128 v[84:87], v52 offset:49152
  ds_read_b64_tr_b16 v[132:133], v63 offset:24576
  ds_read_b64_tr_b16 v[134:135], v63 offset:25088
  v_mfma_f32_32x32x16_bf16 v[180:195], v[104:107], v[68:71], v[180:195]
  ds_read_b64_tr_b16 v[136:137], v65 offset:24576
  ds_read_b64_tr_b16 v[138:139], v65 offset:25088
  ds_read_b128 v[88:91], v54 offset:49152
  v_mfma_f32_32x32x16_bf16 v[164:179], v[108:111], v[72:75], v[164:179]
  ds_read_b64_tr_b16 v[140:141], v63 offset:26624
  ds_read_b64_tr_b16 v[142:143], v63 offset:27136
  ds_read_b64_tr_b16 v[144:145], v65 offset:26624
  v_mfma_f32_32x32x16_bf16 v[180:195], v[112:115], v[72:75], v[180:195]
  ds_read_b64_tr_b16 v[146:147], v65 offset:27136
  ds_read_b128 v[92:95], v56 offset:49152
  ds_read_b64_tr_b16 v[148:149], v63 offset:28672
  v_mfma_f32_32x32x16_bf16 v[164:179], v[116:119], v[76:79], v[164:179]
  ds_read_b64_tr_b16 v[150:151], v63 offset:29184
  ds_read_b64_tr_b16 v[152:153], v65 offset:28672
  ds_read_b64_tr_b16 v[154:155], v65 offset:29184
  v_mfma_f32_32x32x16_bf16 v[180:195], v[120:123], v[76:79], v[180:195]
  ds_read_b128 v[96:99], v58 offset:49152
  ds_read_b64_tr_b16 v[156:157], v63 offset:30720
  ds_read_b64_tr_b16 v[158:159], v63 offset:31232
  v_mfma_f32_32x32x16_bf16 v[164:179], v[124:127], v[80:83], v[164:179]
  ds_read_b64_tr_b16 v[160:161], v65 offset:30720
  ds_read_b64_tr_b16 v[162:163], v65 offset:31232
  v_mfma_f32_32x32x16_bf16 v[180:195], v[128:131], v[80:83], v[180:195]
  s_waitcnt lgkmcnt(0)
  s_barrier
  v_mfma_f32_32x32x16_bf16 v[164:179], v[132:135], v[84:87], v[164:179]
  ds_read_b128 v[68:71], v53 offset:0
  ds_read_b64_tr_b16 v[100:101], v63 offset:0
  ds_read_b64_tr_b16 v[102:103], v63 offset:512
  v_mfma_f32_32x32x16_bf16 v[180:195], v[136:139], v[84:87], v[180:195]
  ds_read_b64_tr_b16 v[104:105], v65 offset:0
  ds_read_b64_tr_b16 v[106:107], v65 offset:512
  ds_read_b128 v[72:75], v55 offset:0
  v_mfma_f32_32x32x16_bf16 v[164:179], v[140:143], v[88:91], v[164:179]
  ds_read_b64_tr_b16 v[108:109], v63 offset:2048
  ds_read_b64_tr_b16 v[110:111], v63 offset:2560
  ds_read_b64_tr_b16 v[112:113], v65 offset:2048
  v_mfma_f32_32x32x16_bf16 v[180:195], v[144:147], v[88:91], v[180:195]
  ds_read_b64_tr_b16 v[114:115], v65 offset:2560
  ds_read_b128 v[76:79], v57 offset:0
  ds_read_b64_tr_b16 v[116:117], v63 offset:4096
  v_mfma_f32_32x32x16_bf16 v[164:179], v[148:151], v[92:95], v[164:179]
  ds_read_b64_tr_b16 v[118:119], v63 offset:4608
  ds_read_b64_tr_b16 v[120:121], v65 offset:4096
  ds_read_b64_tr_b16 v[122:123], v65 offset:4608
  v_mfma_f32_32x32x16_bf16 v[180:195], v[152:155], v[92:95], v[180:195]
  ds_read_b128 v[80:83], v59 offset:0
  ds_read_b64_tr_b16 v[124:125], v63 offset:6144
  ds_read_b64_tr_b16 v[126:127], v63 offset:6656
  v_mfma_f32_32x32x16_bf16 v[164:179], v[156:159], v[96:99], v[164:179]
  ds_read_b64_tr_b16 v[128:129], v65 offset:6144
  ds_read_b64_tr_b16 v[130:131], v65 offset:6656
  v_mfma_f32_32x32x16_bf16 v[180:195], v[160:163], v[96:99], v[180:195]
  s_waitcnt lgkmcnt(0)
  s_barrier
  v_mov_b32 v9, 0
  global_load_dwordx2 v[10:11], v9, s[48:49] sc1
  v_mfma_f32_32x32x16_bf16 v[164:179], v[100:103], v[68:71], v[164:179]
  ds_read_b128 v[84:87], v53 offset:16384
  ds_read_b64_tr_b16 v[132:133], v63 offset:8192
  ds_read_b64_tr_b16 v[134:135], v63 offset:8704
  v_mfma_f32_32x32x16_bf16 v[180:195], v[104:107], v[68:71], v[180:195]
  ds_read_b64_tr_b16 v[136:137], v65 offset:8192
  ds_read_b64_tr_b16 v[138:139], v65 offset:8704
  ds_read_b128 v[88:91], v55 offset:16384
  v_mfma_f32_32x32x16_bf16 v[164:179], v[108:111], v[72:75], v[164:179]
  ds_read_b64_tr_b16 v[140:141], v63 offset:10240
  ds_read_b64_tr_b16 v[142:143], v63 offset:10752
  ds_read_b64_tr_b16 v[144:145], v65 offset:10240
  v_mfma_f32_32x32x16_bf16 v[180:195], v[112:115], v[72:75], v[180:195]
  ds_read_b64_tr_b16 v[146:147], v65 offset:10752
  ds_read_b128 v[92:95], v57 offset:16384
  ds_read_b64_tr_b16 v[148:149], v63 offset:12288
  v_mfma_f32_32x32x16_bf16 v[164:179], v[116:119], v[76:79], v[164:179]
  ds_read_b64_tr_b16 v[150:151], v63 offset:12800
  ds_read_b64_tr_b16 v[152:153], v65 offset:12288
  ds_read_b64_tr_b16 v[154:155], v65 offset:12800
  v_mfma_f32_32x32x16_bf16 v[180:195], v[120:123], v[76:79], v[180:195]
  ds_read_b128 v[96:99], v59 offset:16384
  ds_read_b64_tr_b16 v[156:157], v63 offset:14336
  ds_read_b64_tr_b16 v[158:159], v63 offset:14848
  v_mfma_f32_32x32x16_bf16 v[164:179], v[124:127], v[80:83], v[164:179]
  ds_read_b64_tr_b16 v[160:161], v65 offset:14336
  ds_read_b64_tr_b16 v[162:163], v65 offset:14848
  v_mfma_f32_32x32x16_bf16 v[180:195], v[128:131], v[80:83], v[180:195]
  s_waitcnt lgkmcnt(0)
  s_barrier
  v_mfma_f32_32x32x16_bf16 v[164:179], v[132:135], v[84:87], v[164:179]
  ds_read_b128 v[68:71], v53 offset:32768
  ds_read_b64_tr_b16 v[100:101], v63 offset:16384
  ds_read_b64_tr_b16 v[102:103], v63 offset:16896
  v_mfma_f32_32x32x16_bf16 v[180:195], v[136:139], v[84:87], v[180:195]
  ds_read_b64_tr_b16 v[104:105], v65 offset:16384
  ds_read_b64_tr_b16 v[106:107], v65 offset:16896
  ds_read_b128 v[72:75], v55 offset:32768
  v_mfma_f32_32x32x16_bf16 v[164:179], v[140:143], v[88:91], v[164:179]
  ds_read_b64_tr_b16 v[108:109], v63 offset:18432
  ds_read_b64_tr_b16 v[110:111], v63 offset:18944
  ds_read_b64_tr_b16 v[112:113], v65 offset:18432
  v_mfma_f32_32x32x16_bf16 v[180:195], v[144:147], v[88:91], v[180:195]
  ds_read_b64_tr_b16 v[114:115], v65 offset:18944
  ds_read_b128 v[76:79], v57 offset:32768
  ds_read_b64_tr_b16 v[116:117], v63 offset:20480
  v_mfma_f32_32x32x16_bf16 v[164:179], v[148:151], v[92:95], v[164:179]
  ds_read_b64_tr_b16 v[118:119], v63 offset:20992
  ds_read_b64_tr_b16 v[120:121], v65 offset:20480
  ds_read_b64_tr_b16 v[122:123], v65 offset:20992
  v_mfma_f32_32x32x16_bf16 v[180:195], v[152:155], v[92:95], v[180:195]
  ds_read_b128 v[80:83], v59 offset:32768
  ds_read_b64_tr_b16 v[124:125], v63 offset:22528
  ds_read_b64_tr_b16 v[126:127], v63 offset:23040
  v_mfma_f32_32x32x16_bf16 v[164:179], v[156:159], v[96:99], v[164:179]
  ds_read_b64_tr_b16 v[128:129], v65 offset:22528
  ds_read_b64_tr_b16 v[130:131], v65 offset:23040
  v_mfma_f32_32x32x16_bf16 v[180:195], v[160:163], v[96:99], v[180:195]
  s_waitcnt lgkmcnt(0)
  s_barrier
  v_mfma_f32_32x32x16_bf16 v[164:179], v[100:103], v[68:71], v[164:179]
  ds_read_b128 v[84:87], v53 offset:49152
  ds_read_b64_tr_b16 v[132:133], v63 offset:24576
  ds_read_b64_tr_b16 v[134:135], v63 offset:25088
  v_mfma_f32_32x32x16_bf16 v[180:195], v[104:107], v[68:71], v[180:195]
  ds_read_b64_tr_b16 v[136:137], v65 offset:24576
  ds_read_b64_tr_b16 v[138:139], v65 offset:25088
  ds_read_b128 v[88:91], v55 offset:49152
  v_mfma_f32_32x32x16_bf16 v[164:179], v[108:111], v[72:75], v[164:179]
  ds_read_b64_tr_b16 v[140:141], v63 offset:26624
  ds_read_b64_tr_b16 v[142:143], v63 offset:27136
  ds_read_b64_tr_b16 v[144:145], v65 offset:26624
  v_mfma_f32_32x32x16_bf16 v[180:195], v[112:115], v[72:75], v[180:195]
  ds_read_b64_tr_b16 v[146:147], v65 offset:27136
  ds_read_b128 v[92:95], v57 offset:49152
  ds_read_b64_tr_b16 v[148:149], v63 offset:28672
  v_mfma_f32_32x32x16_bf16 v[164:179], v[116:119], v[76:79], v[164:179]
  ds_read_b64_tr_b16 v[150:151], v63 offset:29184
  ds_read_b64_tr_b16 v[152:153], v65 offset:28672
  ds_read_b64_tr_b16 v[154:155], v65 offset:29184
  v_mfma_f32_32x32x16_bf16 v[180:195], v[120:123], v[76:79], v[180:195]
  ds_read_b128 v[96:99], v59 offset:49152
  ds_read_b64_tr_b16 v[156:157], v63 offset:30720
  ds_read_b64_tr_b16 v[158:159], v63 offset:31232
  v_mfma_f32_32x32x16_bf16 v[164:179], v[124:127], v[80:83], v[164:179]
  ds_read_b64_tr_b16 v[160:161], v65 offset:30720
  ds_read_b64_tr_b16 v[162:163], v65 offset:31232
  v_mfma_f32_32x32x16_bf16 v[180:195], v[128:131], v[80:83], v[180:195]
  s_waitcnt lgkmcnt(0)
  s_barrier
  v_mfma_f32_32x32x16_bf16 v[164:179], v[132:135], v[84:87], v[164:179]
  ds_read_b128 v[68:71], v52 offset:0
  ds_read_b64_tr_b16 v[100:101], v63 offset:0
  ds_read_b64_tr_b16 v[102:103], v63 offset:512
  v_mfma_f32_32x32x16_bf16 v[180:195], v[136:139], v[84:87], v[180:195]
  ds_read_b64_tr_b16 v[104:105], v65 offset:0
  ds_read_b64_tr_b16 v[106:107], v65 offset:512
  ds_read_b128 v[72:75], v54 offset:0
  v_mfma_f32_32x32x16_bf16 v[164:179], v[140:143], v[88:91], v[164:179]
  ds_read_b64_tr_b16 v[108:109], v63 offset:2048
  ds_read_b64_tr_b16 v[110:111], v63 offset:2560
  ds_read_b64_tr_b16 v[112:113], v65 offset:2048
  v_mfma_f32_32x32x16_bf16 v[180:195], v[144:147], v[88:91], v[180:195]
  ds_read_b64_tr_b16 v[114:115], v65 offset:2560
  ds_read_b128 v[76:79], v56 offset:0
  ds_read_b64_tr_b16 v[116:117], v63 offset:4096
  v_mfma_f32_32x32x16_bf16 v[164:179], v[148:151], v[92:95], v[164:179]
  ds_read_b64_tr_b16 v[118:119], v63 offset:4608
  ds_read_b64_tr_b16 v[120:121], v65 offset:4096
  ds_read_b64_tr_b16 v[122:123], v65 offset:4608
  v_mfma_f32_32x32x16_bf16 v[180:195], v[152:155], v[92:95], v[180:195]
  ds_read_b128 v[80:83], v58 offset:0
  ds_read_b64_tr_b16 v[124:125], v63 offset:6144
  ds_read_b64_tr_b16 v[126:127], v63 offset:6656
  v_mfma_f32_32x32x16_bf16 v[164:179], v[156:159], v[96:99], v[164:179]
  ds_read_b64_tr_b16 v[128:129], v65 offset:6144
  ds_read_b64_tr_b16 v[130:131], v65 offset:6656
  v_mfma_f32_32x32x16_bf16 v[180:195], v[160:163], v[96:99], v[180:195]
  s_mov_b32 s85, 0x40000
nonce_37:
  s_waitcnt vmcnt(0)
  v_readfirstlane_b32 s76, v10
  v_readfirstlane_b32 s77, v11
  s_cmp_lg_u32 s77, 0
  s_cbranch_scc1 nonce_ok_38
  s_sub_u32 s85, s85, 1
  s_cbranch_scc1 nonce_ok_38
  s_sleep 1
  v_mov_b32 v9, 0
  global_load_dwordx2 v[10:11], v9, s[48:49] sc1
  s_branch nonce_37
nonce_ok_38:
  s_nop 3
  v_pk_mul_f32 v[196:197], v[164:165], v[164:165]
  v_pk_mul_f32 v[198:199], v[166:167], v[166:167]
  v_pk_mul_f32 v[200:201], v[168:169], v[168:169]
  v_pk_mul_f32 v[202:203], v[170:171], v[170:171]
  v_pk_fma_f32 v[196:197], v[196:197], v[48:49], v[48:49] op_sel:[0,0,1] op_sel_hi:[1,0,1]
  v_pk_fma_f32 v[198:199], v[198:199], v[48:49], v[48:49] op_sel:[0,0,1] op_sel_hi:[1,0,1]
  v_pk_fma_f32 v[200:201], v[200:201], v[48:49], v[48:49] op_sel:[0,0,1] op_sel_hi:[1,0,1]
  v_pk_fma_f32 v[202:203], v[202:203], v[48:49], v[48:49] op_sel:[0,0,1] op_sel_hi:[1,0,1]
  v_pk_mul_f32 v[196:197], v[196:197], v[164:165]
  v_pk_mul_f32 v[198:199], v[198:199], v[166:167]
  v_pk_mul_f32 v[200:201], v[200:201], v[168:169]
  v_pk_mul_f32 v[202:203], v[202:203], v[170:171]
  v_exp_f32 v196, v196
  v_exp_f32 v197, v197
  v_exp_f32 v198, v198
  v_exp_f32 v199, v199
  v_exp_f32 v200, v200
  v_exp_f32 v201, v201
  v_exp_f32 v202, v202
  v_exp_f32 v203, v203
  v_pk_add_f32 v[196:197], v[196:197], v[50:51] op_sel_hi:[1,0]
  v_pk_add_f32 v[198:199], v[198:199], v[50:51] op_sel_hi:[1,0]
  v_pk_add_f32 v[200:201], v[200:201], v[50:51] op_sel_hi:[1,0]
  v_pk_add_f32 v[202:203], v[202:203], v[50:51] op_sel_hi:[1,0]
  v_rcp_f32 v196, v196
  v_rcp_f32 v197, v197
  v_rcp_f32 v198, v198
  v_rcp_f32 v199, v199
  v_rcp_f32 v200, v200
  v_rcp_f32 v201, v201
  v_rcp_f32 v202, v202
  v_rcp_f32 v203, v203
  v_pk_mul_f32 v[164:165], v[164:165], v[196:197]
  v_pk_mul_f32 v[166:167], v[166:167], v[198:199]
  v_pk_mul_f32 v[168:169], v[168:169], v[200:201]
  v_pk_mul_f32 v[170:171], v[170:171], v[202:203]
  v_pk_mul_f32 v[196:197], v[172:173], v[172:173]
  v_pk_mul_f32 v[198:199], v[174:175], v[174:175]
  v_pk_mul_f32 v[200:201], v[176:177], v[176:177]
  v_pk_mul_f32 v[202:203], v[178:179], v[178:179]
  v_pk_fma_f32 v[196:197], v[196:197], v[48:49], v[48:49] op_sel:[0,0,1] op_sel_hi:[1,0,1]
  v_pk_fma_f32 v[198:199], v[198:199], v[48:49], v[48:49] op_sel:[0,0,1] op_sel_hi:[1,0,1]
  v_pk_fma_f32 v[200:201], v[200:201], v[48:49], v[48:49] op_sel:[0,0,1] op_sel_hi:[1,0,1]
  v_pk_fma_f32 v[202:203], v[202:203], v[48:49], v[48:49] op_sel:[0,0,1] op_sel_hi:[1,0,1]
  v_pk_mul_f32 v[196:197], v[196:197], v[172:173]
  v_pk_mul_f32 v[198:199], v[198:199], v[174:175]
  v_pk_mul_f32 v[200:201], v[200:201], v[176:177]
  v_pk_mul_f32 v[202:203], v[202:203], v[178:179]
  v_exp_f32 v196, v196
  v_exp_f32 v197, v197
  v_exp_f32 v198, v198
  v_exp_f32 v199, v199
  v_exp_f32 v200, v200
  v_exp_f32 v201, v201
  v_exp_f32 v202, v202
  v_exp_f32 v203, v203
  v_pk_add_f32 v[196:197], v[196:197], v[50:51] op_sel_hi:[1,0]
  v_pk_add_f32 v[198:199], v[198:199], v[50:51] op_sel_hi:[1,0]
  v_pk_add_f32 v[200:201], v[200:201], v[50:51] op_sel_hi:[1,0]
  v_pk_add_f32 v[202:203], v[202:203], v[50:51] op_sel_hi:[1,0]
  v_rcp_f32 v196, v196
  v_rcp_f32 v197, v197
  v_rcp_f32 v198, v198
  v_rcp_f32 v199, v199
  v_rcp_f32 v200, v200
  v_rcp_f32 v201, v201
  v_rcp_f32 v202, v202
  v_rcp_f32 v203, v203
  v_pk_mul_f32 v[172:173], v[172:173], v[196:197]
  v_pk_mul_f32 v[174:175], v[174:175], v[198:199]
  v_pk_mul_f32 v[176:177], v[176:177], v[200:201]
  v_pk_mul_f32 v[178:179], v[178:179], v[202:203]
  v_pk_mul_f32 v[196:197], v[180:181], v[180:181]
  v_pk_mul_f32 v[198:199], v[182:183], v[182:183]
  v_pk_mul_f32 v[200:201], v[184:185], v[184:185]
  v_pk_mul_f32 v[202:203], v[186:187], v[186:187]
  v_pk_fma_f32 v[196:197], v[196:197], v[48:49], v[48:49] op_sel:[0,0,1] op_sel_hi:[1,0,1]
  v_pk_fma_f32 v[198:199], v[198:199], v[48:49], v[48:49] op_sel:[0,0,1] op_sel_hi:[1,0,1]
  v_pk_fma_f32 v[200:201], v[200:201], v[48:49], v[48:49] op_sel:[0,0,1] op_sel_hi:[1,0,1]
  v_pk_fma_f32 v[202:203], v[202:203], v[48:49], v[48:49] op_sel:[0,0,1] op_sel_hi:[1,0,1]
  v_pk_mul_f32 v[196:197], v[196:197], v[180:181]
  v_pk_mul_f32 v[198:199], v[198:199], v[182:183]
  v_pk_mul_f32 v[200:201], v[200:201], v[184:185]
  v_pk_mul_f32 v[202:203], v[202:203], v[186:187]
  v_exp_f32 v196, v196
  v_exp_f32 v197, v197
  v_exp_f32 v198, v198
  v_exp_f32 v199, v199
  v_exp_f32 v200, v200
  v_exp_f32 v201, v201
  v_exp_f32 v202, v202
  v_exp_f32 v203, v203
  v_pk_add_f32 v[196:197], v[196:197], v[50:51] op_sel_hi:[1,0]
  v_pk_add_f32 v[198:199], v[198:199], v[50:51] op_sel_hi:[1,0]
  v_pk_add_f32 v[200:201], v[200:201], v[50:51] op_sel_hi:[1,0]
  v_pk_add_f32 v[202:203], v[202:203], v[50:51] op_sel_hi:[1,0]
  v_rcp_f32 v196, v196
  v_rcp_f32 v197, v197
  v_rcp_f32 v198, v198
  v_rcp_f32 v199, v199
  v_rcp_f32 v200, v200
  v_rcp_f32 v201, v201
  v_rcp_f32 v202, v202
  v_rcp_f32 v203, v203
  v_pk_mul_f32 v[180:181], v[180:181], v[196:197]
  v_pk_mul_f32 v[182:183], v[182:183], v[198:199]
  v_pk_mul_f32 v[184:185], v[184:185], v[200:201]
  v_pk_mul_f32 v[186:187], v[186:187], v[202:203]
  v_pk_mul_f32 v[196:197], v[188:189], v[188:189]
  v_pk_mul_f32 v[198:199], v[190:191], v[190:191]
  v_pk_mul_f32 v[200:201], v[192:193], v[192:193]
  v_pk_mul_f32 v[202:203], v[194:195], v[194:195]
  v_pk_fma_f32 v[196:197], v[196:197], v[48:49], v[48:49] op_sel:[0,0,1] op_sel_hi:[1,0,1]
  v_pk_fma_f32 v[198:199], v[198:199], v[48:49], v[48:49] op_sel:[0,0,1] op_sel_hi:[1,0,1]
  v_pk_fma_f32 v[200:201], v[200:201], v[48:49], v[48:49] op_sel:[0,0,1] op_sel_hi:[1,0,1]
  v_pk_fma_f32 v[202:203], v[202:203], v[48:49], v[48:49] op_sel:[0,0,1] op_sel_hi:[1,0,1]
  v_pk_mul_f32 v[196:197], v[196:197], v[188:189]
  v_pk_mul_f32 v[198:199], v[198:199], v[190:191]
  v_pk_mul_f32 v[200:201], v[200:201], v[192:193]
  v_pk_mul_f32 v[202:203], v[202:203], v[194:195]
  v_exp_f32 v196, v196
  v_exp_f32 v197, v197
  v_exp_f32 v198, v198
  v_exp_f32 v199, v199
  v_exp_f32 v200, v200
  v_exp_f32 v201, v201
  v_exp_f32 v202, v202
  v_exp_f32 v203, v203
  v_pk_add_f32 v[196:197], v[196:197], v[50:51] op_sel_hi:[1,0]
  v_pk_add_f32 v[198:199], v[198:199], v[50:51] op_sel_hi:[1,0]
  v_pk_add_f32 v[200:201], v[200:201], v[50:51] op_sel_hi:[1,0]
  v_pk_add_f32 v[202:203], v[202:203], v[50:51] op_sel_hi:[1,0]
  v_rcp_f32 v196, v196
  v_rcp_f32 v197, v197
  v_rcp_f32 v198, v198
  v_rcp_f32 v199, v199
  v_rcp_f32 v200, v200
  v_rcp_f32 v201, v201
  v_rcp_f32 v202, v202
  v_rcp_f32 v203, v203
  v_pk_mul_f32 v[188:189], v[188:189], v[196:197]
  v_pk_mul_f32 v[190:191], v[190:191], v[198:199]
  v_pk_mul_f32 v[192:193], v[192:193], v[200:201]
  v_pk_mul_f32 v[194:195], v[194:195], v[202:203]
  v_pk_mul_f32 v[188:189], v[188:189], s[16:17]
  v_pk_mul_f32 v[190:191], v[190:191], s[16:17]
  v_pk_mul_f32 v[192:193], v[192:193], s[16:17]
  v_pk_mul_f32 v[194:195], v[194:195], s[16:17]
  v_pk_mul_f32 v[200:201], v[164:165], v[164:165]
  v_pk_mul_f32 v[202:203], v[166:167], v[166:167]
  v_pk_fma_f32 v[200:201], v[168:169], v[168:169], v[200:201]
  v_pk_add_f32 v[196:197], v[164:165], v[168:169]
  v_pk_fma_f32 v[202:203], v[170:171], v[170:171], v[202:203]
  v_pk_add_f32 v[198:199], v[166:167], v[170:171]
  v_pk_fma_f32 v[200:201], v[172:173], v[172:173], v[200:201]
  v_pk_add_f32 v[196:197], v[196:197], v[172:173]
  v_pk_fma_f32 v[202:203], v[174:175], v[174:175], v[202:203]
  v_pk_add_f32 v[198:199], v[198:199], v[174:175]
  v_pk_fma_f32 v[200:201], v[176:177], v[176:177], v[200:201]
  v_pk_add_f32 v[196:197], v[196:197], v[176:177]
  v_pk_fma_f32 v[202:203], v[178:179], v[178:179], v[202:203]
  v_pk_add_f32 v[198:199], v[198:199], v[178:179]
  v_pk_fma_f32 v[200:201], v[180:181], v[180:181], v[200:201]
  v_pk_add_f32 v[196:197], v[196:197], v[180:181]
  v_pk_fma_f32 v[202:203], v[182:183], v[182:183], v[202:203]
  v_pk_add_f32 v[198:199], v[198:199], v[182:183]
  v_pk_fma_f32 v[200:201], v[184:185], v[184:185], v[200:201]
  v_pk_add_f32 v[196:197], v[196:197], v[184:185]
  v_pk_fma_f32 v[202:203], v[186:187], v[186:187], v[202:203]
  v_pk_add_f32 v[198:199], v[198:199], v[186:187]
  v_pk_fma_f32 v[200:201], v[188:189], v[188:189], v[200:201]
  v_pk_add_f32 v[196:197], v[196:197], v[188:189]
  v_pk_fma_f32 v[202:203], v[190:191], v[190:191], v[202:203]
  v_pk_add_f32 v[198:199], v[198:199], v[190:191]
  v_pk_fma_f32 v[200:201], v[192:193], v[192:193], v[200:201]
  v_pk_add_f32 v[196:197], v[196:197], v[192:193]
  v_pk_fma_f32 v[202:203], v[194:195], v[194:195], v[202:203]
  v_pk_add_f32 v[198:199], v[198:199], v[194:195]
  v_pk_add_f32 v[196:197], v[196:197], v[198:199]
  v_pk_add_f32 v[200:201], v[200:201], v[202:203]
  v_add_f32 v220, v196, v197
  v_add_f32 v221, v200, v201
  v_mov_b64 v[222:223], v[220:221]
  s_nop 1
  v_permlane32_swap_b32 v220, v222
  v_permlane32_swap_b32 v221, v223
  v_pk_add_f32 v[220:221], v[220:221], v[222:223]
  v_mov_b32 v222, s76
  v_mov_b32 v223, s77
  s_mov_b64 exec, 0xffffffff
  buffer_store_dwordx4 v[220:223], v224, s[60:63], s21 offen sc1
  s_mov_b64 exec, -1
  s_waitcnt lgkmcnt(0)
  s_barrier
  v_mfma_f32_32x32x16_bf16 v[16:31], v[100:103], v[68:71], 0
  ds_read_b128 v[84:87], v52 offset:16384
  ds_read_b64_tr_b16 v[132:133], v63 offset:8192
  ds_read_b64_tr_b16 v[134:135], v63 offset:8704
  v_mfma_f32_32x32x16_bf16 v[32:47], v[104:107], v[68:71], 0
  ds_read_b64_tr_b16 v[136:137], v65 offset:8192
  ds_read_b64_tr_b16 v[138:139], v65 offset:8704
  ds_read_b128 v[88:91], v54 offset:16384
  v_mfma_f32_32x32x16_bf16 v[16:31], v[108:111], v[72:75], v[16:31]
  ds_read_b64_tr_b16 v[140:141], v63 offset:10240
  ds_read_b64_tr_b16 v[142:143], v63 offset:10752
  ds_read_b64_tr_b16 v[144:145], v65 offset:10240
  v_mfma_f32_32x32x16_bf16 v[32:47], v[112:115], v[72:75], v[32:47]
  ds_read_b64_tr_b16 v[146:147], v65 offset:10752
  ds_read_b128 v[92:95], v56 offset:16384
  ds_read_b64_tr_b16 v[148:149], v63 offset:12288
  v_mfma_f32_32x32x16_bf16 v[16:31], v[116:119], v[76:79], v[16:31]
  ds_read_b64_tr_b16 v[150:151], v63 offset:12800
  ds_read_b64_tr_b16 v[152:153], v65 offset:12288
  ds_read_b64_tr_b16 v[154:155], v65 offset:12800
  v_mfma_f32_32x32x16_bf16 v[32:47], v[120:123], v[76:79], v[32:47]
  ds_read_b128 v[96:99], v58 offset:16384
  ds_read_b64_tr_b16 v[156:157], v63 offset:14336
  ds_read_b64_tr_b16 v[158:159], v63 offset:14848
  v_mfma_f32_32x32x16_bf16 v[16:31], v[124:127], v[80:83], v[16:31]
  ds_read_b64_tr_b16 v[160:161], v65 offset:14336
  ds_read_b64_tr_b16 v[162:163], v65 offset:14848
  v_mfma_f32_32x32x16_bf16 v[32:47], v[128:131], v[80:83], v[32:47]
  s_waitcnt lgkmcnt(0)
  s_barrier
  v_mfma_f32_32x32x16_bf16 v[16:31], v[132:135], v[84:87], v[16:31]
  ds_read_b128 v[68:71], v52 offset:32768
  ds_read_b64_tr_b16 v[100:101], v63 offset:16384
  ds_read_b64_tr_b16 v[102:103], v63 offset:16896
  v_mfma_f32_32x32x16_bf16 v[32:47], v[136:139], v[84:87], v[32:47]
  ds_read_b64_tr_b16 v[104:105], v65 offset:16384
  ds_read_b64_tr_b16 v[106:107], v65 offset:16896
  ds_read_b128 v[72:75], v54 offset:32768
  v_mfma_f32_32x32x16_bf16 v[16:31], v[140:143], v[88:91], v[16:31]
  ds_read_b64_tr_b16 v[108:109], v63 offset:18432
  ds_read_b64_tr_b16 v[110:111], v63 offset:18944
  ds_read_b64_tr_b16 v[112:113], v65 offset:18432
  v_mfma_f32_32x32x16_bf16 v[32:47], v[144:147], v[88:91], v[32:47]
  ds_read_b64_tr_b16 v[114:115], v65 offset:18944
  ds_read_b128 v[76:79], v56 offset:32768
  ds_read_b64_tr_b16 v[116:117], v63 offset:20480
  v_mfma_f32_32x32x16_bf16 v[16:31], v[148:151], v[92:95], v[16:31]
  ds_read_b64_tr_b16 v[118:119], v63 offset:20992
  ds_read_b64_tr_b16 v[120:121], v65 offset:20480
  ds_read_b64_tr_b16 v[122:123], v65 offset:20992
  v_mfma_f32_32x32x16_bf16 v[32:47], v[152:155], v[92:95], v[32:47]
  ds_read_b128 v[80:83], v58 offset:32768
  ds_read_b64_tr_b16 v[124:125], v63 offset:22528
  ds_read_b64_tr_b16 v[126:127], v63 offset:23040
  v_mfma_f32_32x32x16_bf16 v[16:31], v[156:159], v[96:99], v[16:31]
  ds_read_b64_tr_b16 v[128:129], v65 offset:22528
  ds_read_b64_tr_b16 v[130:131], v65 offset:23040
  v_mfma_f32_32x32x16_bf16 v[32:47], v[160:163], v[96:99], v[32:47]
  s_waitcnt lgkmcnt(0)
  s_barrier
  v_mfma_f32_32x32x16_bf16 v[16:31], v[100:103], v[68:71], v[16:31]
  ds_read_b128 v[84:87], v52 offset:49152
  ds_read_b64_tr_b16 v[132:133], v63 offset:24576
  ds_read_b64_tr_b16 v[134:135], v63 offset:25088
  v_mfma_f32_32x32x16_bf16 v[32:47], v[104:107], v[68:71], v[32:47]
  ds_read_b64_tr_b16 v[136:137], v65 offset:24576
  ds_read_b64_tr_b16 v[138:139], v65 offset:25088
  ds_read_b128 v[88:91], v54 offset:49152
  v_mfma_f32_32x32x16_bf16 v[16:31], v[108:111], v[72:75], v[16:31]
  ds_read_b64_tr_b16 v[140:141], v63 offset:26624
  ds_read_b64_tr_b16 v[142:143], v63 offset:27136
  ds_read_b64_tr_b16 v[144:145], v65 offset:26624
  v_mfma_f32_32x32x16_bf16 v[32:47], v[112:115], v[72:75], v[32:47]
  ds_read_b64_tr_b16 v[146:147], v65 offset:27136
  ds_read_b128 v[92:95], v56 offset:49152
  ds_read_b64_tr_b16 v[148:149], v63 offset:28672
  v_mfma_f32_32x32x16_bf16 v[16:31], v[116:119], v[76:79], v[16:31]
  ds_read_b64_tr_b16 v[150:151], v63 offset:29184
  ds_read_b64_tr_b16 v[152:153], v65 offset:28672
  ds_read_b64_tr_b16 v[154:155], v65 offset:29184
  v_mfma_f32_32x32x16_bf16 v[32:47], v[120:123], v[76:79], v[32:47]
  ds_read_b128 v[96:99], v58 offset:49152
  ds_read_b64_tr_b16 v[156:157], v63 offset:30720
  ds_read_b64_tr_b16 v[158:159], v63 offset:31232
  v_mfma_f32_32x32x16_bf16 v[16:31], v[124:127], v[80:83], v[16:31]
  ds_read_b64_tr_b16 v[160:161], v65 offset:30720
  ds_read_b64_tr_b16 v[162:163], v65 offset:31232
  v_mfma_f32_32x32x16_bf16 v[32:47], v[128:131], v[80:83], v[32:47]
  s_waitcnt lgkmcnt(0)
  s_barrier
  v_mfma_f32_32x32x16_bf16 v[16:31], v[132:135], v[84:87], v[16:31]
  ds_read_b128 v[68:71], v53 offset:0
  ds_read_b64_tr_b16 v[100:101], v60 offset:0
  ds_read_b64_tr_b16 v[102:103], v60 offset:512
  v_mfma_f32_32x32x16_bf16 v[32:47], v[136:139], v[84:87], v[32:47]
  ds_read_b64_tr_b16 v[104:105], v61 offset:0
  ds_read_b64_tr_b16 v[106:107], v61 offset:512
  ds_read_b128 v[72:75], v55 offset:0
  v_mfma_f32_32x32x16_bf16 v[16:31], v[140:143], v[88:91], v[16:31]
  ds_read_b64_tr_b16 v[108:109], v60 offset:2048
  ds_read_b64_tr_b16 v[110:111], v60 offset:2560
  ds_read_b64_tr_b16 v[112:113], v61 offset:2048
  v_mfma_f32_32x32x16_bf16 v[32:47], v[144:147], v[88:91], v[32:47]
  ds_read_b64_tr_b16 v[114:115], v61 offset:2560
  ds_read_b128 v[76:79], v57 offset:0
  ds_read_b64_tr_b16 v[116:117], v60 offset:4096
  v_mfma_f32_32x32x16_bf16 v[16:31], v[148:151], v[92:95], v[16:31]
  ds_read_b64_tr_b16 v[118:119], v60 offset:4608
  ds_read_b64_tr_b16 v[120:121], v61 offset:4096
  ds_read_b64_tr_b16 v[122:123], v61 offset:4608
  v_mfma_f32_32x32x16_bf16 v[32:47], v[152:155], v[92:95], v[32:47]
  ds_read_b128 v[80:83], v59 offset:0
  ds_read_b64_tr_b16 v[124:125], v60 offset:6144
  ds_read_b64_tr_b16 v[126:127], v60 offset:6656
  v_mfma_f32_32x32x16_bf16 v[16:31], v[156:159], v[96:99], v[16:31]
  ds_read_b64_tr_b16 v[128:129], v61 offset:6144
  ds_read_b64_tr_b16 v[130:131], v61 offset:6656
  v_mfma_f32_32x32x16_bf16 v[32:47], v[160:163], v[96:99], v[32:47]
  s_waitcnt lgkmcnt(0)
  s_barrier
  buffer_load_dwordx4 v[196:199], v225, s[60:63], 0 offen offset:0 sc1
  buffer_load_dwordx4 v[200:203], v225, s[60:63], 0 offen offset:2048 sc1
  buffer_load_dwordx4 v[204:207], v225, s[60:63], s20 offen offset:0 sc1
  buffer_load_dwordx4 v[208:211], v225, s[60:63], s20 offen offset:2048 sc1
  buffer_load_dwordx4 v[212:215], v225, s[60:63], s22 offen offset:0 sc1
  buffer_load_dwordx4 v[216:219], v225, s[60:63], s22 offen offset:2048 sc1
  v_mfma_f32_32x32x16_bf16 v[16:31], v[100:103], v[68:71], v[16:31]
  ds_read_b128 v[84:87], v53 offset:16384
  ds_read_b64_tr_b16 v[132:133], v60 offset:8192
  ds_read_b64_tr_b16 v[134:135], v60 offset:8704
  v_mfma_f32_32x32x16_bf16 v[32:47], v[104:107], v[68:71], v[32:47]
  ds_read_b64_tr_b16 v[136:137], v61 offset:8192
  ds_read_b64_tr_b16 v[138:139], v61 offset:8704
  ds_read_b128 v[88:91], v55 offset:16384
  v_mfma_f32_32x32x16_bf16 v[16:31], v[108:111], v[72:75], v[16:31]
  ds_read_b64_tr_b16 v[140:141], v60 offset:10240
  ds_read_b64_tr_b16 v[142:143], v60 offset:10752
  ds_read_b64_tr_b16 v[144:145], v61 offset:10240
  v_mfma_f32_32x32x16_bf16 v[32:47], v[112:115], v[72:75], v[32:47]
  ds_read_b64_tr_b16 v[146:147], v61 offset:10752
  ds_read_b128 v[92:95], v57 offset:16384
  ds_read_b64_tr_b16 v[148:149], v60 offset:12288
  v_mfma_f32_32x32x16_bf16 v[16:31], v[116:119], v[76:79], v[16:31]
  ds_read_b64_tr_b16 v[150:151], v60 offset:12800
  ds_read_b64_tr_b16 v[152:153], v61 offset:12288
  ds_read_b64_tr_b16 v[154:155], v61 offset:12800
  v_mfma_f32_32x32x16_bf16 v[32:47], v[120:123], v[76:79], v[32:47]
  ds_read_b128 v[96:99], v59 offset:16384
  ds_read_b64_tr_b16 v[156:157], v60 offset:14336
  ds_read_b64_tr_b16 v[158:159], v60 offset:14848
  v_mfma_f32_32x32x16_bf16 v[16:31], v[124:127], v[80:83], v[16:31]
  ds_read_b64_tr_b16 v[160:161], v61 offset:14336
  ds_read_b64_tr_b16 v[162:163], v61 offset:14848
  v_mfma_f32_32x32x16_bf16 v[32:47], v[128:131], v[80:83], v[32:47]
  s_waitcnt lgkmcnt(0)
  s_barrier
  v_mfma_f32_32x32x16_bf16 v[16:31], v[132:135], v[84:87], v[16:31]
  ds_read_b128 v[68:71], v53 offset:32768
  ds_read_b64_tr_b16 v[100:101], v63 offset:0
  ds_read_b64_tr_b16 v[102:103], v63 offset:512
  v_mfma_f32_32x32x16_bf16 v[32:47], v[136:139], v[84:87], v[32:47]
  ds_read_b64_tr_b16 v[104:105], v65 offset:0
  ds_read_b64_tr_b16 v[106:107], v65 offset:512
  ds_read_b128 v[72:75], v55 offset:32768
  v_mfma_f32_32x32x16_bf16 v[16:31], v[140:143], v[88:91], v[16:31]
  ds_read_b64_tr_b16 v[108:109], v63 offset:2048
  ds_read_b64_tr_b16 v[110:111], v63 offset:2560
  ds_read_b64_tr_b16 v[112:113], v65 offset:2048
  v_mfma_f32_32x32x16_bf16 v[32:47], v[144:147], v[88:91], v[32:47]
  ds_read_b64_tr_b16 v[114:115], v65 offset:2560
  ds_read_b128 v[76:79], v57 offset:32768
  ds_read_b64_tr_b16 v[116:117], v63 offset:4096
  v_mfma_f32_32x32x16_bf16 v[16:31], v[148:151], v[92:95], v[16:31]
  ds_read_b64_tr_b16 v[118:119], v63 offset:4608
  ds_read_b64_tr_b16 v[120:121], v65 offset:4096
  ds_read_b64_tr_b16 v[122:123], v65 offset:4608
  v_mfma_f32_32x32x16_bf16 v[32:47], v[152:155], v[92:95], v[32:47]
  ds_read_b128 v[80:83], v59 offset:32768
  ds_read_b64_tr_b16 v[124:125], v63 offset:6144
  ds_read_b64_tr_b16 v[126:127], v63 offset:6656
  v_mfma_f32_32x32x16_bf16 v[16:31], v[156:159], v[96:99], v[16:31]
  ds_read_b64_tr_b16 v[128:129], v65 offset:6144
  ds_read_b64_tr_b16 v[130:131], v65 offset:6656
  v_mfma_f32_32x32x16_bf16 v[32:47], v[160:163], v[96:99], v[32:47]
  s_waitcnt lgkmcnt(0)
  s_barrier
  s_mov_b32 s85, 0x40000
  s_branch pollchk_41
poll_39:
  buffer_load_dwordx4 v[196:199], v225, s[60:63], 0 offen offset:0 sc1
  buffer_load_dwordx4 v[200:203], v225, s[60:63], 0 offen offset:2048 sc1
  buffer_load_dwordx4 v[204:207], v225, s[60:63], s20 offen offset:0 sc1
  buffer_load_dwordx4 v[208:211], v225, s[60:63], s20 offen offset:2048 sc1
  buffer_load_dwordx4 v[212:215], v225, s[60:63], s22 offen offset:0 sc1
  buffer_load_dwordx4 v[216:219], v225, s[60:63], s22 offen offset:2048 sc1
pollchk_41:
  s_mov_b64 s[14:15], -1
  s_waitcnt vmcnt(0)
  v_cmp_eq_u32 vcc, s76, v198
  v_cmp_eq_u32 s[12:13], s77, v199
  s_and_b64 vcc, vcc, s[12:13]
  s_and_b64 s[14:15], s[14:15], vcc
  v_cmp_eq_u32 vcc, s76, v202
  v_cmp_eq_u32 s[12:13], s77, v203
  s_and_b64 vcc, vcc, s[12:13]
  s_and_b64 s[14:15], s[14:15], vcc
  v_cmp_eq_u32 vcc, s76, v206
  v_cmp_eq_u32 s[12:13], s77, v207
  s_and_b64 vcc, vcc, s[12:13]
  s_and_b64 s[14:15], s[14:15], vcc
  v_cmp_eq_u32 vcc, s76, v210
  v_cmp_eq_u32 s[12:13], s77, v211
  s_and_b64 vcc, vcc, s[12:13]
  s_and_b64 s[14:15], s[14:15], vcc
  v_cmp_eq_u32 vcc, s76, v214
  v_cmp_eq_u32 s[12:13], s77, v215
  s_and_b64 vcc, vcc, s[12:13]
  s_and_b64 s[14:15], s[14:15], vcc
  v_cmp_eq_u32 vcc, s76, v218
  v_cmp_eq_u32 s[12:13], s77, v219
  s_and_b64 vcc, vcc, s[12:13]
  s_and_b64 s[14:15], s[14:15], vcc
  s_cmp_eq_u64 s[14:15], -1
  s_cbranch_scc1 polled_40
  s_sub_u32 s85, s85, 1
  s_cbranch_scc1 polled_40
  s_sleep 1
  s_branch poll_39
polled_40:
  s_mov_b64 exec, 0xffffffff
  v_pk_add_f32 v[200:201], v[200:201], v[196:197]
  s_mov_b64 exec, -1
  v_pk_add_f32 v[204:205], v[204:205], v[208:209]
  v_pk_add_f32 v[212:213], v[212:213], v[216:217]
  v_pk_add_f32 v[200:201], v[200:201], v[204:205]
  v_pk_add_f32 v[196:197], v[200:201], v[212:213]
  v_mov_b64 v[198:199], v[196:197]
  s_nop 1
  v_permlane32_swap_b32 v196, v198
  v_permlane32_swap_b32 v197, v199
  v_pk_add_f32 v[196:197], v[196:197], v[198:199]
  v_mul_f32 v196, 0x3abe82fa, v196
  v_mul_f32 v197, 0x3abe82fa, v197
  v_fma_f32 v197, -v196, v196, v197
  v_max_f32 v197, 0, v197
  v_add_f32 v197, 0x3727c5ac, v197
  v_rsq_f32 v220, v197
  s_nop 0
  v_mul_f32 v221, -v196, v220
  v_pk_fma_f32 v[164:165], v[164:165], v[220:221], v[220:221] op_sel:[0,0,1] op_sel_hi:[1,0,1]
  v_pk_fma_f32 v[166:167], v[166:167], v[220:221], v[220:221] op_sel:[0,0,1] op_sel_hi:[1,0,1]
  v_pk_fma_f32 v[168:169], v[168:169], v[220:221], v[220:221] op_sel:[0,0,1] op_sel_hi:[1,0,1]
  v_pk_fma_f32 v[170:171], v[170:171], v[220:221], v[220:221] op_sel:[0,0,1] op_sel_hi:[1,0,1]
  v_cvt_pk_bf16_f32 v164, v164, v165
  v_cvt_pk_bf16_f32 v165, v166, v167
  v_cvt_pk_bf16_f32 v166, v168, v169
  v_cvt_pk_bf16_f32 v167, v170, v171
  buffer_store_dwordx4 v[164:167], v226, s[60:63], s24 offen offset:0 sc1
  v_pk_fma_f32 v[172:173], v[172:173], v[220:221], v[220:221] op_sel:[0,0,1] op_sel_hi:[1,0,1]
  v_pk_fma_f32 v[174:175], v[174:175], v[220:221], v[220:221] op_sel:[0,0,1] op_sel_hi:[1,0,1]
  v_pk_fma_f32 v[176:177], v[176:177], v[220:221], v[220:221] op_sel:[0,0,1] op_sel_hi:[1,0,1]
  v_pk_fma_f32 v[178:179], v[178:179], v[220:221], v[220:221] op_sel:[0,0,1] op_sel_hi:[1,0,1]
  v_cvt_pk_bf16_f32 v172, v172, v173
  v_cvt_pk_bf16_f32 v173, v174, v175
  v_cvt_pk_bf16_f32 v174, v176, v177
  v_cvt_pk_bf16_f32 v175, v178, v179
  buffer_store_dwordx4 v[172:175], v227, s[60:63], s24 offen offset:2048 sc1
  v_pk_fma_f32 v[180:181], v[180:181], v[220:221], v[220:221] op_sel:[0,0,1] op_sel_hi:[1,0,1]
  v_pk_fma_f32 v[182:183], v[182:183], v[220:221], v[220:221] op_sel:[0,0,1] op_sel_hi:[1,0,1]
  v_pk_fma_f32 v[184:185], v[184:185], v[220:221], v[220:221] op_sel:[0,0,1] op_sel_hi:[1,0,1]
  v_pk_fma_f32 v[186:187], v[186:187], v[220:221], v[220:221] op_sel:[0,0,1] op_sel_hi:[1,0,1]
  v_cvt_pk_bf16_f32 v180, v180, v181
  v_cvt_pk_bf16_f32 v181, v182, v183
  v_cvt_pk_bf16_f32 v182, v184, v185
  v_cvt_pk_bf16_f32 v183, v186, v187
  buffer_store_dwordx4 v[180:183], v226, s[60:63], s25 offen offset:0 sc1
  v_pk_fma_f32 v[188:189], v[188:189], v[220:221], v[220:221] op_sel:[0,0,1] op_sel_hi:[1,0,1]
  v_pk_fma_f32 v[190:191], v[190:191], v[220:221], v[220:221] op_sel:[0,0,1] op_sel_hi:[1,0,1]
  v_pk_fma_f32 v[192:193], v[192:193], v[220:221], v[220:221] op_sel:[0,0,1] op_sel_hi:[1,0,1]
  v_pk_fma_f32 v[194:195], v[194:195], v[220:221], v[220:221] op_sel:[0,0,1] op_sel_hi:[1,0,1]
  v_cvt_pk_bf16_f32 v188, v188, v189
  v_cvt_pk_bf16_f32 v189, v190, v191
  v_cvt_pk_bf16_f32 v190, v192, v193
  v_cvt_pk_bf16_f32 v191, v194, v195
  buffer_store_dwordx4 v[188:191], v227, s[60:63], s25 offen offset:2048 sc1
  v_mfma_f32_32x32x16_bf16 v[16:31], v[100:103], v[68:71], v[16:31]
  ds_read_b128 v[84:87], v53 offset:49152
  ds_read_b64_tr_b16 v[132:133], v63 offset:8192
  ds_read_b64_tr_b16 v[134:135], v63 offset:8704
  v_mfma_f32_32x32x16_bf16 v[32:47], v[104:107], v[68:71], v[32:47]
  ds_read_b64_tr_b16 v[136:137], v65 offset:8192
  ds_read_b64_tr_b16 v[138:139], v65 offset:8704
  ds_read_b128 v[88:91], v55 offset:49152
  v_mfma_f32_32x32x16_bf16 v[16:31], v[108:111], v[72:75], v[16:31]
  ds_read_b64_tr_b16 v[140:141], v63 offset:10240
  ds_read_b64_tr_b16 v[142:143], v63 offset:10752
  ds_read_b64_tr_b16 v[144:145], v65 offset:10240
  v_mfma_f32_32x32x16_bf16 v[32:47], v[112:115], v[72:75], v[32:47]
  ds_read_b64_tr_b16 v[146:147], v65 offset:10752
  ds_read_b128 v[92:95], v57 offset:49152
  ds_read_b64_tr_b16 v[148:149], v63 offset:12288
  v_mfma_f32_32x32x16_bf16 v[16:31], v[116:119], v[76:79], v[16:31]
  ds_read_b64_tr_b16 v[150:151], v63 offset:12800
  ds_read_b64_tr_b16 v[152:153], v65 offset:12288
  ds_read_b64_tr_b16 v[154:155], v65 offset:12800
  v_mfma_f32_32x32x16_bf16 v[32:47], v[120:123], v[76:79], v[32:47]
  ds_read_b128 v[96:99], v59 offset:49152
  ds_read_b64_tr_b16 v[156:157], v63 offset:14336
  ds_read_b64_tr_b16 v[158:159], v63 offset:14848
  v_mfma_f32_32x32x16_bf16 v[16:31], v[124:127], v[80:83], v[16:31]
  ds_read_b64_tr_b16 v[160:161], v65 offset:14336
  ds_read_b64_tr_b16 v[162:163], v65 offset:14848
  v_mfma_f32_32x32x16_bf16 v[32:47], v[128:131], v[80:83], v[32:47]
  s_waitcnt lgkmcnt(0)
  s_barrier
  v_mfma_f32_32x32x16_bf16 v[16:31], v[132:135], v[84:87], v[16:31]
  v_mfma_f32_32x32x16_bf16 v[32:47], v[136:139], v[84:87], v[32:47]
  v_mfma_f32_32x32x16_bf16 v[16:31], v[140:143], v[88:91], v[16:31]
  v_mfma_f32_32x32x16_bf16 v[32:47], v[144:147], v[88:91], v[32:47]
  v_mfma_f32_32x32x16_bf16 v[16:31], v[148:151], v[92:95], v[16:31]
  v_mfma_f32_32x32x16_bf16 v[32:47], v[152:155], v[92:95], v[32:47]
  v_mfma_f32_32x32x16_bf16 v[16:31], v[156:159], v[96:99], v[16:31]
  v_mfma_f32_32x32x16_bf16 v[32:47], v[160:163], v[96:99], v[32:47]
  v_mov_b32 v2, 0x27ff0
  v_mov_b32 v3, 0
  ds_write_b32 v2, v3
  s_waitcnt lgkmcnt(0)
  s_barrier
  v_mov_b32 v4, s76
  v_mov_b32 v5, s77
  v_mov_b32 v6, 0x27ff0
  v_mov_b32 v7, 1
  s_mov_b64 exec, 1
  s_waitcnt vmcnt(0)
  ds_add_rtn_u32 v7, v6, v7
  s_mov_b64 exec, 0xffff
  v_lshlrev_b32 v6, 3, v1
  s_waitcnt lgkmcnt(0)
  v_readfirstlane_b32 s15, v7
  s_cmp_lg_u32 s15, 3
  s_cbranch_scc1 notlast_42
  buffer_store_dwordx2 v[4:5], v6, s[60:63], s23 offen sc1
notlast_42:
  s_mov_b64 exec, -1
  v_bfe_u32 v2, v1, 4, 1
  v_bfe_u32 v3, v1, 2, 2
  v_lshl_add_u32 v3, v2, 2, v3
  v_lshl_add_u32 v3, v13, 3, v3
  v_lshlrev_b32 v3, 5, v3
  v_lshl_add_u32 v3, v2, 11, v3
  v_and_b32 v2, 1, v1
  v_lshl_add_u32 v3, v2, 4, v3
  v_bfe_u32 v2, v1, 1, 1
  v_lshl_add_u32 v60, v2, 3, v3
  v_xor_b32 v61, 128, v60
  v_add_u32 v62, 0x10000, v60
  v_add_u32 v63, 0x20000, v60
  v_add_u32 v64, 0x10000, v61
  v_add_u32 v65, 0x20000, v61
  s_lshl2_add_u32 s11, s4, s3
  s_lshl_b32 s12, s11, 6
  v_lshl_add_u32 v9, v12, 1, s12
  v_lshlrev_b32 v68, 4, v1
  s_mul_i32 s11, s11, 44
  s_lshl2_add_u32 s11, s8, s11
  s_lshl_b32 s16, s11, 10
  s_add_u32 s16, s16, 0xa00000
  s_lshl_b32 s11, s8, 11
  s_add_u32 s11, s11, 0x1140000
  v_lshl_add_u32 v8, v1, 7, s11
  s_barrier
  ds_read_b128 v[72:75], v52 offset:0
  ds_read_b128 v[76:79], v54 offset:0
  ds_read_b128 v[80:83], v56 offset:0
  ds_read_b128 v[84:87], v58 offset:0
  ds_read_b128 v[88:91], v52 offset:16384
  ds_read_b128 v[92:95], v54 offset:16384
  ds_read_b128 v[96:99], v56 offset:16384
  ds_read_b128 v[100:103], v58 offset:16384
  ds_read_b128 v[104:107], v52 offset:32768
  ds_read_b128 v[108:111], v54 offset:32768
  ds_read_b128 v[112:115], v56 offset:32768
  ds_read_b128 v[116:119], v58 offset:32768
  s_waitcnt lgkmcnt(0)
  s_barrier
  s_cmp_lg_u32 s3, 0
  s_cbranch_scc1 nopoll_43
  s_lshr_b32 s11, s2, 5
  s_mul_i32 s11, s11, 2
  s_lshl_b32 s18, 15, s11
  s_mov_b32 s19, 0
  s_mov_b32 s85, 0x40000
  s_mov_b64 exec, s[18:19]
fpoll_44:
  buffer_load_dwordx2 v[4:5], v8, s[60:63], 0 offen sc1
fchk_46:
  s_waitcnt vmcnt(0)
  v_cmp_ne_u64 vcc, s[76:77], v[4:5]
  s_and_b64 exec, exec, vcc
  s_cbranch_execz fdone_45
  s_sub_u32 s85, s85, 1
  s_cbranch_scc1 fdone_45
  s_sleep 2
  s_branch fpoll_44
fdone_45:
  s_mov_b64 exec, -1
  s_mov_b64 exec, 0xffff
  buffer_load_dwordx2 v[4:5], v8, s[60:63], 0 offen sc1
  s_mov_b64 exec, -1
nopoll_43:
  s_waitcnt lgkmcnt(0)
  s_barrier
  global_load_ushort v66, v9, s[40:41]
  s_barrier
  ds_read_b128 v[152:155], v52 offset:49152
  ds_read_b64_tr_b16 v[184:185], v62 offset:49152
  ds_read_b64_tr_b16 v[186:187], v64 offset:49152
  ds_read_b64_tr_b16 v[188:189], v62 offset:53248
  ds_read_b64_tr_b16 v[190:191], v64 offset:53248
  ds_read_b128 v[156:159], v54 offset:49152
  ds_read_b64_tr_b16 v[192:193], v62 offset:49664
  ds_read_b64_tr_b16 v[194:195], v64 offset:49664
  ds_read_b64_tr_b16 v[196:197], v62 offset:53760
  ds_read_b64_tr_b16 v[198:199], v64 offset:53760
  ds_read_b128 v[160:163], v56 offset:49152
  ds_read_b64_tr_b16 v[200:201], v62 offset:50176
  ds_read_b64_tr_b16 v[202:203], v64 offset:50176
  ds_read_b64_tr_b16 v[204:205], v62 offset:54272
  ds_read_b64_tr_b16 v[206:207], v64 offset:54272
  ds_read_b128 v[164:167], v58 offset:49152
  ds_read_b64_tr_b16 v[208:209], v62 offset:50688
  ds_read_b64_tr_b16 v[210:211], v64 offset:50688
  ds_read_b64_tr_b16 v[212:213], v62 offset:54784
  ds_read_b64_tr_b16 v[214:215], v64 offset:54784
  s_waitcnt lgkmcnt(0)
  s_barrier
  v_mfma_f32_32x32x16_bf16 v[120:135], v[184:187], v[152:155], 0
  ds_read_b128 v[168:171], v53 offset:0
  ds_read_b64_tr_b16 v[216:217], v62 offset:57344
  ds_read_b64_tr_b16 v[218:219], v64 offset:57344
  v_mfma_f32_32x32x16_bf16 v[136:151], v[188:191], v[152:155], 0
  ds_read_b64_tr_b16 v[220:221], v62 offset:61440
  ds_read_b64_tr_b16 v[222:223], v64 offset:61440
  ds_read_b128 v[172:175], v55 offset:0
  v_mfma_f32_32x32x16_bf16 v[120:135], v[192:195], v[156:159], v[120:135]
  ds_read_b64_tr_b16 v[224:225], v62 offset:57856
  ds_read_b64_tr_b16 v[226:227], v64 offset:57856
  ds_read_b64_tr_b16 v[228:229], v62 offset:61952
  v_mfma_f32_32x32x16_bf16 v[136:151], v[196:199], v[156:159], v[136:151]
  ds_read_b64_tr_b16 v[230:231], v64 offset:61952
  ds_read_b128 v[176:179], v57 offset:0
  ds_read_b64_tr_b16 v[232:233], v62 offset:58368
  v_mfma_f32_32x32x16_bf16 v[120:135], v[200:203], v[160:163], v[120:135]
  ds_read_b64_tr_b16 v[234:235], v64 offset:58368
  ds_read_b64_tr_b16 v[236:237], v62 offset:62464
  ds_read_b64_tr_b16 v[238:239], v64 offset:62464
  v_mfma_f32_32x32x16_bf16 v[136:151], v[204:207], v[160:163], v[136:151]
  ds_read_b128 v[180:183], v59 offset:0
  ds_read_b64_tr_b16 v[240:241], v62 offset:58880
  ds_read_b64_tr_b16 v[242:243], v64 offset:58880
  v_mfma_f32_32x32x16_bf16 v[120:135], v[208:211], v[164:167], v[120:135]
  ds_read_b64_tr_b16 v[244:245], v62 offset:62976
  ds_read_b64_tr_b16 v[246:247], v64 offset:62976
  v_mfma_f32_32x32x16_bf16 v[136:151], v[212:215], v[164:167], v[136:151]
  s_waitcnt lgkmcnt(0)
  s_barrier
  v_mfma_f32_32x32x16_bf16 v[120:135], v[216:219], v[168:171], v[120:135]
  ds_read_b64_tr_b16 v[184:185], v63 offset:0
  ds_read_b64_tr_b16 v[186:187], v65 offset:0
  ds_read_b64_tr_b16 v[188:189], v63 offset:4096
  v_mfma_f32_32x32x16_bf16 v[136:151], v[220:223], v[168:171], v[136:151]
  ds_read_b64_tr_b16 v[190:191], v65 offset:4096
  ds_read_b64_tr_b16 v[192:193], v63 offset:512
  ds_read_b64_tr_b16 v[194:195], v65 offset:512
  v_mfma_f32_32x32x16_bf16 v[120:135], v[224:227], v[172:175], v[120:135]
  ds_read_b64_tr_b16 v[196:197], v63 offset:4608
  ds_read_b64_tr_b16 v[198:199], v65 offset:4608
  ds_read_b64_tr_b16 v[200:201], v63 offset:1024
  v_mfma_f32_32x32x16_bf16 v[136:151], v[228:231], v[172:175], v[136:151]
  ds_read_b64_tr_b16 v[202:203], v65 offset:1024
  ds_read_b64_tr_b16 v[204:205], v63 offset:5120
  ds_read_b64_tr_b16 v[206:207], v65 offset:5120
  v_mfma_f32_32x32x16_bf16 v[120:135], v[232:235], v[176:179], v[120:135]
  ds_read_b64_tr_b16 v[208:209], v63 offset:1536
  ds_read_b64_tr_b16 v[210:211], v65 offset:1536
  ds_read_b64_tr_b16 v[212:213], v63 offset:5632
  v_mfma_f32_32x32x16_bf16 v[136:151], v[236:239], v[176:179], v[136:151]
  ds_read_b64_tr_b16 v[214:215], v65 offset:5632
  v_mfma_f32_32x32x16_bf16 v[120:135], v[240:243], v[180:183], v[120:135]
  v_mfma_f32_32x32x16_bf16 v[136:151], v[244:247], v[180:183], v[136:151]
  s_cmp_lg_u32 s3, 0
  s_cbranch_scc1 nopoll_47
  s_mov_b32 s85, 0x40000
  s_mov_b64 exec, 0xffff
  s_branch fchk_50
fpoll_48:
  buffer_load_dwordx2 v[4:5], v8, s[60:63], 0 offen sc1
fchk_50:
  s_waitcnt vmcnt(0)
  v_cmp_ne_u64 vcc, s[76:77], v[4:5]
  s_and_b64 exec, exec, vcc
  s_cbranch_execz fdone_49
  s_sub_u32 s85, s85, 1
  s_cbranch_scc1 fdone_49
  s_sleep 2
  s_branch fpoll_48
fdone_49:
  s_mov_b64 exec, -1
nopoll_47:
  s_waitcnt lgkmcnt(0)
  s_barrier
  v_mfma_f32_32x32x16_bf16 v[120:135], v[184:187], v[72:75], v[120:135]
  ds_read_b128 v[168:171], v53 offset:16384
  ds_read_b64_tr_b16 v[216:217], v63 offset:8192
  ds_read_b64_tr_b16 v[218:219], v65 offset:8192
  v_mfma_f32_32x32x16_bf16 v[136:151], v[188:191], v[72:75], v[136:151]
  ds_read_b64_tr_b16 v[220:221], v63 offset:12288
  ds_read_b64_tr_b16 v[222:223], v65 offset:12288
  ds_read_b128 v[172:175], v55 offset:16384
  v_mfma_f32_32x32x16_bf16 v[120:135], v[192:195], v[76:79], v[120:135]
  ds_read_b64_tr_b16 v[224:225], v63 offset:8704
  ds_read_b64_tr_b16 v[226:227], v65 offset:8704
  ds_read_b64_tr_b16 v[228:229], v63 offset:12800
  v_mfma_f32_32x32x16_bf16 v[136:151], v[196:199], v[76:79], v[136:151]
  ds_read_b64_tr_b16 v[230:231], v65 offset:12800
  ds_read_b128 v[176:179], v57 offset:16384
  ds_read_b64_tr_b16 v[232:233], v63 offset:9216
  v_mfma_f32_32x32x16_bf16 v[120:135], v[200:203], v[80:83], v[120:135]
  ds_read_b64_tr_b16 v[234:235], v65 offset:9216
  ds_read_b64_tr_b16 v[236:237], v63 offset:13312
  ds_read_b64_tr_b16 v[238:239], v65 offset:13312
  v_mfma_f32_32x32x16_bf16 v[136:151], v[204:207], v[80:83], v[136:151]
  ds_read_b128 v[180:183], v59 offset:16384
  ds_read_b64_tr_b16 v[240:241], v63 offset:9728
  ds_read_b64_tr_b16 v[242:243], v65 offset:9728
  v_mfma_f32_32x32x16_bf16 v[120:135], v[208:211], v[84:87], v[120:135]
  ds_read_b64_tr_b16 v[244:245], v63 offset:13824
  ds_read_b64_tr_b16 v[246:247], v65 offset:13824
  v_mfma_f32_32x32x16_bf16 v[136:151], v[212:215], v[84:87], v[136:151]
  s_waitcnt lgkmcnt(0)
  s_barrier
  v_mfma_f32_32x32x16_bf16 v[120:135], v[216:219], v[168:171], v[120:135]
  ds_read_b128 v[152:155], v53 offset:32768
  ds_read_b64_tr_b16 v[184:185], v63 offset:16384
  ds_read_b64_tr_b16 v[186:187], v65 offset:16384
  v_mfma_f32_32x32x16_bf16 v[136:151], v[220:223], v[168:171], v[136:151]
  ds_read_b64_tr_b16 v[188:189], v63 offset:20480
  ds_read_b64_tr_b16 v[190:191], v65 offset:20480
  ds_read_b128 v[156:159], v55 offset:32768
  v_mfma_f32_32x32x16_bf16 v[120:135], v[224:227], v[172:175], v[120:135]
  ds_read_b64_tr_b16 v[192:193], v63 offset:16896
  ds_read_b64_tr_b16 v[194:195], v65 offset:16896
  ds_read_b64_tr_b16 v[196:197], v63 offset:20992
  v_mfma_f32_32x32x16_bf16 v[136:151], v[228:231], v[172:175], v[136:151]
  ds_read_b64_tr_b16 v[198:199], v65 offset:20992
  ds_read_b128 v[160:163], v57 offset:32768
  ds_read_b64_tr_b16 v[200:201], v63 offset:17408
  v_mfma_f32_32x32x16_bf16 v[120:135], v[232:235], v[176:179], v[120:135]
  ds_read_b64_tr_b16 v[202:203], v65 offset:17408
  ds_read_b64_tr_b16 v[204:205], v63 offset:21504
  ds_read_b64_tr_b16 v[206:207], v65 offset:21504
  v_mfma_f32_32x32x16_bf16 v[136:151], v[236:239], v[176:179], v[136:151]
  ds_read_b128 v[164:167], v59 offset:32768
  ds_read_b64_tr_b16 v[208:209], v63 offset:17920
  ds_read_b64_tr_b16 v[210:211], v65 offset:17920
  v_mfma_f32_32x32x16_bf16 v[120:135], v[240:243], v[180:183], v[120:135]
  ds_read_b64_tr_b16 v[212:213], v63 offset:22016
  ds_read_b64_tr_b16 v[214:215], v65 offset:22016
  v_mfma_f32_32x32x16_bf16 v[136:151], v[244:247], v[180:183], v[136:151]
  s_waitcnt lgkmcnt(0)
  s_barrier
  v_mfma_f32_32x32x16_bf16 v[120:135], v[184:187], v[152:155], v[120:135]
  ds_read_b64_tr_b16 v[216:217], v63 offset:24576
  ds_read_b64_tr_b16 v[218:219], v65 offset:24576
  ds_read_b64_tr_b16 v[220:221], v63 offset:28672
  v_mfma_f32_32x32x16_bf16 v[136:151], v[188:191], v[152:155], v[136:151]
  ds_read_b64_tr_b16 v[222:223], v65 offset:28672
  ds_read_b64_tr_b16 v[224:225], v63 offset:25088
  ds_read_b64_tr_b16 v[226:227], v65 offset:25088
  v_mfma_f32_32x32x16_bf16 v[120:135], v[192:195], v[156:159], v[120:135]
  ds_read_b64_tr_b16 v[228:229], v63 offset:29184
  ds_read_b64_tr_b16 v[230:231], v65 offset:29184
  ds_read_b64_tr_b16 v[232:233], v63 offset:25600
  v_mfma_f32_32x32x16_bf16 v[136:151], v[196:199], v[156:159], v[136:151]
  ds_read_b64_tr_b16 v[234:235], v65 offset:25600
  ds_read_b64_tr_b16 v[236:237], v63 offset:29696
  ds_read_b64_tr_b16 v[238:239], v65 offset:29696
  v_mfma_f32_32x32x16_bf16 v[120:135], v[200:203], v[160:163], v[120:135]
  ds_read_b64_tr_b16 v[240:241], v63 offset:26112
  ds_read_b64_tr_b16 v[242:243], v65 offset:26112
  ds_read_b64_tr_b16 v[244:245], v63 offset:30208
  v_mfma_f32_32x32x16_bf16 v[136:151], v[204:207], v[160:163], v[136:151]
  ds_read_b64_tr_b16 v[246:247], v65 offset:30208
  v_mfma_f32_32x32x16_bf16 v[120:135], v[208:211], v[164:167], v[120:135]
  v_mfma_f32_32x32x16_bf16 v[136:151], v[212:215], v[164:167], v[136:151]
  s_waitcnt lgkmcnt(0)
  s_barrier
  v_mfma_f32_32x32x16_bf16 v[120:135], v[216:219], v[88:91], v[120:135]
  ds_read_b128 v[152:155], v52 offset:0
  ds_read_b64_tr_b16 v[184:185], v62 offset:49152
  ds_read_b64_tr_b16 v[186:187], v64 offset:49152
  v_mfma_f32_32x32x16_bf16 v[136:151], v[220:223], v[88:91], v[136:151]
  ds_read_b64_tr_b16 v[188:189], v62 offset:53248
  ds_read_b64_tr_b16 v[190:191], v64 offset:53248
  ds_read_b128 v[156:159], v54 offset:0
  v_mfma_f32_32x32x16_bf16 v[120:135], v[224:227], v[92:95], v[120:135]
  ds_read_b64_tr_b16 v[192:193], v62 offset:49664
  ds_read_b64_tr_b16 v[194:195], v64 offset:49664
  ds_read_b64_tr_b16 v[196:197], v62 offset:53760
  v_mfma_f32_32x32x16_bf16 v[136:151], v[228:231], v[92:95], v[136:151]
  ds_read_b64_tr_b16 v[198:199], v64 offset:53760
  ds_read_b128 v[160:163], v56 offset:0
  ds_read_b64_tr_b16 v[200:201], v62 offset:50176
  v_mfma_f32_32x32x16_bf16 v[120:135], v[232:235], v[96:99], v[120:135]
  ds_read_b64_tr_b16 v[202:203], v64 offset:50176
  ds_read_b64_tr_b16 v[204:205], v62 offset:54272
  ds_read_b64_tr_b16 v[206:207], v64 offset:54272
  v_mfma_f32_32x32x16_bf16 v[136:151], v[236:239], v[96:99], v[136:151]
  ds_read_b128 v[164:167], v58 offset:0
  ds_read_b64_tr_b16 v[208:209], v62 offset:50688
  ds_read_b64_tr_b16 v[210:211], v64 offset:50688
  v_mfma_f32_32x32x16_bf16 v[120:135], v[240:243], v[100:103], v[120:135]
  ds_read_b64_tr_b16 v[212:213], v62 offset:54784
  ds_read_b64_tr_b16 v[214:215], v64 offset:54784
  v_mfma_f32_32x32x16_bf16 v[136:151], v[244:247], v[100:103], v[136:151]
  s_waitcnt lgkmcnt(0)
  s_barrier
  v_mfma_f32_32x32x16_bf16 v[120:135], v[184:187], v[152:155], v[120:135]
  ds_read_b128 v[168:171], v52 offset:16384
  ds_read_b64_tr_b16 v[216:217], v62 offset:57344
  ds_read_b64_tr_b16 v[218:219], v64 offset:57344
  v_cvt_pk_bf16_f32 v17, v16, v17
  v_lshlrev_b32 v16, 16, v17
  v_mfma_f32_32x32x16_bf16 v[136:151], v[188:191], v[152:155], v[136:151]
  ds_read_b64_tr_b16 v[220:221], v62 offset:61440
  ds_read_b64_tr_b16 v[222:223], v64 offset:61440
  ds_read_b128 v[172:175], v54 offset:16384
  v_and_b32 v17, 0xffff0000, v17
  v_pk_mul_f32 v[6:7], v[16:17], v[16:17]
  v_mfma_f32_32x32x16_bf16 v[120:135], v[192:195], v[156:159], v[120:135]
  ds_read_b64_tr_b16 v[224:225], v62 offset:57856
  ds_read_b64_tr_b16 v[226:227], v64 offset:57856
  ds_read_b64_tr_b16 v[228:229], v62 offset:61952
  v_pk_fma_f32 v[6:7], v[6:7], v[48:49], v[48:49] op_sel:[0,0,1] op_sel_hi:[1,0,1]
  v_pk_mul_f32 v[6:7], v[6:7], v[16:17]
  v_mfma_f32_32x32x16_bf16 v[136:151], v[196:199], v[156:159], v[136:151]
  ds_read_b64_tr_b16 v[230:231], v64 offset:61952
  ds_read_b128 v[176:179], v56 offset:16384
  ds_read_b64_tr_b16 v[232:233], v62 offset:58368
  v_exp_f32 v6, v6
  v_exp_f32 v7, v7
  v_mfma_f32_32x32x16_bf16 v[120:135], v[200:203], v[160:163], v[120:135]
  ds_read_b64_tr_b16 v[234:235], v64 offset:58368
  ds_read_b64_tr_b16 v[236:237], v62 offset:62464
  ds_read_b64_tr_b16 v[238:239], v64 offset:62464
  s_nop 0
  v_pk_add_f32 v[6:7], v[6:7], v[50:51] op_sel_hi:[1,0]
  v_mfma_f32_32x32x16_bf16 v[136:151], v[204:207], v[160:163], v[136:151]
  ds_read_b128 v[180:183], v58 offset:16384
  ds_read_b64_tr_b16 v[240:241], v62 offset:58880
  ds_read_b64_tr_b16 v[242:243], v64 offset:58880
  v_rcp_f32 v6, v6
  v_rcp_f32 v7, v7
  v_mfma_f32_32x32x16_bf16 v[120:135], v[208:211], v[164:167], v[120:135]
  ds_read_b64_tr_b16 v[244:245], v62 offset:62976
  ds_read_b64_tr_b16 v[246:247], v64 offset:62976
  s_nop 0
  v_pk_mul_f32 v[16:17], v[16:17], v[6:7]
  v_mfma_f32_32x32x16_bf16 v[136:151], v[212:215], v[164:167], v[136:151]
  s_waitcnt lgkmcnt(0)
  s_barrier
  v_mfma_f32_32x32x16_bf16 v[120:135], v[216:219], v[168:171], v[120:135]
  ds_read_b64_tr_b16 v[184:185], v63 offset:0
  ds_read_b64_tr_b16 v[186:187], v65 offset:0
  ds_read_b64_tr_b16 v[188:189], v63 offset:4096
  v_cvt_pk_bf16_f32 v19, v18, v19
  v_lshlrev_b32 v18, 16, v19
  v_mfma_f32_32x32x16_bf16 v[136:151], v[220:223], v[168:171], v[136:151]
  ds_read_b64_tr_b16 v[190:191], v65 offset:4096
  ds_read_b64_tr_b16 v[192:193], v63 offset:512
  ds_read_b64_tr_b16 v[194:195], v65 offset:512
  v_and_b32 v19, 0xffff0000, v19
  v_pk_mul_f32 v[6:7], v[18:19], v[18:19]
  v_mfma_f32_32x32x16_bf16 v[120:135], v[224:227], v[172:175], v[120:135]
  ds_read_b64_tr_b16 v[196:197], v63 offset:4608
  ds_read_b64_tr_b16 v[198:199], v65 offset:4608
  ds_read_b64_tr_b16 v[200:201], v63 offset:1024
  v_pk_fma_f32 v[6:7], v[6:7], v[48:49], v[48:49] op_sel:[0,0,1] op_sel_hi:[1,0,1]
  v_pk_mul_f32 v[6:7], v[6:7], v[18:19]
  v_mfma_f32_32x32x16_bf16 v[136:151], v[228:231], v[172:175], v[136:151]
  ds_read_b64_tr_b16 v[202:203], v65 offset:1024
  ds_read_b64_tr_b16 v[204:205], v63 offset:5120
  ds_read_b64_tr_b16 v[206:207], v65 offset:5120
  v_exp_f32 v6, v6
  v_exp_f32 v7, v7
  v_mfma_f32_32x32x16_bf16 v[120:135], v[232:235], v[176:179], v[120:135]
  ds_read_b64_tr_b16 v[208:209], v63 offset:1536
  ds_read_b64_tr_b16 v[210:211], v65 offset:1536
  ds_read_b64_tr_b16 v[212:213], v63 offset:5632
  s_nop 0
  v_pk_add_f32 v[6:7], v[6:7], v[50:51] op_sel_hi:[1,0]
  v_mfma_f32_32x32x16_bf16 v[136:151], v[236:239], v[176:179], v[136:151]
  ds_read_b64_tr_b16 v[214:215], v65 offset:5632
  v_rcp_f32 v6, v6
  v_rcp_f32 v7, v7
  v_mfma_f32_32x32x16_bf16 v[120:135], v[240:243], v[180:183], v[120:135]
  s_nop 0
  v_pk_mul_f32 v[18:19], v[18:19], v[6:7]
  v_mfma_f32_32x32x16_bf16 v[136:151], v[244:247], v[180:183], v[136:151]
  s_waitcnt lgkmcnt(0)
  s_barrier
  v_mfma_f32_32x32x16_bf16 v[120:135], v[184:187], v[104:107], v[120:135]
  ds_read_b128 v[168:171], v52 offset:32768
  ds_read_b64_tr_b16 v[216:217], v63 offset:8192
  ds_read_b64_tr_b16 v[218:219], v65 offset:8192
  v_cvt_pk_bf16_f32 v21, v20, v21
  v_lshlrev_b32 v20, 16, v21
  v_mfma_f32_32x32x16_bf16 v[136:151], v[188:191], v[104:107], v[136:151]
  ds_read_b64_tr_b16 v[220:221], v63 offset:12288
  ds_read_b64_tr_b16 v[222:223], v65 offset:12288
  ds_read_b128 v[172:175], v54 offset:32768
  v_and_b32 v21, 0xffff0000, v21
  v_pk_mul_f32 v[6:7], v[20:21], v[20:21]
  v_mfma_f32_32x32x16_bf16 v[120:135], v[192:195], v[108:111], v[120:135]
  ds_read_b64_tr_b16 v[224:225], v63 offset:8704
  ds_read_b64_tr_b16 v[226:227], v65 offset:8704
  ds_read_b64_tr_b16 v[228:229], v63 offset:12800
  v_pk_fma_f32 v[6:7], v[6:7], v[48:49], v[48:49] op_sel:[0,0,1] op_sel_hi:[1,0,1]
  v_pk_mul_f32 v[6:7], v[6:7], v[20:21]
  v_mfma_f32_32x32x16_bf16 v[136:151], v[196:199], v[108:111], v[136:151]
  ds_read_b64_tr_b16 v[230:231], v65 offset:12800
  ds_read_b128 v[176:179], v56 offset:32768
  ds_read_b64_tr_b16 v[232:233], v63 offset:9216
  v_exp_f32 v6, v6
  v_exp_f32 v7, v7
  v_mfma_f32_32x32x16_bf16 v[120:135], v[200:203], v[112:115], v[120:135]
  ds_read_b64_tr_b16 v[234:235], v65 offset:9216
  ds_read_b64_tr_b16 v[236:237], v63 offset:13312
  ds_read_b64_tr_b16 v[238:239], v65 offset:13312
  s_nop 0
  v_pk_add_f32 v[6:7], v[6:7], v[50:51] op_sel_hi:[1,0]
  v_mfma_f32_32x32x16_bf16 v[136:151], v[204:207], v[112:115], v[136:151]
  ds_read_b128 v[180:183], v58 offset:32768
  ds_read_b64_tr_b16 v[240:241], v63 offset:9728
  ds_read_b64_tr_b16 v[242:243], v65 offset:9728
  v_rcp_f32 v6, v6
  v_rcp_f32 v7, v7
  v_mfma_f32_32x32x16_bf16 v[120:135], v[208:211], v[116:119], v[120:135]
  ds_read_b64_tr_b16 v[244:245], v63 offset:13824
  ds_read_b64_tr_b16 v[246:247], v65 offset:13824
  s_nop 0
  v_pk_mul_f32 v[20:21], v[20:21], v[6:7]
  v_mfma_f32_32x32x16_bf16 v[136:151], v[212:215], v[116:119], v[136:151]
  s_waitcnt lgkmcnt(0)
  s_barrier
  v_mfma_f32_32x32x16_bf16 v[120:135], v[216:219], v[168:171], v[120:135]
  ds_read_b128 v[152:155], v52 offset:49152
  ds_read_b64_tr_b16 v[184:185], v63 offset:16384
  ds_read_b64_tr_b16 v[186:187], v65 offset:16384
  v_cvt_pk_bf16_f32 v23, v22, v23
  v_lshlrev_b32 v22, 16, v23
  v_mfma_f32_32x32x16_bf16 v[136:151], v[220:223], v[168:171], v[136:151]
  ds_read_b64_tr_b16 v[188:189], v63 offset:20480
  ds_read_b64_tr_b16 v[190:191], v65 offset:20480
  ds_read_b128 v[156:159], v54 offset:49152
  v_and_b32 v23, 0xffff0000, v23
  v_pk_mul_f32 v[6:7], v[22:23], v[22:23]
  v_mfma_f32_32x32x16_bf16 v[120:135], v[224:227], v[172:175], v[120:135]
  ds_read_b64_tr_b16 v[192:193], v63 offset:16896
  ds_read_b64_tr_b16 v[194:195], v65 offset:16896
  ds_read_b64_tr_b16 v[196:197], v63 offset:20992
  v_pk_fma_f32 v[6:7], v[6:7], v[48:49], v[48:49] op_sel:[0,0,1] op_sel_hi:[1,0,1]
  v_pk_mul_f32 v[6:7], v[6:7], v[22:23]
  v_mfma_f32_32x32x16_bf16 v[136:151], v[228:231], v[172:175], v[136:151]
  ds_read_b64_tr_b16 v[198:199], v65 offset:20992
  ds_read_b128 v[160:163], v56 offset:49152
  ds_read_b64_tr_b16 v[200:201], v63 offset:17408
  v_exp_f32 v6, v6
  v_exp_f32 v7, v7
  v_mfma_f32_32x32x16_bf16 v[120:135], v[232:235], v[176:179], v[120:135]
  ds_read_b64_tr_b16 v[202:203], v65 offset:17408
  ds_read_b64_tr_b16 v[204:205], v63 offset:21504
  ds_read_b64_tr_b16 v[206:207], v65 offset:21504
  s_nop 0
  v_pk_add_f32 v[6:7], v[6:7], v[50:51] op_sel_hi:[1,0]
  v_mfma_f32_32x32x16_bf16 v[136:151], v[236:239], v[176:179], v[136:151]
  ds_read_b128 v[164:167], v58 offset:49152
  ds_read_b64_tr_b16 v[208:209], v63 offset:17920
  ds_read_b64_tr_b16 v[210:211], v65 offset:17920
  v_rcp_f32 v6, v6
  v_rcp_f32 v7, v7
  v_mfma_f32_32x32x16_bf16 v[120:135], v[240:243], v[180:183], v[120:135]
  ds_read_b64_tr_b16 v[212:213], v63 offset:22016
  ds_read_b64_tr_b16 v[214:215], v65 offset:22016
  s_nop 0
  v_pk_mul_f32 v[22:23], v[22:23], v[6:7]
  v_mfma_f32_32x32x16_bf16 v[136:151], v[244:247], v[180:183], v[136:151]
  s_waitcnt lgkmcnt(0)
  s_barrier
  v_mfma_f32_32x32x16_bf16 v[120:135], v[184:187], v[152:155], v[120:135]
  ds_read_b128 v[168:171], v53 offset:0
  ds_read_b64_tr_b16 v[216:217], v63 offset:24576
  ds_read_b64_tr_b16 v[218:219], v65 offset:24576
  v_cvt_pk_bf16_f32 v25, v24, v25
  v_lshlrev_b32 v24, 16, v25
  v_mfma_f32_32x32x16_bf16 v[136:151], v[188:191], v[152:155], v[136:151]
  ds_read_b64_tr_b16 v[220:221], v63 offset:28672
  ds_read_b64_tr_b16 v[222:223], v65 offset:28672
  ds_read_b128 v[172:175], v55 offset:0
  v_and_b32 v25, 0xffff0000, v25
  v_pk_mul_f32 v[6:7], v[24:25], v[24:25]
  v_mfma_f32_32x32x16_bf16 v[120:135], v[192:195], v[156:159], v[120:135]
  ds_read_b64_tr_b16 v[224:225], v63 offset:25088
  ds_read_b64_tr_b16 v[226:227], v65 offset:25088
  ds_read_b64_tr_b16 v[228:229], v63 offset:29184
  v_pk_fma_f32 v[6:7], v[6:7], v[48:49], v[48:49] op_sel:[0,0,1] op_sel_hi:[1,0,1]
  v_pk_mul_f32 v[6:7], v[6:7], v[24:25]
  v_mfma_f32_32x32x16_bf16 v[136:151], v[196:199], v[156:159], v[136:151]
  ds_read_b64_tr_b16 v[230:231], v65 offset:29184
  ds_read_b128 v[176:179], v57 offset:0
  ds_read_b64_tr_b16 v[232:233], v63 offset:25600
  v_exp_f32 v6, v6
  v_exp_f32 v7, v7
  v_mfma_f32_32x32x16_bf16 v[120:135], v[200:203], v[160:163], v[120:135]
  ds_read_b64_tr_b16 v[234:235], v65 offset:25600
  ds_read_b64_tr_b16 v[236:237], v63 offset:29696
  ds_read_b64_tr_b16 v[238:239], v65 offset:29696
  s_nop 0
  v_pk_add_f32 v[6:7], v[6:7], v[50:51] op_sel_hi:[1,0]
  v_mfma_f32_32x32x16_bf16 v[136:151], v[204:207], v[160:163], v[136:151]
  ds_read_b128 v[180:183], v59 offset:0
  ds_read_b64_tr_b16 v[240:241], v63 offset:26112
  ds_read_b64_tr_b16 v[242:243], v65 offset:26112
  v_rcp_f32 v6, v6
  v_rcp_f32 v7, v7
  v_mfma_f32_32x32x16_bf16 v[120:135], v[208:211], v[164:167], v[120:135]
  ds_read_b64_tr_b16 v[244:245], v63 offset:30208
  ds_read_b64_tr_b16 v[246:247], v65 offset:30208
  s_nop 0
  v_pk_mul_f32 v[24:25], v[24:25], v[6:7]
  v_mfma_f32_32x32x16_bf16 v[136:151], v[212:215], v[164:167], v[136:151]
  s_waitcnt lgkmcnt(0)
  s_barrier
  v_mfma_f32_32x32x16_bf16 v[120:135], v[216:219], v[168:171], v[120:135]
  ds_read_b128 v[152:155], v53 offset:16384
  ds_read_b64_tr_b16 v[184:185], v62 offset:49152
  ds_read_b64_tr_b16 v[186:187], v64 offset:49152
  v_cvt_pk_bf16_f32 v27, v26, v27
  v_lshlrev_b32 v26, 16, v27
  v_mfma_f32_32x32x16_bf16 v[136:151], v[220:223], v[168:171], v[136:151]
  ds_read_b64_tr_b16 v[188:189], v62 offset:53248
  ds_read_b64_tr_b16 v[190:191], v64 offset:53248
  ds_read_b128 v[156:159], v55 offset:16384
  v_and_b32 v27, 0xffff0000, v27
  v_pk_mul_f32 v[6:7], v[26:27], v[26:27]
  v_mfma_f32_32x32x16_bf16 v[120:135], v[224:227], v[172:175], v[120:135]
  ds_read_b64_tr_b16 v[192:193], v62 offset:49664
  ds_read_b64_tr_b16 v[194:195], v64 offset:49664
  ds_read_b64_tr_b16 v[196:197], v62 offset:53760
  v_pk_fma_f32 v[6:7], v[6:7], v[48:49], v[48:49] op_sel:[0,0,1] op_sel_hi:[1,0,1]
  v_pk_mul_f32 v[6:7], v[6:7], v[26:27]
  v_mfma_f32_32x32x16_bf16 v[136:151], v[228:231], v[172:175], v[136:151]
  ds_read_b64_tr_b16 v[198:199], v64 offset:53760
  ds_read_b128 v[160:163], v57 offset:16384
  ds_read_b64_tr_b16 v[200:201], v62 offset:50176
  v_exp_f32 v6, v6
  v_exp_f32 v7, v7
  v_mfma_f32_32x32x16_bf16 v[120:135], v[232:235], v[176:179], v[120:135]
  ds_read_b64_tr_b16 v[202:203], v64 offset:50176
  ds_read_b64_tr_b16 v[204:205], v62 offset:54272
  ds_read_b64_tr_b16 v[206:207], v64 offset:54272
  s_nop 0
  v_pk_add_f32 v[6:7], v[6:7], v[50:51] op_sel_hi:[1,0]
  v_mfma_f32_32x32x16_bf16 v[136:151], v[236:239], v[176:179], v[136:151]
  ds_read_b128 v[164:167], v59 offset:16384
  ds_read_b64_tr_b16 v[208:209], v62 offset:50688
  ds_read_b64_tr_b16 v[210:211], v64 offset:50688
  v_rcp_f32 v6, v6
  v_rcp_f32 v7, v7
  v_mfma_f32_32x32x16_bf16 v[120:135], v[240:243], v[180:183], v[120:135]
  ds_read_b64_tr_b16 v[212:213], v62 offset:54784
  ds_read_b64_tr_b16 v[214:215], v64 offset:54784
  s_nop 0
  v_pk_mul_f32 v[26:27], v[26:27], v[6:7]
  v_mfma_f32_32x32x16_bf16 v[136:151], v[244:247], v[180:183], v[136:151]
  s_waitcnt lgkmcnt(0)
  s_barrier
  v_mfma_f32_32x32x16_bf16 v[120:135], v[184:187], v[152:155], v[120:135]
  ds_read_b128 v[168:171], v53 offset:32768
  ds_read_b64_tr_b16 v[216:217], v62 offset:57344
  ds_read_b64_tr_b16 v[218:219], v64 offset:57344
  v_cvt_pk_bf16_f32 v29, v28, v29
  v_lshlrev_b32 v28, 16, v29
  v_mfma_f32_32x32x16_bf16 v[136:151], v[188:191], v[152:155], v[136:151]
  ds_read_b64_tr_b16 v[220:221], v62 offset:61440
  ds_read_b64_tr_b16 v[222:223], v64 offset:61440
  ds_read_b128 v[172:175], v55 offset:32768
  v_and_b32 v29, 0xffff0000, v29
  v_pk_mul_f32 v[6:7], v[28:29], v[28:29]
  v_mfma_f32_32x32x16_bf16 v[120:135], v[192:195], v[156:159], v[120:135]
  ds_read_b64_tr_b16 v[224:225], v62 offset:57856
  ds_read_b64_tr_b16 v[226:227], v64 offset:57856
  ds_read_b64_tr_b16 v[228:229], v62 offset:61952
  v_pk_fma_f32 v[6:7], v[6:7], v[48:49], v[48:49] op_sel:[0,0,1] op_sel_hi:[1,0,1]
  v_pk_mul_f32 v[6:7], v[6:7], v[28:29]
  v_mfma_f32_32x32x16_bf16 v[136:151], v[196:199], v[156:159], v[136:151]
  ds_read_b64_tr_b16 v[230:231], v64 offset:61952
  ds_read_b128 v[176:179], v57 offset:32768
  ds_read_b64_tr_b16 v[232:233], v62 offset:58368
  v_exp_f32 v6, v6
  v_exp_f32 v7, v7
  v_mfma_f32_32x32x16_bf16 v[120:135], v[200:203], v[160:163], v[120:135]
  ds_read_b64_tr_b16 v[234:235], v64 offset:58368
  ds_read_b64_tr_b16 v[236:237], v62 offset:62464
  ds_read_b64_tr_b16 v[238:239], v64 offset:62464
  s_nop 0
  v_pk_add_f32 v[6:7], v[6:7], v[50:51] op_sel_hi:[1,0]
  v_mfma_f32_32x32x16_bf16 v[136:151], v[204:207], v[160:163], v[136:151]
  ds_read_b128 v[180:183], v59 offset:32768
  ds_read_b64_tr_b16 v[240:241], v62 offset:58880
  ds_read_b64_tr_b16 v[242:243], v64 offset:58880
  v_rcp_f32 v6, v6
  v_rcp_f32 v7, v7
  v_mfma_f32_32x32x16_bf16 v[120:135], v[208:211], v[164:167], v[120:135]
  ds_read_b64_tr_b16 v[244:245], v62 offset:62976
  ds_read_b64_tr_b16 v[246:247], v64 offset:62976
  s_nop 0
  v_pk_mul_f32 v[28:29], v[28:29], v[6:7]
  v_mfma_f32_32x32x16_bf16 v[136:151], v[212:215], v[164:167], v[136:151]
  s_waitcnt lgkmcnt(0)
  s_barrier
  v_mfma_f32_32x32x16_bf16 v[120:135], v[216:219], v[168:171], v[120:135]
  ds_read_b128 v[152:155], v52 offset:0
  ds_read_b64_tr_b16 v[184:185], v63 offset:0
  ds_read_b64_tr_b16 v[186:187], v65 offset:0
  v_cvt_pk_bf16_f32 v31, v30, v31
  v_lshlrev_b32 v30, 16, v31
  v_mfma_f32_32x32x16_bf16 v[136:151], v[220:223], v[168:171], v[136:151]
  ds_read_b64_tr_b16 v[188:189], v63 offset:4096
  ds_read_b64_tr_b16 v[190:191], v65 offset:4096
  ds_read_b128 v[156:159], v54 offset:0
  v_and_b32 v31, 0xffff0000, v31
  v_pk_mul_f32 v[6:7], v[30:31], v[30:31]
  v_mfma_f32_32x32x16_bf16 v[120:135], v[224:227], v[172:175], v[120:135]
  ds_read_b64_tr_b16 v[192:193], v63 offset:512
  ds_read_b64_tr_b16 v[194:195], v65 offset:512
  ds_read_b64_tr_b16 v[196:197], v63 offset:4608
  v_pk_fma_f32 v[6:7], v[6:7], v[48:49], v[48:49] op_sel:[0,0,1] op_sel_hi:[1,0,1]
  v_pk_mul_f32 v[6:7], v[6:7], v[30:31]
  v_mfma_f32_32x32x16_bf16 v[136:151], v[228:231], v[172:175], v[136:151]
  ds_read_b64_tr_b16 v[198:199], v65 offset:4608
  ds_read_b128 v[160:163], v56 offset:0
  ds_read_b64_tr_b16 v[200:201], v63 offset:1024
  v_exp_f32 v6, v6
  v_exp_f32 v7, v7
  v_mfma_f32_32x32x16_bf16 v[120:135], v[232:235], v[176:179], v[120:135]
  ds_read_b64_tr_b16 v[202:203], v65 offset:1024
  ds_read_b64_tr_b16 v[204:205], v63 offset:5120
  ds_read_b64_tr_b16 v[206:207], v65 offset:5120
  s_nop 0
  v_pk_add_f32 v[6:7], v[6:7], v[50:51] op_sel_hi:[1,0]
  v_mfma_f32_32x32x16_bf16 v[136:151], v[236:239], v[176:179], v[136:151]
  ds_read_b128 v[164:167], v58 offset:0
  ds_read_b64_tr_b16 v[208:209], v63 offset:1536
  ds_read_b64_tr_b16 v[210:211], v65 offset:1536
  v_rcp_f32 v6, v6
  v_rcp_f32 v7, v7
  v_mfma_f32_32x32x16_bf16 v[120:135], v[240:243], v[180:183], v[120:135]
  ds_read_b64_tr_b16 v[212:213], v63 offset:5632
  ds_read_b64_tr_b16 v[214:215], v65 offset:5632
  s_nop 0
  v_pk_mul_f32 v[30:31], v[30:31], v[6:7]
  v_mfma_f32_32x32x16_bf16 v[136:151], v[244:247], v[180:183], v[136:151]
  s_waitcnt lgkmcnt(0)
  s_barrier
  v_mfma_f32_32x32x16_bf16 v[120:135], v[184:187], v[152:155], v[120:135]
  ds_read_b128 v[168:171], v52 offset:16384
  ds_read_b64_tr_b16 v[216:217], v63 offset:8192
  ds_read_b64_tr_b16 v[218:219], v65 offset:8192
  v_cvt_pk_bf16_f32 v33, v32, v33
  v_lshlrev_b32 v32, 16, v33
  v_mfma_f32_32x32x16_bf16 v[136:151], v[188:191], v[152:155], v[136:151]
  ds_read_b64_tr_b16 v[220:221], v63 offset:12288
  ds_read_b64_tr_b16 v[222:223], v65 offset:12288
  ds_read_b128 v[172:175], v54 offset:16384
  v_and_b32 v33, 0xffff0000, v33
  v_pk_mul_f32 v[6:7], v[32:33], v[32:33]
  v_mfma_f32_32x32x16_bf16 v[120:135], v[192:195], v[156:159], v[120:135]
  ds_read_b64_tr_b16 v[224:225], v63 offset:8704
  ds_read_b64_tr_b16 v[226:227], v65 offset:8704
  ds_read_b64_tr_b16 v[228:229], v63 offset:12800
  v_pk_fma_f32 v[6:7], v[6:7], v[48:49], v[48:49] op_sel:[0,0,1] op_sel_hi:[1,0,1]
  v_pk_mul_f32 v[6:7], v[6:7], v[32:33]
  v_mfma_f32_32x32x16_bf16 v[136:151], v[196:199], v[156:159], v[136:151]
  ds_read_b64_tr_b16 v[230:231], v65 offset:12800
  ds_read_b128 v[176:179], v56 offset:16384
  ds_read_b64_tr_b16 v[232:233], v63 offset:9216
  v_exp_f32 v6, v6
  v_exp_f32 v7, v7
  v_mfma_f32_32x32x16_bf16 v[120:135], v[200:203], v[160:163], v[120:135]
  ds_read_b64_tr_b16 v[234:235], v65 offset:9216
  ds_read_b64_tr_b16 v[236:237], v63 offset:13312
  ds_read_b64_tr_b16 v[238:239], v65 offset:13312
  s_nop 0
  v_pk_add_f32 v[6:7], v[6:7], v[50:51] op_sel_hi:[1,0]
  v_mfma_f32_32x32x16_bf16 v[136:151], v[204:207], v[160:163], v[136:151]
  ds_read_b128 v[180:183], v58 offset:16384
  ds_read_b64_tr_b16 v[240:241], v63 offset:9728
  ds_read_b64_tr_b16 v[242:243], v65 offset:9728
  v_rcp_f32 v6, v6
  v_rcp_f32 v7, v7
  v_mfma_f32_32x32x16_bf16 v[120:135], v[208:211], v[164:167], v[120:135]
  ds_read_b64_tr_b16 v[244:245], v63 offset:13824
  ds_read_b64_tr_b16 v[246:247], v65 offset:13824
  s_nop 0
  v_pk_mul_f32 v[32:33], v[32:33], v[6:7]
  v_mfma_f32_32x32x16_bf16 v[136:151], v[212:215], v[164:167], v[136:151]
  s_waitcnt lgkmcnt(0)
  s_barrier
  v_mfma_f32_32x32x16_bf16 v[120:135], v[216:219], v[168:171], v[120:135]
  ds_read_b128 v[152:155], v52 offset:32768
  ds_read_b64_tr_b16 v[184:185], v63 offset:16384
  ds_read_b64_tr_b16 v[186:187], v65 offset:16384
  v_cvt_pk_bf16_f32 v35, v34, v35
  v_lshlrev_b32 v34, 16, v35
  v_mfma_f32_32x32x16_bf16 v[136:151], v[220:223], v[168:171], v[136:151]
  ds_read_b64_tr_b16 v[188:189], v63 offset:20480
  ds_read_b64_tr_b16 v[190:191], v65 offset:20480
  ds_read_b128 v[156:159], v54 offset:32768
  v_and_b32 v35, 0xffff0000, v35
  v_pk_mul_f32 v[6:7], v[34:35], v[34:35]
  v_mfma_f32_32x32x16_bf16 v[120:135], v[224:227], v[172:175], v[120:135]
  ds_read_b64_tr_b16 v[192:193], v63 offset:16896
  ds_read_b64_tr_b16 v[194:195], v65 offset:16896
  ds_read_b64_tr_b16 v[196:197], v63 offset:20992
  v_pk_fma_f32 v[6:7], v[6:7], v[48:49], v[48:49] op_sel:[0,0,1] op_sel_hi:[1,0,1]
  v_pk_mul_f32 v[6:7], v[6:7], v[34:35]
  v_mfma_f32_32x32x16_bf16 v[136:151], v[228:231], v[172:175], v[136:151]
  ds_read_b64_tr_b16 v[198:199], v65 offset:20992
  ds_read_b128 v[160:163], v56 offset:32768
  ds_read_b64_tr_b16 v[200:201], v63 offset:17408
  v_exp_f32 v6, v6
  v_exp_f32 v7, v7
  v_mfma_f32_32x32x16_bf16 v[120:135], v[232:235], v[176:179], v[120:135]
  ds_read_b64_tr_b16 v[202:203], v65 offset:17408
  ds_read_b64_tr_b16 v[204:205], v63 offset:21504
  ds_read_b64_tr_b16 v[206:207], v65 offset:21504
  s_nop 0
  v_pk_add_f32 v[6:7], v[6:7], v[50:51] op_sel_hi:[1,0]
  v_mfma_f32_32x32x16_bf16 v[136:151], v[236:239], v[176:179], v[136:151]
  ds_read_b128 v[164:167], v58 offset:32768
  ds_read_b64_tr_b16 v[208:209], v63 offset:17920
  ds_read_b64_tr_b16 v[210:211], v65 offset:17920
  v_rcp_f32 v6, v6
  v_rcp_f32 v7, v7
  v_mfma_f32_32x32x16_bf16 v[120:135], v[240:243], v[180:183], v[120:135]
  ds_read_b64_tr_b16 v[212:213], v63 offset:22016
  ds_read_b64_tr_b16 v[214:215], v65 offset:22016
  s_nop 0
  v_pk_mul_f32 v[34:35], v[34:35], v[6:7]
  v_mfma_f32_32x32x16_bf16 v[136:151], v[244:247], v[180:183], v[136:151]
  s_waitcnt lgkmcnt(0)
  s_barrier
  v_mfma_f32_32x32x16_bf16 v[120:135], v[184:187], v[152:155], v[120:135]
  ds_read_b128 v[168:171], v52 offset:49152
  ds_read_b64_tr_b16 v[216:217], v63 offset:24576
  ds_read_b64_tr_b16 v[218:219], v65 offset:24576
  v_cvt_pk_bf16_f32 v37, v36, v37
  v_lshlrev_b32 v36, 16, v37
  v_mfma_f32_32x32x16_bf16 v[136:151], v[188:191], v[152:155], v[136:151]
  ds_read_b64_tr_b16 v[220:221], v63 offset:28672
  ds_read_b64_tr_b16 v[222:223], v65 offset:28672
  ds_read_b128 v[172:175], v54 offset:49152
  v_and_b32 v37, 0xffff0000, v37
  v_pk_mul_f32 v[6:7], v[36:37], v[36:37]
  v_mfma_f32_32x32x16_bf16 v[120:135], v[192:195], v[156:159], v[120:135]
  ds_read_b64_tr_b16 v[224:225], v63 offset:25088
  ds_read_b64_tr_b16 v[226:227], v65 offset:25088
  ds_read_b64_tr_b16 v[228:229], v63 offset:29184
  v_pk_fma_f32 v[6:7], v[6:7], v[48:49], v[48:49] op_sel:[0,0,1] op_sel_hi:[1,0,1]
  v_pk_mul_f32 v[6:7], v[6:7], v[36:37]
  v_mfma_f32_32x32x16_bf16 v[136:151], v[196:199], v[156:159], v[136:151]
  ds_read_b64_tr_b16 v[230:231], v65 offset:29184
  ds_read_b128 v[176:179], v56 offset:49152
  ds_read_b64_tr_b16 v[232:233], v63 offset:25600
  v_exp_f32 v6, v6
  v_exp_f32 v7, v7
  v_mfma_f32_32x32x16_bf16 v[120:135], v[200:203], v[160:163], v[120:135]
  ds_read_b64_tr_b16 v[234:235], v65 offset:25600
  ds_read_b64_tr_b16 v[236:237], v63 offset:29696
  ds_read_b64_tr_b16 v[238:239], v65 offset:29696
  s_nop 0
  v_pk_add_f32 v[6:7], v[6:7], v[50:51] op_sel_hi:[1,0]
  v_mfma_f32_32x32x16_bf16 v[136:151], v[204:207], v[160:163], v[136:151]
  ds_read_b128 v[180:183], v58 offset:49152
  ds_read_b64_tr_b16 v[240:241], v63 offset:26112
  ds_read_b64_tr_b16 v[242:243], v65 offset:26112
  v_rcp_f32 v6, v6
  v_rcp_f32 v7, v7
  v_mfma_f32_32x32x16_bf16 v[120:135], v[208:211], v[164:167], v[120:135]
  ds_read_b64_tr_b16 v[244:245], v63 offset:30208
  ds_read_b64_tr_b16 v[246:247], v65 offset:30208
  s_nop 0
  v_pk_mul_f32 v[36:37], v[36:37], v[6:7]
  v_mfma_f32_32x32x16_bf16 v[136:151], v[212:215], v[164:167], v[136:151]
  s_waitcnt lgkmcnt(0)
  s_barrier
  v_mfma_f32_32x32x16_bf16 v[120:135], v[216:219], v[168:171], v[120:135]
  ds_read_b128 v[152:155], v53 offset:0
  ds_read_b64_tr_b16 v[184:185], v62 offset:49152
  ds_read_b64_tr_b16 v[186:187], v64 offset:49152
  v_cvt_pk_bf16_f32 v39, v38, v39
  v_lshlrev_b32 v38, 16, v39
  v_mfma_f32_32x32x16_bf16 v[136:151], v[220:223], v[168:171], v[136:151]
  ds_read_b64_tr_b16 v[188:189], v62 offset:53248
  ds_read_b64_tr_b16 v[190:191], v64 offset:53248
  ds_read_b128 v[156:159], v55 offset:0
  v_and_b32 v39, 0xffff0000, v39
  v_pk_mul_f32 v[6:7], v[38:39], v[38:39]
  v_mfma_f32_32x32x16_bf16 v[120:135], v[224:227], v[172:175], v[120:135]
  ds_read_b64_tr_b16 v[192:193], v62 offset:49664
  ds_read_b64_tr_b16 v[194:195], v64 offset:49664
  ds_read_b64_tr_b16 v[196:197], v62 offset:53760
  v_pk_fma_f32 v[6:7], v[6:7], v[48:49], v[48:49] op_sel:[0,0,1] op_sel_hi:[1,0,1]
  v_pk_mul_f32 v[6:7], v[6:7], v[38:39]
  v_mfma_f32_32x32x16_bf16 v[136:151], v[228:231], v[172:175], v[136:151]
  ds_read_b64_tr_b16 v[198:199], v64 offset:53760
  ds_read_b128 v[160:163], v57 offset:0
  ds_read_b64_tr_b16 v[200:201], v62 offset:50176
  v_exp_f32 v6, v6
  v_exp_f32 v7, v7
  v_mfma_f32_32x32x16_bf16 v[120:135], v[232:235], v[176:179], v[120:135]
  ds_read_b64_tr_b16 v[202:203], v64 offset:50176
  ds_read_b64_tr_b16 v[204:205], v62 offset:54272
  ds_read_b64_tr_b16 v[206:207], v64 offset:54272
  s_nop 0
  v_pk_add_f32 v[6:7], v[6:7], v[50:51] op_sel_hi:[1,0]
  v_mfma_f32_32x32x16_bf16 v[136:151], v[236:239], v[176:179], v[136:151]
  ds_read_b128 v[164:167], v59 offset:0
  ds_read_b64_tr_b16 v[208:209], v62 offset:50688
  ds_read_b64_tr_b16 v[210:211], v64 offset:50688
  v_rcp_f32 v6, v6
  v_rcp_f32 v7, v7
  v_mfma_f32_32x32x16_bf16 v[120:135], v[240:243], v[180:183], v[120:135]
  ds_read_b64_tr_b16 v[212:213], v62 offset:54784
  ds_read_b64_tr_b16 v[214:215], v64 offset:54784
  s_nop 0
  v_pk_mul_f32 v[38:39], v[38:39], v[6:7]
  v_mfma_f32_32x32x16_bf16 v[136:151], v[244:247], v[180:183], v[136:151]
  s_waitcnt lgkmcnt(0)
  s_barrier
  v_mfma_f32_32x32x16_bf16 v[120:135], v[184:187], v[152:155], v[120:135]
  ds_read_b128 v[168:171], v53 offset:16384
  ds_read_b64_tr_b16 v[216:217], v62 offset:57344
  ds_read_b64_tr_b16 v[218:219], v64 offset:57344
  v_cvt_pk_bf16_f32 v41, v40, v41
  v_lshlrev_b32 v40, 16, v41
  v_mfma_f32_32x32x16_bf16 v[136:151], v[188:191], v[152:155], v[136:151]
  ds_read_b64_tr_b16 v[220:221], v62 offset:61440
  ds_read_b64_tr_b16 v[222:223], v64 offset:61440
  ds_read_b128 v[172:175], v55 offset:16384
  v_and_b32 v41, 0xffff0000, v41
  v_pk_mul_f32 v[6:7], v[40:41], v[40:41]
  v_mfma_f32_32x32x16_bf16 v[120:135], v[192:195], v[156:159], v[120:135]
  ds_read_b64_tr_b16 v[224:225], v62 offset:57856
  ds_read_b64_tr_b16 v[226:227], v64 offset:57856
  ds_read_b64_tr_b16 v[228:229], v62 offset:61952
  v_pk_fma_f32 v[6:7], v[6:7], v[48:49], v[48:49] op_sel:[0,0,1] op_sel_hi:[1,0,1]
  v_pk_mul_f32 v[6:7], v[6:7], v[40:41]
  v_mfma_f32_32x32x16_bf16 v[136:151], v[196:199], v[156:159], v[136:151]
  ds_read_b64_tr_b16 v[230:231], v64 offset:61952
  ds_read_b128 v[176:179], v57 offset:16384
  ds_read_b64_tr_b16 v[232:233], v62 offset:58368
  v_exp_f32 v6, v6
  v_exp_f32 v7, v7
  v_mfma_f32_32x32x16_bf16 v[120:135], v[200:203], v[160:163], v[120:135]
  ds_read_b64_tr_b16 v[234:235], v64 offset:58368
  ds_read_b64_tr_b16 v[236:237], v62 offset:62464
  ds_read_b64_tr_b16 v[238:239], v64 offset:62464
  s_nop 0
  v_pk_add_f32 v[6:7], v[6:7], v[50:51] op_sel_hi:[1,0]
  v_mfma_f32_32x32x16_bf16 v[136:151], v[204:207], v[160:163], v[136:151]
  ds_read_b128 v[180:183], v59 offset:16384
  ds_read_b64_tr_b16 v[240:241], v62 offset:58880
  ds_read_b64_tr_b16 v[242:243], v64 offset:58880
  v_rcp_f32 v6, v6
  v_rcp_f32 v7, v7
  v_mfma_f32_32x32x16_bf16 v[120:135], v[208:211], v[164:167], v[120:135]
  ds_read_b64_tr_b16 v[244:245], v62 offset:62976
  ds_read_b64_tr_b16 v[246:247], v64 offset:62976
  s_nop 0
  v_pk_mul_f32 v[40:41], v[40:41], v[6:7]
  v_mfma_f32_32x32x16_bf16 v[136:151], v[212:215], v[164:167], v[136:151]
  s_waitcnt lgkmcnt(0)
  s_barrier
  v_mfma_f32_32x32x16_bf16 v[120:135], v[216:219], v[168:171], v[120:135]
  ds_read_b128 v[152:155], v53 offset:32768
  ds_read_b64_tr_b16 v[184:185], v63 offset:0
  ds_read_b64_tr_b16 v[186:187], v65 offset:0
  v_cvt_pk_bf16_f32 v43, v42, v43
  v_lshlrev_b32 v42, 16, v43
  v_mfma_f32_32x32x16_bf16 v[136:151], v[220:223], v[168:171], v[136:151]
  ds_read_b64_tr_b16 v[188:189], v63 offset:4096
  ds_read_b64_tr_b16 v[190:191], v65 offset:4096
  ds_read_b128 v[156:159], v55 offset:32768
  v_and_b32 v43, 0xffff0000, v43
  v_pk_mul_f32 v[6:7], v[42:43], v[42:43]
  v_mfma_f32_32x32x16_bf16 v[120:135], v[224:227], v[172:175], v[120:135]
  ds_read_b64_tr_b16 v[192:193], v63 offset:512
  ds_read_b64_tr_b16 v[194:195], v65 offset:512
  ds_read_b64_tr_b16 v[196:197], v63 offset:4608
  v_pk_fma_f32 v[6:7], v[6:7], v[48:49], v[48:49] op_sel:[0,0,1] op_sel_hi:[1,0,1]
  v_pk_mul_f32 v[6:7], v[6:7], v[42:43]
  v_mfma_f32_32x32x16_bf16 v[136:151], v[228:231], v[172:175], v[136:151]
  ds_read_b64_tr_b16 v[198:199], v65 offset:4608
  ds_read_b128 v[160:163], v57 offset:32768
  ds_read_b64_tr_b16 v[200:201], v63 offset:1024
  v_exp_f32 v6, v6
  v_exp_f32 v7, v7
  v_mfma_f32_32x32x16_bf16 v[120:135], v[232:235], v[176:179], v[120:135]
  ds_read_b64_tr_b16 v[202:203], v65 offset:1024
  ds_read_b64_tr_b16 v[204:205], v63 offset:5120
  ds_read_b64_tr_b16 v[206:207], v65 offset:5120
  s_nop 0
  v_pk_add_f32 v[6:7], v[6:7], v[50:51] op_sel_hi:[1,0]
  v_mfma_f32_32x32x16_bf16 v[136:151], v[236:239], v[176:179], v[136:151]
  ds_read_b128 v[164:167], v59 offset:32768
  ds_read_b64_tr_b16 v[208:209], v63 offset:1536
  ds_read_b64_tr_b16 v[210:211], v65 offset:1536
  v_rcp_f32 v6, v6
  v_rcp_f32 v7, v7
  v_mfma_f32_32x32x16_bf16 v[120:135], v[240:243], v[180:183], v[120:135]
  ds_read_b64_tr_b16 v[212:213], v63 offset:5632
  ds_read_b64_tr_b16 v[214:215], v65 offset:5632
  s_nop 0
  v_pk_mul_f32 v[42:43], v[42:43], v[6:7]
  v_mfma_f32_32x32x16_bf16 v[136:151], v[244:247], v[180:183], v[136:151]
  s_waitcnt lgkmcnt(0)
  s_barrier
  v_mfma_f32_32x32x16_bf16 v[120:135], v[184:187], v[152:155], v[120:135]
  ds_read_b128 v[168:171], v52 offset:0
  ds_read_b64_tr_b16 v[216:217], v63 offset:8192
  ds_read_b64_tr_b16 v[218:219], v65 offset:8192
  v_cvt_pk_bf16_f32 v45, v44, v45
  v_lshlrev_b32 v44, 16, v45
  v_mfma_f32_32x32x16_bf16 v[136:151], v[188:191], v[152:155], v[136:151]
  ds_read_b64_tr_b16 v[220:221], v63 offset:12288
  ds_read_b64_tr_b16 v[222:223], v65 offset:12288
  ds_read_b128 v[172:175], v54 offset:0
  v_and_b32 v45, 0xffff0000, v45
  v_pk_mul_f32 v[6:7], v[44:45], v[44:45]
  v_mfma_f32_32x32x16_bf16 v[120:135], v[192:195], v[156:159], v[120:135]
  ds_read_b64_tr_b16 v[224:225], v63 offset:8704
  ds_read_b64_tr_b16 v[226:227], v65 offset:8704
  ds_read_b64_tr_b16 v[228:229], v63 offset:12800
  v_pk_fma_f32 v[6:7], v[6:7], v[48:49], v[48:49] op_sel:[0,0,1] op_sel_hi:[1,0,1]
  v_pk_mul_f32 v[6:7], v[6:7], v[44:45]
  v_mfma_f32_32x32x16_bf16 v[136:151], v[196:199], v[156:159], v[136:151]
  ds_read_b64_tr_b16 v[230:231], v65 offset:12800
  ds_read_b128 v[176:179], v56 offset:0
  ds_read_b64_tr_b16 v[232:233], v63 offset:9216
  v_exp_f32 v6, v6
  v_exp_f32 v7, v7
  v_mfma_f32_32x32x16_bf16 v[120:135], v[200:203], v[160:163], v[120:135]
  ds_read_b64_tr_b16 v[234:235], v65 offset:9216
  ds_read_b64_tr_b16 v[236:237], v63 offset:13312
  ds_read_b64_tr_b16 v[238:239], v65 offset:13312
  s_nop 0
  v_pk_add_f32 v[6:7], v[6:7], v[50:51] op_sel_hi:[1,0]
  v_mfma_f32_32x32x16_bf16 v[136:151], v[204:207], v[160:163], v[136:151]
  ds_read_b128 v[180:183], v58 offset:0
  ds_read_b64_tr_b16 v[240:241], v63 offset:9728
  ds_read_b64_tr_b16 v[242:243], v65 offset:9728
  v_rcp_f32 v6, v6
  v_rcp_f32 v7, v7
  v_mfma_f32_32x32x16_bf16 v[120:135], v[208:211], v[164:167], v[120:135]
  ds_read_b64_tr_b16 v[244:245], v63 offset:13824
  ds_read_b64_tr_b16 v[246:247], v65 offset:13824
  s_nop 0
  v_pk_mul_f32 v[44:45], v[44:45], v[6:7]
  v_mfma_f32_32x32x16_bf16 v[136:151], v[212:215], v[164:167], v[136:151]
  s_waitcnt lgkmcnt(0)
  s_barrier
  v_mfma_f32_32x32x16_bf16 v[120:135], v[216:219], v[168:171], v[120:135]
  ds_read_b128 v[152:155], v52 offset:16384
  ds_read_b64_tr_b16 v[184:185], v63 offset:16384
  ds_read_b64_tr_b16 v[186:187], v65 offset:16384
  v_cvt_pk_bf16_f32 v47, v46, v47
  v_lshlrev_b32 v46, 16, v47
  v_mfma_f32_32x32x16_bf16 v[136:151], v[220:223], v[168:171], v[136:151]
  ds_read_b64_tr_b16 v[188:189], v63 offset:20480
  ds_read_b64_tr_b16 v[190:191], v65 offset:20480
  ds_read_b128 v[156:159], v54 offset:16384
  v_and_b32 v47, 0xffff0000, v47
  v_pk_mul_f32 v[6:7], v[46:47], v[46:47]
  v_mfma_f32_32x32x16_bf16 v[120:135], v[224:227], v[172:175], v[120:135]
  ds_read_b64_tr_b16 v[192:193], v63 offset:16896
  ds_read_b64_tr_b16 v[194:195], v65 offset:16896
  ds_read_b64_tr_b16 v[196:197], v63 offset:20992
  v_pk_fma_f32 v[6:7], v[6:7], v[48:49], v[48:49] op_sel:[0,0,1] op_sel_hi:[1,0,1]
  v_pk_mul_f32 v[6:7], v[6:7], v[46:47]
  v_mfma_f32_32x32x16_bf16 v[136:151], v[228:231], v[172:175], v[136:151]
  ds_read_b64_tr_b16 v[198:199], v65 offset:20992
  ds_read_b128 v[160:163], v56 offset:16384
  ds_read_b64_tr_b16 v[200:201], v63 offset:17408
  v_exp_f32 v6, v6
  v_exp_f32 v7, v7
  v_mfma_f32_32x32x16_bf16 v[120:135], v[232:235], v[176:179], v[120:135]
  ds_read_b64_tr_b16 v[202:203], v65 offset:17408
  ds_read_b64_tr_b16 v[204:205], v63 offset:21504
  ds_read_b64_tr_b16 v[206:207], v65 offset:21504
  s_nop 0
  v_pk_add_f32 v[6:7], v[6:7], v[50:51] op_sel_hi:[1,0]
  v_mfma_f32_32x32x16_bf16 v[136:151], v[236:239], v[176:179], v[136:151]
  ds_read_b128 v[164:167], v58 offset:16384
  ds_read_b64_tr_b16 v[208:209], v63 offset:17920
  ds_read_b64_tr_b16 v[210:211], v65 offset:17920
  v_rcp_f32 v6, v6
  v_rcp_f32 v7, v7
  v_mfma_f32_32x32x16_bf16 v[120:135], v[240:243], v[180:183], v[120:135]
  ds_read_b64_tr_b16 v[212:213], v63 offset:22016
  ds_read_b64_tr_b16 v[214:215], v65 offset:22016
  s_nop 0
  v_pk_mul_f32 v[46:47], v[46:47], v[6:7]
  v_mfma_f32_32x32x16_bf16 v[136:151], v[244:247], v[180:183], v[136:151]
  s_waitcnt lgkmcnt(0)
  s_barrier
  v_mfma_f32_32x32x16_bf16 v[120:135], v[184:187], v[152:155], v[120:135]
  ds_read_b128 v[168:171], v52 offset:32768
  ds_read_b64_tr_b16 v[216:217], v63 offset:24576
  ds_read_b64_tr_b16 v[218:219], v65 offset:24576
  s_waitcnt vmcnt(0)
  v_lshlrev_b32 v66, 16, v66
  v_mfma_f32_32x32x16_bf16 v[136:151], v[188:191], v[152:155], v[136:151]
  ds_read_b64_tr_b16 v[220:221], v63 offset:28672
  ds_read_b64_tr_b16 v[222:223], v65 offset:28672
  ds_read_b128 v[172:175], v54 offset:32768
  v_mfma_f32_32x32x16_bf16 v[120:135], v[192:195], v[156:159], v[120:135]
  ds_read_b64_tr_b16 v[224:225], v63 offset:25088
  ds_read_b64_tr_b16 v[226:227], v65 offset:25088
  ds_read_b64_tr_b16 v[228:229], v63 offset:29184
  v_mfma_f32_32x32x16_bf16 v[136:151], v[196:199], v[156:159], v[136:151]
  ds_read_b64_tr_b16 v[230:231], v65 offset:29184
  ds_read_b128 v[176:179], v56 offset:32768
  ds_read_b64_tr_b16 v[232:233], v63 offset:25600
  v_mfma_f32_32x32x16_bf16 v[120:135], v[200:203], v[160:163], v[120:135]
  ds_read_b64_tr_b16 v[234:235], v65 offset:25600
  ds_read_b64_tr_b16 v[236:237], v63 offset:29696
  ds_read_b64_tr_b16 v[238:239], v65 offset:29696
  v_mfma_f32_32x32x16_bf16 v[136:151], v[204:207], v[160:163], v[136:151]
  ds_read_b128 v[180:183], v58 offset:32768
  ds_read_b64_tr_b16 v[240:241], v63 offset:26112
  ds_read_b64_tr_b16 v[242:243], v65 offset:26112
  v_mfma_f32_32x32x16_bf16 v[120:135], v[208:211], v[164:167], v[120:135]
  ds_read_b64_tr_b16 v[244:245], v63 offset:30208
  ds_read_b64_tr_b16 v[246:247], v65 offset:30208
  v_mfma_f32_32x32x16_bf16 v[136:151], v[212:215], v[164:167], v[136:151]
  s_waitcnt lgkmcnt(0)
  s_barrier
  v_mfma_f32_32x32x16_bf16 v[120:135], v[216:219], v[168:171], v[120:135]
  ds_read_b128 v[152:155], v52 offset:49152
  ds_read_b64_tr_b16 v[184:185], v62 offset:49152
  ds_read_b64_tr_b16 v[186:187], v64 offset:49152
  v_mfma_f32_32x32x16_bf16 v[136:151], v[220:223], v[168:171], v[136:151]
  ds_read_b64_tr_b16 v[188:189], v62 offset:53248
  ds_read_b64_tr_b16 v[190:191], v64 offset:53248
  ds_read_b128 v[156:159], v54 offset:49152
  v_mfma_f32_32x32x16_bf16 v[120:135], v[224:227], v[172:175], v[120:135]
  ds_read_b64_tr_b16 v[192:193], v62 offset:49664
  ds_read_b64_tr_b16 v[194:195], v64 offset:49664
  ds_read_b64_tr_b16 v[196:197], v62 offset:53760
  v_mfma_f32_32x32x16_bf16 v[136:151], v[228:231], v[172:175], v[136:151]
  ds_read_b64_tr_b16 v[198:199], v64 offset:53760
  ds_read_b128 v[160:163], v56 offset:49152
  ds_read_b64_tr_b16 v[200:201], v62 offset:50176
  v_mfma_f32_32x32x16_bf16 v[120:135], v[232:235], v[176:179], v[120:135]
  ds_read_b64_tr_b16 v[202:203], v64 offset:50176
  ds_read_b64_tr_b16 v[204:205], v62 offset:54272
  ds_read_b64_tr_b16 v[206:207], v64 offset:54272
  v_mfma_f32_32x32x16_bf16 v[136:151], v[236:239], v[176:179], v[136:151]
  ds_read_b128 v[164:167], v58 offset:49152
  ds_read_b64_tr_b16 v[208:209], v62 offset:50688
  ds_read_b64_tr_b16 v[210:211], v64 offset:50688
  v_mfma_f32_32x32x16_bf16 v[120:135], v[240:243], v[180:183], v[120:135]
  ds_read_b64_tr_b16 v[212:213], v62 offset:54784
  ds_read_b64_tr_b16 v[214:215], v64 offset:54784
  v_mfma_f32_32x32x16_bf16 v[136:151], v[244:247], v[180:183], v[136:151]
  s_waitcnt lgkmcnt(0)
  s_barrier
  v_mfma_f32_32x32x16_bf16 v[120:135], v[184:187], v[152:155], v[120:135]
  ds_read_b128 v[168:171], v53 offset:0
  ds_read_b64_tr_b16 v[216:217], v62 offset:57344
  ds_read_b64_tr_b16 v[218:219], v64 offset:57344
  v_mfma_f32_32x32x16_bf16 v[136:151], v[188:191], v[152:155], v[136:151]
  ds_read_b64_tr_b16 v[220:221], v62 offset:61440
  ds_read_b64_tr_b16 v[222:223], v64 offset:61440
  ds_read_b128 v[172:175], v55 offset:0
  v_mfma_f32_32x32x16_bf16 v[120:135], v[192:195], v[156:159], v[120:135]
  ds_read_b64_tr_b16 v[224:225], v62 offset:57856
  ds_read_b64_tr_b16 v[226:227], v64 offset:57856
  ds_read_b64_tr_b16 v[228:229], v62 offset:61952
  v_mfma_f32_32x32x16_bf16 v[136:151], v[196:199], v[156:159], v[136:151]
  ds_read_b64_tr_b16 v[230:231], v64 offset:61952
  ds_read_b128 v[176:179], v57 offset:0
  ds_read_b64_tr_b16 v[232:233], v62 offset:58368
  v_mfma_f32_32x32x16_bf16 v[120:135], v[200:203], v[160:163], v[120:135]
  ds_read_b64_tr_b16 v[234:235], v64 offset:58368
  ds_read_b64_tr_b16 v[236:237], v62 offset:62464
  ds_read_b64_tr_b16 v[238:239], v64 offset:62464
  v_mfma_f32_32x32x16_bf16 v[136:151], v[204:207], v[160:163], v[136:151]
  ds_read_b128 v[180:183], v59 offset:0
  ds_read_b64_tr_b16 v[240:241], v62 offset:58880
  ds_read_b64_tr_b16 v[242:243], v64 offset:58880
  v_mfma_f32_32x32x16_bf16 v[120:135], v[208:211], v[164:167], v[120:135]
  ds_read_b64_tr_b16 v[244:245], v62 offset:62976
  ds_read_b64_tr_b16 v[246:247], v64 offset:62976
  v_mfma_f32_32x32x16_bf16 v[136:151], v[212:215], v[164:167], v[136:151]
  s_waitcnt lgkmcnt(0)
  s_barrier
  v_mfma_f32_32x32x16_bf16 v[120:135], v[216:219], v[168:171], v[120:135]
  ds_read_b128 v[152:155], v53 offset:16384
  ds_read_b64_tr_b16 v[184:185], v63 offset:0
  ds_read_b64_tr_b16 v[186:187], v65 offset:0
  v_mfma_f32_32x32x16_bf16 v[136:151], v[220:223], v[168:171], v[136:151]
  ds_read_b64_tr_b16 v[188:189], v63 offset:4096
  ds_read_b64_tr_b16 v[190:191], v65 offset:4096
  ds_read_b128 v[156:159], v55 offset:16384
  v_mfma_f32_32x32x16_bf16 v[120:135], v[224:227], v[172:175], v[120:135]
  ds_read_b64_tr_b16 v[192:193], v63 offset:512
  ds_read_b64_tr_b16 v[194:195], v65 offset:512
  ds_read_b64_tr_b16 v[196:197], v63 offset:4608
  v_mfma_f32_32x32x16_bf16 v[136:151], v[228:231], v[172:175], v[136:151]
  ds_read_b64_tr_b16 v[198:199], v65 offset:4608
  ds_read_b128 v[160:163], v57 offset:16384
  ds_read_b64_tr_b16 v[200:201], v63 offset:1024
  v_mfma_f32_32x32x16_bf16 v[120:135], v[232:235], v[176:179], v[120:135]
  ds_read_b64_tr_b16 v[202:203], v65 offset:1024
  ds_read_b64_tr_b16 v[204:205], v63 offset:5120
  ds_read_b64_tr_b16 v[206:207], v65 offset:5120
  v_mfma_f32_32x32x16_bf16 v[136:151], v[236:239], v[176:179], v[136:151]
  ds_read_b128 v[164:167], v59 offset:16384
  ds_read_b64_tr_b16 v[208:209], v63 offset:1536
  ds_read_b64_tr_b16 v[210:211], v65 offset:1536
  v_mfma_f32_32x32x16_bf16 v[120:135], v[240:243], v[180:183], v[120:135]
  ds_read_b64_tr_b16 v[212:213], v63 offset:5632
  ds_read_b64_tr_b16 v[214:215], v65 offset:5632
  v_mfma_f32_32x32x16_bf16 v[136:151], v[244:247], v[180:183], v[136:151]
  s_waitcnt lgkmcnt(0)
  s_barrier
  v_mfma_f32_32x32x16_bf16 v[120:135], v[184:187], v[152:155], v[120:135]
  ds_read_b128 v[168:171], v53 offset:32768
  ds_read_b64_tr_b16 v[216:217], v63 offset:8192
  ds_read_b64_tr_b16 v[218:219], v65 offset:8192
  v_mfma_f32_32x32x16_bf16 v[136:151], v[188:191], v[152:155], v[136:151]
  ds_read_b64_tr_b16 v[220:221], v63 offset:12288
  ds_read_b64_tr_b16 v[222:223], v65 offset:12288
  ds_read_b128 v[172:175], v55 offset:32768
  v_mfma_f32_32x32x16_bf16 v[120:135], v[192:195], v[156:159], v[120:135]
  ds_read_b64_tr_b16 v[224:225], v63 offset:8704
  ds_read_b64_tr_b16 v[226:227], v65 offset:8704
  ds_read_b64_tr_b16 v[228:229], v63 offset:12800
  v_mfma_f32_32x32x16_bf16 v[136:151], v[196:199], v[156:159], v[136:151]
  ds_read_b64_tr_b16 v[230:231], v65 offset:12800
  ds_read_b128 v[176:179], v57 offset:32768
  ds_read_b64_tr_b16 v[232:233], v63 offset:9216
  v_mfma_f32_32x32x16_bf16 v[120:135], v[200:203], v[160:163], v[120:135]
  ds_read_b64_tr_b16 v[234:235], v65 offset:9216
  ds_read_b64_tr_b16 v[236:237], v63 offset:13312
  ds_read_b64_tr_b16 v[238:239], v65 offset:13312
  v_mfma_f32_32x32x16_bf16 v[136:151], v[204:207], v[160:163], v[136:151]
  ds_read_b128 v[180:183], v59 offset:32768
  ds_read_b64_tr_b16 v[240:241], v63 offset:9728
  ds_read_b64_tr_b16 v[242:243], v65 offset:9728
  v_mfma_f32_32x32x16_bf16 v[120:135], v[208:211], v[164:167], v[120:135]
  ds_read_b64_tr_b16 v[244:245], v63 offset:13824
  ds_read_b64_tr_b16 v[246:247], v65 offset:13824
  v_mfma_f32_32x32x16_bf16 v[136:151], v[212:215], v[164:167], v[136:151]
  s_waitcnt lgkmcnt(0)
  s_barrier
  v_mfma_f32_32x32x16_bf16 v[120:135], v[216:219], v[168:171], v[120:135]
  ds_read_b128 v[152:155], v52 offset:0
  ds_read_b64_tr_b16 v[184:185], v63 offset:16384
  ds_read_b64_tr_b16 v[186:187], v65 offset:16384
  v_mfma_f32_32x32x16_bf16 v[136:151], v[220:223], v[168:171], v[136:151]
  ds_read_b64_tr_b16 v[188:189], v63 offset:20480
  ds_read_b64_tr_b16 v[190:191], v65 offset:20480
  ds_read_b128 v[156:159], v54 offset:0
  v_mfma_f32_32x32x16_bf16 v[120:135], v[224:227], v[172:175], v[120:135]
  ds_read_b64_tr_b16 v[192:193], v63 offset:16896
  ds_read_b64_tr_b16 v[194:195], v65 offset:16896
  ds_read_b64_tr_b16 v[196:197], v63 offset:20992
  v_mfma_f32_32x32x16_bf16 v[136:151], v[228:231], v[172:175], v[136:151]
  ds_read_b64_tr_b16 v[198:199], v65 offset:20992
  ds_read_b128 v[160:163], v56 offset:0
  ds_read_b64_tr_b16 v[200:201], v63 offset:17408
  v_mfma_f32_32x32x16_bf16 v[120:135], v[232:235], v[176:179], v[120:135]
  ds_read_b64_tr_b16 v[202:203], v65 offset:17408
  ds_read_b64_tr_b16 v[204:205], v63 offset:21504
  ds_read_b64_tr_b16 v[206:207], v65 offset:21504
  v_mfma_f32_32x32x16_bf16 v[136:151], v[236:239], v[176:179], v[136:151]
  ds_read_b128 v[164:167], v58 offset:0
  ds_read_b64_tr_b16 v[208:209], v63 offset:17920
  ds_read_b64_tr_b16 v[210:211], v65 offset:17920
  v_mfma_f32_32x32x16_bf16 v[120:135], v[240:243], v[180:183], v[120:135]
  ds_read_b64_tr_b16 v[212:213], v63 offset:22016
  ds_read_b64_tr_b16 v[214:215], v65 offset:22016
  v_mfma_f32_32x32x16_bf16 v[136:151], v[244:247], v[180:183], v[136:151]
  s_waitcnt lgkmcnt(0)
  s_barrier
  v_mfma_f32_32x32x16_bf16 v[120:135], v[184:187], v[152:155], v[120:135]
  ds_read_b128 v[168:171], v52 offset:16384
  ds_read_b64_tr_b16 v[216:217], v63 offset:24576
  ds_read_b64_tr_b16 v[218:219], v65 offset:24576
  v_mfma_f32_32x32x16_bf16 v[136:151], v[188:191], v[152:155], v[136:151]
  ds_read_b64_tr_b16 v[220:221], v63 offset:28672
  ds_read_b64_tr_b16 v[222:223], v65 offset:28672
  ds_read_b128 v[172:175], v54 offset:16384
  v_mfma_f32_32x32x16_bf16 v[120:135], v[192:195], v[156:159], v[120:135]
  ds_read_b64_tr_b16 v[224:225], v63 offset:25088
  ds_read_b64_tr_b16 v[226:227], v65 offset:25088
  ds_read_b64_tr_b16 v[228:229], v63 offset:29184
  v_mfma_f32_32x32x16_bf16 v[136:151], v[196:199], v[156:159], v[136:151]
  ds_read_b64_tr_b16 v[230:231], v65 offset:29184
  ds_read_b128 v[176:179], v56 offset:16384
  ds_read_b64_tr_b16 v[232:233], v63 offset:25600
  v_mfma_f32_32x32x16_bf16 v[120:135], v[200:203], v[160:163], v[120:135]
  ds_read_b64_tr_b16 v[234:235], v65 offset:25600
  ds_read_b64_tr_b16 v[236:237], v63 offset:29696
  ds_read_b64_tr_b16 v[238:239], v65 offset:29696
  v_mfma_f32_32x32x16_bf16 v[136:151], v[204:207], v[160:163], v[136:151]
  ds_read_b128 v[180:183], v58 offset:16384
  ds_read_b64_tr_b16 v[240:241], v63 offset:26112
  ds_read_b64_tr_b16 v[242:243], v65 offset:26112
  v_mfma_f32_32x32x16_bf16 v[120:135], v[208:211], v[164:167], v[120:135]
  ds_read_b64_tr_b16 v[244:245], v63 offset:30208
  ds_read_b64_tr_b16 v[246:247], v65 offset:30208
  v_mfma_f32_32x32x16_bf16 v[136:151], v[212:215], v[164:167], v[136:151]
  s_waitcnt lgkmcnt(0)
  s_barrier
  v_mfma_f32_32x32x16_bf16 v[120:135], v[216:219], v[168:171], v[120:135]
  ds_read_b128 v[152:155], v52 offset:32768
  ds_read_b64_tr_b16 v[184:185], v62 offset:49152
  ds_read_b64_tr_b16 v[186:187], v64 offset:49152
  v_mfma_f32_32x32x16_bf16 v[136:151], v[220:223], v[168:171], v[136:151]
  ds_read_b64_tr_b16 v[188:189], v62 offset:53248
  ds_read_b64_tr_b16 v[190:191], v64 offset:53248
  ds_read_b128 v[156:159], v54 offset:32768
  v_mfma_f32_32x32x16_bf16 v[120:135], v[224:227], v[172:175], v[120:135]
  ds_read_b64_tr_b16 v[192:193], v62 offset:49664
  ds_read_b64_tr_b16 v[194:195], v64 offset:49664
  ds_read_b64_tr_b16 v[196:197], v62 offset:53760
  v_mfma_f32_32x32x16_bf16 v[136:151], v[228:231], v[172:175], v[136:151]
  ds_read_b64_tr_b16 v[198:199], v64 offset:53760
  ds_read_b128 v[160:163], v56 offset:32768
  ds_read_b64_tr_b16 v[200:201], v62 offset:50176
  v_mfma_f32_32x32x16_bf16 v[120:135], v[232:235], v[176:179], v[120:135]
  ds_read_b64_tr_b16 v[202:203], v64 offset:50176
  ds_read_b64_tr_b16 v[204:205], v62 offset:54272
  ds_read_b64_tr_b16 v[206:207], v64 offset:54272
  v_mfma_f32_32x32x16_bf16 v[136:151], v[236:239], v[176:179], v[136:151]
  ds_read_b128 v[164:167], v58 offset:32768
  ds_read_b64_tr_b16 v[208:209], v62 offset:50688
  ds_read_b64_tr_b16 v[210:211], v64 offset:50688
  v_mfma_f32_32x32x16_bf16 v[120:135], v[240:243], v[180:183], v[120:135]
  ds_read_b64_tr_b16 v[212:213], v62 offset:54784
  ds_read_b64_tr_b16 v[214:215], v64 offset:54784
  v_mfma_f32_32x32x16_bf16 v[136:151], v[244:247], v[180:183], v[136:151]
  s_waitcnt lgkmcnt(0)
  s_barrier
  v_mfma_f32_32x32x16_bf16 v[120:135], v[184:187], v[152:155], v[120:135]
  ds_read_b128 v[168:171], v52 offset:49152
  ds_read_b64_tr_b16 v[216:217], v62 offset:57344
  ds_read_b64_tr_b16 v[218:219], v64 offset:57344
  v_mfma_f32_32x32x16_bf16 v[136:151], v[188:191], v[152:155], v[136:151]
  ds_read_b64_tr_b16 v[220:221], v62 offset:61440
  ds_read_b64_tr_b16 v[222:223], v64 offset:61440
  ds_read_b128 v[172:175], v54 offset:49152
  v_mfma_f32_32x32x16_bf16 v[120:135], v[192:195], v[156:159], v[120:135]
  ds_read_b64_tr_b16 v[224:225], v62 offset:57856
  ds_read_b64_tr_b16 v[226:227], v64 offset:57856
  ds_read_b64_tr_b16 v[228:229], v62 offset:61952
  v_mfma_f32_32x32x16_bf16 v[136:151], v[196:199], v[156:159], v[136:151]
  ds_read_b64_tr_b16 v[230:231], v64 offset:61952
  ds_read_b128 v[176:179], v56 offset:49152
  ds_read_b64_tr_b16 v[232:233], v62 offset:58368
  v_mfma_f32_32x32x16_bf16 v[120:135], v[200:203], v[160:163], v[120:135]
  ds_read_b64_tr_b16 v[234:235], v64 offset:58368
  ds_read_b64_tr_b16 v[236:237], v62 offset:62464
  ds_read_b64_tr_b16 v[238:239], v64 offset:62464
  v_mfma_f32_32x32x16_bf16 v[136:151], v[204:207], v[160:163], v[136:151]
  ds_read_b128 v[180:183], v58 offset:49152
  ds_read_b64_tr_b16 v[240:241], v62 offset:58880
  ds_read_b64_tr_b16 v[242:243], v64 offset:58880
  v_mfma_f32_32x32x16_bf16 v[120:135], v[208:211], v[164:167], v[120:135]
  ds_read_b64_tr_b16 v[244:245], v62 offset:62976
  ds_read_b64_tr_b16 v[246:247], v64 offset:62976
  v_mfma_f32_32x32x16_bf16 v[136:151], v[212:215], v[164:167], v[136:151]
  s_waitcnt lgkmcnt(0)
  s_barrier
  v_mfma_f32_32x32x16_bf16 v[120:135], v[216:219], v[168:171], v[120:135]
  v_mfma_f32_32x32x16_bf16 v[136:151], v[220:223], v[168:171], v[136:151]
  v_mfma_f32_32x32x16_bf16 v[120:135], v[224:227], v[172:175], v[120:135]
  v_mfma_f32_32x32x16_bf16 v[136:151], v[228:231], v[172:175], v[136:151]
  v_mfma_f32_32x32x16_bf16 v[120:135], v[232:235], v[176:179], v[120:135]
  v_mfma_f32_32x32x16_bf16 v[136:151], v[236:239], v[176:179], v[136:151]
  v_mfma_f32_32x32x16_bf16 v[120:135], v[240:243], v[180:183], v[120:135]
  v_mfma_f32_32x32x16_bf16 v[136:151], v[244:247], v[180:183], v[136:151]
  s_nop 7
  s_nop 3
  v_pk_add_f32 v[120:121], v[120:121], v[66:67] op_sel_hi:[1,0]
  v_pk_add_f32 v[122:123], v[122:123], v[66:67] op_sel_hi:[1,0]
  v_pk_add_f32 v[124:125], v[124:125], v[66:67] op_sel_hi:[1,0]
  v_pk_add_f32 v[126:127], v[126:127], v[66:67] op_sel_hi:[1,0]
  v_pk_mul_f32 v[120:121], v[120:121], v[16:17]
  v_pk_mul_f32 v[122:123], v[122:123], v[18:19]
  v_pk_mul_f32 v[124:125], v[124:125], v[20:21]
  v_pk_mul_f32 v[126:127], v[126:127], v[22:23]
  v_cvt_pk_bf16_f32 v152, v120, v121
  v_cvt_pk_bf16_f32 v153, v122, v123
  v_cvt_pk_bf16_f32 v154, v124, v125
  v_cvt_pk_bf16_f32 v155, v126, v127
  buffer_store_dwordx4 v[152:155], v68, s[60:63], s16 offen offset:0 sc1
  v_pk_add_f32 v[128:129], v[128:129], v[66:67] op_sel_hi:[1,0]
  v_pk_add_f32 v[130:131], v[130:131], v[66:67] op_sel_hi:[1,0]
  v_pk_add_f32 v[132:133], v[132:133], v[66:67] op_sel_hi:[1,0]
  v_pk_add_f32 v[134:135], v[134:135], v[66:67] op_sel_hi:[1,0]
  v_pk_mul_f32 v[128:129], v[128:129], v[24:25]
  v_pk_mul_f32 v[130:131], v[130:131], v[26:27]
  v_pk_mul_f32 v[132:133], v[132:133], v[28:29]
  v_pk_mul_f32 v[134:135], v[134:135], v[30:31]
  v_cvt_pk_bf16_f32 v156, v128, v129
  v_cvt_pk_bf16_f32 v157, v130, v131
  v_cvt_pk_bf16_f32 v158, v132, v133
  v_cvt_pk_bf16_f32 v159, v134, v135
  buffer_store_dwordx4 v[156:159], v68, s[60:63], s16 offen offset:1024 sc1
  v_pk_add_f32 v[136:137], v[136:137], v[66:67] op_sel_hi:[1,0]
  v_pk_add_f32 v[138:139], v[138:139], v[66:67] op_sel_hi:[1,0]
  v_pk_add_f32 v[140:141], v[140:141], v[66:67] op_sel_hi:[1,0]
  v_pk_add_f32 v[142:143], v[142:143], v[66:67] op_sel_hi:[1,0]
  v_pk_mul_f32 v[136:137], v[136:137], v[32:33]
  v_pk_mul_f32 v[138:139], v[138:139], v[34:35]
  v_pk_mul_f32 v[140:141], v[140:141], v[36:37]
  v_pk_mul_f32 v[142:143], v[142:143], v[38:39]
  v_cvt_pk_bf16_f32 v160, v136, v137
  v_cvt_pk_bf16_f32 v161, v138, v139
  v_cvt_pk_bf16_f32 v162, v140, v141
  v_cvt_pk_bf16_f32 v163, v142, v143
  buffer_store_dwordx4 v[160:163], v68, s[60:63], s16 offen offset:2048 sc1
  v_pk_add_f32 v[144:145], v[144:145], v[66:67] op_sel_hi:[1,0]
  v_pk_add_f32 v[146:147], v[146:147], v[66:67] op_sel_hi:[1,0]
  v_pk_add_f32 v[148:149], v[148:149], v[66:67] op_sel_hi:[1,0]
  v_pk_add_f32 v[150:151], v[150:151], v[66:67] op_sel_hi:[1,0]
  v_pk_mul_f32 v[144:145], v[144:145], v[40:41]
  v_pk_mul_f32 v[146:147], v[146:147], v[42:43]
  v_pk_mul_f32 v[148:149], v[148:149], v[44:45]
  v_pk_mul_f32 v[150:151], v[150:151], v[46:47]
  v_cvt_pk_bf16_f32 v164, v144, v145
  v_cvt_pk_bf16_f32 v165, v146, v147
  v_cvt_pk_bf16_f32 v166, v148, v149
  v_cvt_pk_bf16_f32 v167, v150, v151
  buffer_store_dwordx4 v[164:167], v68, s[60:63], s16 offen offset:3072 sc1
  v_mov_b32 v2, s76
  v_mov_b32 v3, s77
  v_lshlrev_b32 v4, 3, v1
  s_mov_b64 exec, 0xffff
  s_waitcnt vmcnt(0)
  buffer_store_dwordx2 v[2:3], v4, s[60:63], s83 offen sc1
  s_mov_b64 exec, -1
  s_lshr_b32 s44, s43, 16
  s_and_b32 s45, s44, 3
  s_add_u32 s45, s45, 60
  s_lshl_b32 s45, s45, 7
  s_lshl_b32 s46, s4, 13
  s_add_u32 s45, s45, s46
  s_add_u32 s45, s45, 0x11c0000
  v_mov_b32 v220, s45
  s_lshl_b32 s44, s44, 15
  s_and_b32 s45, s43, 0x780
  s_lshl4_add_u32 s44, s45, s44
  s_add_u32 s45, s44, 0xf00000
  s_add_u32 s44, s44, 0xd00000
  s_mov_b32 s46, 0x1100000
  s_mov_b64 exec, 1
  buffer_load_dwordx2 v[222:223], v220, s[60:63], 0 offen sc1
  s_mov_b64 exec, -1
  s_mov_b32 s85, 0x40000
  s_mov_b64 exec, 1
  s_branch fchk_53
fpoll_51:
  buffer_load_dwordx2 v[222:223], v220, s[60:63], 0 offen sc1
fchk_53:
  s_waitcnt vmcnt(0)
  v_cmp_ne_u64 vcc, s[76:77], v[222:223]
  s_and_b64 exec, exec, vcc
  s_cbranch_execz fdone_52
  s_sub_u32 s85, s85, 1
  s_cbranch_scc1 fdone_52
  s_sleep 2
  s_branch fpoll_51
fdone_52:
  s_mov_b64 exec, -1
  v_lshrrev_b32 v220, 11, v15
  v_lshlrev_b32 v220, 3, v220
  v_lshlrev_b32 v221, 4, v1
  buffer_load_dwordx2 v[240:241], v220, s[60:63], s46 offen sc1
  buffer_load_dwordx4 v[242:245], v221, s[60:63], s45 offen offset:0 sc1
  buffer_load_dwordx4 v[246:249], v221, s[60:63], s45 offen offset:1024 sc1
  s_waitcnt vmcnt(0)
  v_lshlrev_b32 v224, 16, v242
  v_and_b32 v225, 0xffff0000, v242
  v_lshlrev_b32 v226, 16, v243
  v_and_b32 v227, 0xffff0000, v243
  v_lshlrev_b32 v228, 16, v244
  v_and_b32 v229, 0xffff0000, v244
  v_lshlrev_b32 v230, 16, v245
  v_and_b32 v231, 0xffff0000, v245
  v_lshlrev_b32 v232, 16, v246
  v_and_b32 v233, 0xffff0000, v246
  v_lshlrev_b32 v234, 16, v247
  v_and_b32 v235, 0xffff0000, v247
  v_lshlrev_b32 v236, 16, v248
  v_and_b32 v237, 0xffff0000, v248
  v_lshlrev_b32 v238, 16, v249
  v_and_b32 v239, 0xffff0000, v249
  v_pk_mul_f32 v[224:225], v[224:225], v[240:241] op_sel_hi:[1,0]
  v_pk_mul_f32 v[226:227], v[226:227], v[240:241] op_sel_hi:[1,0]
  v_pk_mul_f32 v[228:229], v[228:229], v[240:241] op_sel_hi:[1,0]
  v_pk_mul_f32 v[230:231], v[230:231], v[240:241] op_sel_hi:[1,0]
  v_pk_mul_f32 v[232:233], v[232:233], v[240:241] op_sel_hi:[1,0]
  v_pk_mul_f32 v[234:235], v[234:235], v[240:241] op_sel_hi:[1,0]
  v_pk_mul_f32 v[236:237], v[236:237], v[240:241] op_sel_hi:[1,0]
  v_pk_mul_f32 v[238:239], v[238:239], v[240:241] op_sel_hi:[1,0]
  s_branch L_p3cons
L_ycons:
  s_lshl_b32 s11, s34, 13
  v_xor_b32 v2, 0, v14
  v_add_u32 v16, s11, v2
  v_add_u32 v17, 0x10000, v16
  v_xor_b32 v2, 32, v14
  v_add_u32 v18, s11, v2
  v_add_u32 v19, 0x10000, v18
  v_xor_b32 v2, 64, v14
  v_add_u32 v20, s11, v2
  v_add_u32 v21, 0x10000, v20
  v_xor_b32 v2, 96, v14
  v_add_u32 v22, s11, v2
  v_add_u32 v23, 0x10000, v22
  v_bfe_u32 v2, v1, 4, 1
  v_bfe_u32 v3, v1, 1, 1
  v_lshl_add_u32 v2, v2, 1, v3
  v_bfe_u32 v3, v1, 2, 2
  v_lshl_add_u32 v3, v13, 3, v3
  v_lshlrev_b32 v4, 2, v2
  v_xor_b32 v3, v3, v4
  v_lshlrev_b32 v3, 4, v3
  v_lshl_add_u32 v3, v2, 10, v3
  v_and_b32 v2, 1, v1
  v_lshl_add_u32 v3, v2, 3, v3
  s_lshl_b32 s11, s35, 9
  v_add_u32 v24, s11, v3
  v_xor_b32 v25, 64, v24
  v_add_u32 v26, 0x10000, v24
  v_add_u32 v27, 0x20000, v24
  v_add_u32 v28, 0x10000, v25
  v_add_u32 v29, 0x20000, v25
  v_lshlrev_b32 v160, 4, v1
  s_lshl1_add_u32 s11, s4, s35
  s_lshl_b32 s11, s11, 16
  s_sub_u32 s12, s8, 11
  s_lshl1_add_u32 s12, s12, s34
  s_lshl_b32 s12, s12, 12
  s_add_u32 s11, s11, s12
  s_add_u32 s16, s11, 0xd00000
  s_add_u32 s17, s16, 32768
  v_mov_b32 v4, s76
  v_mov_b32 v5, s77
  v_lshlrev_b32 v6, 3, v1
  s_mov_b64 exec, 0xffff
  s_waitcnt vmcnt(0)
  buffer_store_dwordx2 v[4:5], v6, s[60:63], s40 offen sc1
  s_mov_b64 exec, -1
  s_barrier
  ds_read_b128 v[32:35], v16 offset:0
  ds_read_b64_tr_b16 v[64:65], v26 offset:32768
  ds_read_b64_tr_b16 v[66:67], v28 offset:32768
  ds_read_b128 v[36:39], v16 offset:4096
  ds_read_b64_tr_b16 v[68:69], v26 offset:33024
  ds_read_b64_tr_b16 v[70:71], v28 offset:33024
  ds_read_b128 v[40:43], v18 offset:0
  ds_read_b64_tr_b16 v[72:73], v26 offset:36864
  ds_read_b64_tr_b16 v[74:75], v28 offset:36864
  ds_read_b128 v[44:47], v18 offset:4096
  ds_read_b64_tr_b16 v[76:77], v26 offset:37120
  ds_read_b64_tr_b16 v[78:79], v28 offset:37120
  s_waitcnt lgkmcnt(0)
  v_mfma_f32_32x32x16_bf16 v[96:111], v[32:35], v[64:67], 0
  ds_read_b128 v[48:51], v20 offset:0
  ds_read_b64_tr_b16 v[80:81], v26 offset:40960
  v_mfma_f32_32x32x16_bf16 v[112:127], v[36:39], v[64:67], 0
  ds_read_b64_tr_b16 v[82:83], v28 offset:40960
  ds_read_b128 v[52:55], v20 offset:4096
  v_mfma_f32_32x32x16_bf16 v[128:143], v[32:35], v[68:71], 0
  ds_read_b64_tr_b16 v[84:85], v26 offset:41216
  ds_read_b64_tr_b16 v[86:87], v28 offset:41216
  v_mfma_f32_32x32x16_bf16 v[144:159], v[36:39], v[68:71], 0
  ds_read_b128 v[56:59], v22 offset:0
  ds_read_b64_tr_b16 v[88:89], v26 offset:45056
  v_mfma_f32_32x32x16_bf16 v[96:111], v[40:43], v[72:75], v[96:111]
  ds_read_b64_tr_b16 v[90:91], v28 offset:45056
  ds_read_b128 v[60:63], v22 offset:4096
  v_mfma_f32_32x32x16_bf16 v[112:127], v[44:47], v[72:75], v[112:127]
  ds_read_b64_tr_b16 v[92:93], v26 offset:45312
  ds_read_b64_tr_b16 v[94:95], v28 offset:45312
  v_mfma_f32_32x32x16_bf16 v[128:143], v[40:43], v[76:79], v[128:143]
  v_mfma_f32_32x32x16_bf16 v[144:159], v[44:47], v[76:79], v[144:159]
  s_waitcnt lgkmcnt(0)
  s_barrier
  v_mfma_f32_32x32x16_bf16 v[96:111], v[48:51], v[80:83], v[96:111]
  ds_read_b128 v[32:35], v16 offset:16384
  ds_read_b64_tr_b16 v[64:65], v26 offset:49152
  v_mfma_f32_32x32x16_bf16 v[112:127], v[52:55], v[80:83], v[112:127]
  ds_read_b64_tr_b16 v[66:67], v28 offset:49152
  ds_read_b128 v[36:39], v16 offset:20480
  v_mfma_f32_32x32x16_bf16 v[128:143], v[48:51], v[84:87], v[128:143]
  ds_read_b64_tr_b16 v[68:69], v26 offset:49408
  ds_read_b64_tr_b16 v[70:71], v28 offset:49408
  v_mfma_f32_32x32x16_bf16 v[144:159], v[52:55], v[84:87], v[144:159]
  ds_read_b128 v[40:43], v18 offset:16384
  ds_read_b64_tr_b16 v[72:73], v26 offset:53248
  v_mfma_f32_32x32x16_bf16 v[96:111], v[56:59], v[88:91], v[96:111]
  ds_read_b64_tr_b16 v[74:75], v28 offset:53248
  ds_read_b128 v[44:47], v18 offset:20480
  v_mfma_f32_32x32x16_bf16 v[112:127], v[60:63], v[88:91], v[112:127]
  ds_read_b64_tr_b16 v[76:77], v26 offset:53504
  ds_read_b64_tr_b16 v[78:79], v28 offset:53504
  v_mfma_f32_32x32x16_bf16 v[128:143], v[56:59], v[92:95], v[128:143]
  v_mfma_f32_32x32x16_bf16 v[144:159], v[60:63], v[92:95], v[144:159]
  s_waitcnt lgkmcnt(0)
  v_mfma_f32_32x32x16_bf16 v[96:111], v[32:35], v[64:67], v[96:111]
  ds_read_b128 v[48:51], v20 offset:16384
  ds_read_b64_tr_b16 v[80:81], v26 offset:57344
  v_mfma_f32_32x32x16_bf16 v[112:127], v[36:39], v[64:67], v[112:127]
  ds_read_b64_tr_b16 v[82:83], v28 offset:57344
  ds_read_b128 v[52:55], v20 offset:20480
  v_mfma_f32_32x32x16_bf16 v[128:143], v[32:35], v[68:71], v[128:143]
  ds_read_b64_tr_b16 v[84:85], v26 offset:57600
  ds_read_b64_tr_b16 v[86:87], v28 offset:57600
  v_mfma_f32_32x32x16_bf16 v[144:159], v[36:39], v[68:71], v[144:159]
  ds_read_b128 v[56:59], v22 offset:16384
  ds_read_b64_tr_b16 v[88:89], v26 offset:61440
  v_mfma_f32_32x32x16_bf16 v[96:111], v[40:43], v[72:75], v[96:111]
  ds_read_b64_tr_b16 v[90:91], v28 offset:61440
  ds_read_b128 v[60:63], v22 offset:20480
  v_mfma_f32_32x32x16_bf16 v[112:127], v[44:47], v[72:75], v[112:127]
  ds_read_b64_tr_b16 v[92:93], v26 offset:61696
  ds_read_b64_tr_b16 v[94:95], v28 offset:61696
  v_mfma_f32_32x32x16_bf16 v[128:143], v[40:43], v[76:79], v[128:143]
  v_mfma_f32_32x32x16_bf16 v[144:159], v[44:47], v[76:79], v[144:159]
  s_waitcnt lgkmcnt(0)
  s_barrier
  v_mfma_f32_32x32x16_bf16 v[96:111], v[48:51], v[80:83], v[96:111]
  ds_read_b128 v[32:35], v16 offset:32768
  ds_read_b64_tr_b16 v[64:65], v27 offset:0
  v_mfma_f32_32x32x16_bf16 v[112:127], v[52:55], v[80:83], v[112:127]
  ds_read_b64_tr_b16 v[66:67], v29 offset:0
  ds_read_b128 v[36:39], v16 offset:36864
  v_mfma_f32_32x32x16_bf16 v[128:143], v[48:51], v[84:87], v[128:143]
  ds_read_b64_tr_b16 v[68:69], v27 offset:256
  ds_read_b64_tr_b16 v[70:71], v29 offset:256
  v_mfma_f32_32x32x16_bf16 v[144:159], v[52:55], v[84:87], v[144:159]
  ds_read_b128 v[40:43], v18 offset:32768
  ds_read_b64_tr_b16 v[72:73], v27 offset:4096
  v_mfma_f32_32x32x16_bf16 v[96:111], v[56:59], v[88:91], v[96:111]
  ds_read_b64_tr_b16 v[74:75], v29 offset:4096
  ds_read_b128 v[44:47], v18 offset:36864
  v_mfma_f32_32x32x16_bf16 v[112:127], v[60:63], v[88:91], v[112:127]
  ds_read_b64_tr_b16 v[76:77], v27 offset:4352
  ds_read_b64_tr_b16 v[78:79], v29 offset:4352
  v_mfma_f32_32x32x16_bf16 v[128:143], v[56:59], v[92:95], v[128:143]
  v_mfma_f32_32x32x16_bf16 v[144:159], v[60:63], v[92:95], v[144:159]
  s_waitcnt lgkmcnt(0)
  v_mfma_f32_32x32x16_bf16 v[96:111], v[32:35], v[64:67], v[96:111]
  ds_read_b128 v[48:51], v20 offset:32768
  ds_read_b64_tr_b16 v[80:81], v27 offset:8192
  v_mfma_f32_32x32x16_bf16 v[112:127], v[36:39], v[64:67], v[112:127]
  ds_read_b64_tr_b16 v[82:83], v29 offset:8192
  ds_read_b128 v[52:55], v20 offset:36864
  v_mfma_f32_32x32x16_bf16 v[128:143], v[32:35], v[68:71], v[128:143]
  ds_read_b64_tr_b16 v[84:85], v27 offset:8448
  ds_read_b64_tr_b16 v[86:87], v29 offset:8448
  v_mfma_f32_32x32x16_bf16 v[144:159], v[36:39], v[68:71], v[144:159]
  ds_read_b128 v[56:59], v22 offset:32768
  ds_read_b64_tr_b16 v[88:89], v27 offset:12288
  v_mfma_f32_32x32x16_bf16 v[96:111], v[40:43], v[72:75], v[96:111]
  ds_read_b64_tr_b16 v[90:91], v29 offset:12288
  ds_read_b128 v[60:63], v22 offset:36864
  v_mfma_f32_32x32x16_bf16 v[112:127], v[44:47], v[72:75], v[112:127]
  ds_read_b64_tr_b16 v[92:93], v27 offset:12544
  ds_read_b64_tr_b16 v[94:95], v29 offset:12544
  v_mfma_f32_32x32x16_bf16 v[128:143], v[40:43], v[76:79], v[128:143]
  v_mfma_f32_32x32x16_bf16 v[144:159], v[44:47], v[76:79], v[144:159]
  s_waitcnt lgkmcnt(0)
  s_barrier
  v_mfma_f32_32x32x16_bf16 v[96:111], v[48:51], v[80:83], v[96:111]
  ds_read_b128 v[32:35], v16 offset:49152
  ds_read_b64_tr_b16 v[64:65], v27 offset:16384
  v_mfma_f32_32x32x16_bf16 v[112:127], v[52:55], v[80:83], v[112:127]
  ds_read_b64_tr_b16 v[66:67], v29 offset:16384
  ds_read_b128 v[36:39], v16 offset:53248
  v_mfma_f32_32x32x16_bf16 v[128:143], v[48:51], v[84:87], v[128:143]
  ds_read_b64_tr_b16 v[68:69], v27 offset:16640
  ds_read_b64_tr_b16 v[70:71], v29 offset:16640
  v_mfma_f32_32x32x16_bf16 v[144:159], v[52:55], v[84:87], v[144:159]
  ds_read_b128 v[40:43], v18 offset:49152
  ds_read_b64_tr_b16 v[72:73], v27 offset:20480
  v_mfma_f32_32x32x16_bf16 v[96:111], v[56:59], v[88:91], v[96:111]
  ds_read_b64_tr_b16 v[74:75], v29 offset:20480
  ds_read_b128 v[44:47], v18 offset:53248
  v_mfma_f32_32x32x16_bf16 v[112:127], v[60:63], v[88:91], v[112:127]
  ds_read_b64_tr_b16 v[76:77], v27 offset:20736
  ds_read_b64_tr_b16 v[78:79], v29 offset:20736
  v_mfma_f32_32x32x16_bf16 v[128:143], v[56:59], v[92:95], v[128:143]
  v_mfma_f32_32x32x16_bf16 v[144:159], v[60:63], v[92:95], v[144:159]
  s_waitcnt lgkmcnt(0)
  v_mfma_f32_32x32x16_bf16 v[96:111], v[32:35], v[64:67], v[96:111]
  ds_read_b128 v[48:51], v20 offset:49152
  ds_read_b64_tr_b16 v[80:81], v27 offset:24576
  v_mfma_f32_32x32x16_bf16 v[112:127], v[36:39], v[64:67], v[112:127]
  ds_read_b64_tr_b16 v[82:83], v29 offset:24576
  ds_read_b128 v[52:55], v20 offset:53248
  v_mfma_f32_32x32x16_bf16 v[128:143], v[32:35], v[68:71], v[128:143]
  ds_read_b64_tr_b16 v[84:85], v27 offset:24832
  ds_read_b64_tr_b16 v[86:87], v29 offset:24832
  v_mfma_f32_32x32x16_bf16 v[144:159], v[36:39], v[68:71], v[144:159]
  ds_read_b128 v[56:59], v22 offset:49152
  ds_read_b64_tr_b16 v[88:89], v27 offset:28672
  v_mfma_f32_32x32x16_bf16 v[96:111], v[40:43], v[72:75], v[96:111]
  ds_read_b64_tr_b16 v[90:91], v29 offset:28672
  ds_read_b128 v[60:63], v22 offset:53248
  v_mfma_f32_32x32x16_bf16 v[112:127], v[44:47], v[72:75], v[112:127]
  ds_read_b64_tr_b16 v[92:93], v27 offset:28928
  ds_read_b64_tr_b16 v[94:95], v29 offset:28928
  v_mfma_f32_32x32x16_bf16 v[128:143], v[40:43], v[76:79], v[128:143]
  v_mfma_f32_32x32x16_bf16 v[144:159], v[44:47], v[76:79], v[144:159]
  s_waitcnt lgkmcnt(0)
  s_barrier
  v_mfma_f32_32x32x16_bf16 v[96:111], v[48:51], v[80:83], v[96:111]
  ds_read_b128 v[32:35], v17 offset:0
  ds_read_b64_tr_b16 v[64:65], v26 offset:32768
  v_mfma_f32_32x32x16_bf16 v[112:127], v[52:55], v[80:83], v[112:127]
  ds_read_b64_tr_b16 v[66:67], v28 offset:32768
  ds_read_b128 v[36:39], v17 offset:4096
  v_mfma_f32_32x32x16_bf16 v[128:143], v[48:51], v[84:87], v[128:143]
  ds_read_b64_tr_b16 v[68:69], v26 offset:33024
  ds_read_b64_tr_b16 v[70:71], v28 offset:33024
  v_mfma_f32_32x32x16_bf16 v[144:159], v[52:55], v[84:87], v[144:159]
  ds_read_b128 v[40:43], v19 offset:0
  ds_read_b64_tr_b16 v[72:73], v26 offset:36864
  v_mfma_f32_32x32x16_bf16 v[96:111], v[56:59], v[88:91], v[96:111]
  ds_read_b64_tr_b16 v[74:75], v28 offset:36864
  ds_read_b128 v[44:47], v19 offset:4096
  v_mfma_f32_32x32x16_bf16 v[112:127], v[60:63], v[88:91], v[112:127]
  ds_read_b64_tr_b16 v[76:77], v26 offset:37120
  ds_read_b64_tr_b16 v[78:79], v28 offset:37120
  v_mfma_f32_32x32x16_bf16 v[128:143], v[56:59], v[92:95], v[128:143]
  v_mfma_f32_32x32x16_bf16 v[144:159], v[60:63], v[92:95], v[144:159]
  s_waitcnt lgkmcnt(0)
  v_mfma_f32_32x32x16_bf16 v[96:111], v[32:35], v[64:67], v[96:111]
  ds_read_b128 v[48:51], v21 offset:0
  ds_read_b64_tr_b16 v[80:81], v26 offset:40960
  v_mfma_f32_32x32x16_bf16 v[112:127], v[36:39], v[64:67], v[112:127]
  ds_read_b64_tr_b16 v[82:83], v28 offset:40960
  ds_read_b128 v[52:55], v21 offset:4096
  v_mfma_f32_32x32x16_bf16 v[128:143], v[32:35], v[68:71], v[128:143]
  ds_read_b64_tr_b16 v[84:85], v26 offset:41216
  ds_read_b64_tr_b16 v[86:87], v28 offset:41216
  v_mfma_f32_32x32x16_bf16 v[144:159], v[36:39], v[68:71], v[144:159]
  ds_read_b128 v[56:59], v23 offset:0
  ds_read_b64_tr_b16 v[88:89], v26 offset:45056
  v_mfma_f32_32x32x16_bf16 v[96:111], v[40:43], v[72:75], v[96:111]
  ds_read_b64_tr_b16 v[90:91], v28 offset:45056
  ds_read_b128 v[60:63], v23 offset:4096
  v_mfma_f32_32x32x16_bf16 v[112:127], v[44:47], v[72:75], v[112:127]
  ds_read_b64_tr_b16 v[92:93], v26 offset:45312
  ds_read_b64_tr_b16 v[94:95], v28 offset:45312
  v_mfma_f32_32x32x16_bf16 v[128:143], v[40:43], v[76:79], v[128:143]
  v_mfma_f32_32x32x16_bf16 v[144:159], v[44:47], v[76:79], v[144:159]
  s_waitcnt lgkmcnt(0)
  s_barrier
  v_mfma_f32_32x32x16_bf16 v[96:111], v[48:51], v[80:83], v[96:111]
  ds_read_b128 v[32:35], v17 offset:16384
  ds_read_b64_tr_b16 v[64:65], v26 offset:49152
  v_mfma_f32_32x32x16_bf16 v[112:127], v[52:55], v[80:83], v[112:127]
  ds_read_b64_tr_b16 v[66:67], v28 offset:49152
  ds_read_b128 v[36:39], v17 offset:20480
  v_mfma_f32_32x32x16_bf16 v[128:143], v[48:51], v[84:87], v[128:143]
  ds_read_b64_tr_b16 v[68:69], v26 offset:49408
  ds_read_b64_tr_b16 v[70:71], v28 offset:49408
  v_mfma_f32_32x32x16_bf16 v[144:159], v[52:55], v[84:87], v[144:159]
  ds_read_b128 v[40:43], v19 offset:16384
  ds_read_b64_tr_b16 v[72:73], v26 offset:53248
  v_mfma_f32_32x32x16_bf16 v[96:111], v[56:59], v[88:91], v[96:111]
  ds_read_b64_tr_b16 v[74:75], v28 offset:53248
  ds_read_b128 v[44:47], v19 offset:20480
  v_mfma_f32_32x32x16_bf16 v[112:127], v[60:63], v[88:91], v[112:127]
  ds_read_b64_tr_b16 v[76:77], v26 offset:53504
  ds_read_b64_tr_b16 v[78:79], v28 offset:53504
  v_mfma_f32_32x32x16_bf16 v[128:143], v[56:59], v[92:95], v[128:143]
  v_mfma_f32_32x32x16_bf16 v[144:159], v[60:63], v[92:95], v[144:159]
  s_waitcnt lgkmcnt(0)
  v_mfma_f32_32x32x16_bf16 v[96:111], v[32:35], v[64:67], v[96:111]
  ds_read_b128 v[48:51], v21 offset:16384
  ds_read_b64_tr_b16 v[80:81], v26 offset:57344
  v_mfma_f32_32x32x16_bf16 v[112:127], v[36:39], v[64:67], v[112:127]
  ds_read_b64_tr_b16 v[82:83], v28 offset:57344
  ds_read_b128 v[52:55], v21 offset:20480
  v_mfma_f32_32x32x16_bf16 v[128:143], v[32:35], v[68:71], v[128:143]
  ds_read_b64_tr_b16 v[84:85], v26 offset:57600
  ds_read_b64_tr_b16 v[86:87], v28 offset:57600
  v_mfma_f32_32x32x16_bf16 v[144:159], v[36:39], v[68:71], v[144:159]
  ds_read_b128 v[56:59], v23 offset:16384
  ds_read_b64_tr_b16 v[88:89], v26 offset:61440
  v_mfma_f32_32x32x16_bf16 v[96:111], v[40:43], v[72:75], v[96:111]
  ds_read_b64_tr_b16 v[90:91], v28 offset:61440
  ds_read_b128 v[60:63], v23 offset:20480
  v_mfma_f32_32x32x16_bf16 v[112:127], v[44:47], v[72:75], v[112:127]
  ds_read_b64_tr_b16 v[92:93], v26 offset:61696
  ds_read_b64_tr_b16 v[94:95], v28 offset:61696
  v_mfma_f32_32x32x16_bf16 v[128:143], v[40:43], v[76:79], v[128:143]
  v_mfma_f32_32x32x16_bf16 v[144:159], v[44:47], v[76:79], v[144:159]
  s_waitcnt lgkmcnt(0)
  s_barrier
  v_mfma_f32_32x32x16_bf16 v[96:111], v[48:51], v[80:83], v[96:111]
  ds_read_b128 v[32:35], v16 offset:0
  ds_read_b64_tr_b16 v[64:65], v27 offset:0
  v_mfma_f32_32x32x16_bf16 v[112:127], v[52:55], v[80:83], v[112:127]
  ds_read_b64_tr_b16 v[66:67], v29 offset:0
  ds_read_b128 v[36:39], v16 offset:4096
  v_mfma_f32_32x32x16_bf16 v[128:143], v[48:51], v[84:87], v[128:143]
  ds_read_b64_tr_b16 v[68:69], v27 offset:256
  ds_read_b64_tr_b16 v[70:71], v29 offset:256
  v_mfma_f32_32x32x16_bf16 v[144:159], v[52:55], v[84:87], v[144:159]
  ds_read_b128 v[40:43], v18 offset:0
  ds_read_b64_tr_b16 v[72:73], v27 offset:4096
  v_mfma_f32_32x32x16_bf16 v[96:111], v[56:59], v[88:91], v[96:111]
  ds_read_b64_tr_b16 v[74:75], v29 offset:4096
  ds_read_b128 v[44:47], v18 offset:4096
  v_mfma_f32_32x32x16_bf16 v[112:127], v[60:63], v[88:91], v[112:127]
  ds_read_b64_tr_b16 v[76:77], v27 offset:4352
  ds_read_b64_tr_b16 v[78:79], v29 offset:4352
  v_mfma_f32_32x32x16_bf16 v[128:143], v[56:59], v[92:95], v[128:143]
  v_mfma_f32_32x32x16_bf16 v[144:159], v[60:63], v[92:95], v[144:159]
  s_waitcnt lgkmcnt(0)
  v_mfma_f32_32x32x16_bf16 v[96:111], v[32:35], v[64:67], v[96:111]
  ds_read_b128 v[48:51], v20 offset:0
  ds_read_b64_tr_b16 v[80:81], v27 offset:8192
  v_mfma_f32_32x32x16_bf16 v[112:127], v[36:39], v[64:67], v[112:127]
  ds_read_b64_tr_b16 v[82:83], v29 offset:8192
  ds_read_b128 v[52:55], v20 offset:4096
  v_mfma_f32_32x32x16_bf16 v[128:143], v[32:35], v[68:71], v[128:143]
  ds_read_b64_tr_b16 v[84:85], v27 offset:8448
  ds_read_b64_tr_b16 v[86:87], v29 offset:8448
  v_mfma_f32_32x32x16_bf16 v[144:159], v[36:39], v[68:71], v[144:159]
  ds_read_b128 v[56:59], v22 offset:0
  ds_read_b64_tr_b16 v[88:89], v27 offset:12288
  v_mfma_f32_32x32x16_bf16 v[96:111], v[40:43], v[72:75], v[96:111]
  ds_read_b64_tr_b16 v[90:91], v29 offset:12288
  ds_read_b128 v[60:63], v22 offset:4096
  v_mfma_f32_32x32x16_bf16 v[112:127], v[44:47], v[72:75], v[112:127]
  ds_read_b64_tr_b16 v[92:93], v27 offset:12544
  ds_read_b64_tr_b16 v[94:95], v29 offset:12544
  v_mfma_f32_32x32x16_bf16 v[128:143], v[40:43], v[76:79], v[128:143]
  v_mfma_f32_32x32x16_bf16 v[144:159], v[44:47], v[76:79], v[144:159]
  s_waitcnt lgkmcnt(0)
  s_barrier
  v_mfma_f32_32x32x16_bf16 v[96:111], v[48:51], v[80:83], v[96:111]
  ds_read_b128 v[32:35], v16 offset:16384
  ds_read_b64_tr_b16 v[64:65], v27 offset:16384
  v_mfma_f32_32x32x16_bf16 v[112:127], v[52:55], v[80:83], v[112:127]
  ds_read_b64_tr_b16 v[66:67], v29 offset:16384
  ds_read_b128 v[36:39], v16 offset:20480
  v_mfma_f32_32x32x16_bf16 v[128:143], v[48:51], v[84:87], v[128:143]
  ds_read_b64_tr_b16 v[68:69], v27 offset:16640
  ds_read_b64_tr_b16 v[70:71], v29 offset:16640
  v_mfma_f32_32x32x16_bf16 v[144:159], v[52:55], v[84:87], v[144:159]
  ds_read_b128 v[40:43], v18 offset:16384
  ds_read_b64_tr_b16 v[72:73], v27 offset:20480
  v_mfma_f32_32x32x16_bf16 v[96:111], v[56:59], v[88:91], v[96:111]
  ds_read_b64_tr_b16 v[74:75], v29 offset:20480
  ds_read_b128 v[44:47], v18 offset:20480
  v_mfma_f32_32x32x16_bf16 v[112:127], v[60:63], v[88:91], v[112:127]
  ds_read_b64_tr_b16 v[76:77], v27 offset:20736
  ds_read_b64_tr_b16 v[78:79], v29 offset:20736
  v_mfma_f32_32x32x16_bf16 v[128:143], v[56:59], v[92:95], v[128:143]
  v_mfma_f32_32x32x16_bf16 v[144:159], v[60:63], v[92:95], v[144:159]
  s_waitcnt lgkmcnt(0)
  s_lshr_b32 s44, s43, 16
  s_and_b32 s45, s44, 3
  s_add_u32 s45, s45, 60
  s_lshl_b32 s45, s45, 7
  s_lshl_b32 s46, s4, 13
  s_add_u32 s45, s45, s46
  s_add_u32 s45, s45, 0x11c0000
  v_mov_b32 v220, s45
  s_lshl_b32 s44, s44, 15
  s_and_b32 s45, s43, 0x780
  s_lshl4_add_u32 s44, s45, s44
  s_add_u32 s45, s44, 0xf00000
  s_add_u32 s44, s44, 0xd00000
  s_mov_b32 s46, 0x1100000
  s_mov_b64 exec, 1
  buffer_load_dwordx2 v[222:223], v220, s[60:63], 0 offen sc1
  s_mov_b64 exec, -1
  v_mfma_f32_32x32x16_bf16 v[96:111], v[32:35], v[64:67], v[96:111]
  ds_read_b128 v[48:51], v20 offset:16384
  ds_read_b64_tr_b16 v[80:81], v27 offset:24576
  v_mfma_f32_32x32x16_bf16 v[112:127], v[36:39], v[64:67], v[112:127]
  ds_read_b64_tr_b16 v[82:83], v29 offset:24576
  ds_read_b128 v[52:55], v20 offset:20480
  v_mfma_f32_32x32x16_bf16 v[128:143], v[32:35], v[68:71], v[128:143]
  ds_read_b64_tr_b16 v[84:85], v27 offset:24832
  ds_read_b64_tr_b16 v[86:87], v29 offset:24832
  v_mfma_f32_32x32x16_bf16 v[144:159], v[36:39], v[68:71], v[144:159]
  ds_read_b128 v[56:59], v22 offset:16384
  ds_read_b64_tr_b16 v[88:89], v27 offset:28672
  v_mfma_f32_32x32x16_bf16 v[96:111], v[40:43], v[72:75], v[96:111]
  ds_read_b64_tr_b16 v[90:91], v29 offset:28672
  ds_read_b128 v[60:63], v22 offset:20480
  v_mfma_f32_32x32x16_bf16 v[112:127], v[44:47], v[72:75], v[112:127]
  ds_read_b64_tr_b16 v[92:93], v27 offset:28928
  ds_read_b64_tr_b16 v[94:95], v29 offset:28928
  v_mfma_f32_32x32x16_bf16 v[128:143], v[40:43], v[76:79], v[128:143]
  v_mfma_f32_32x32x16_bf16 v[144:159], v[44:47], v[76:79], v[144:159]
  s_waitcnt lgkmcnt(0)
  s_barrier
  v_mfma_f32_32x32x16_bf16 v[96:111], v[48:51], v[80:83], v[96:111]
  ds_read_b128 v[32:35], v16 offset:32768
  ds_read_b64_tr_b16 v[64:65], v26 offset:32768
  v_mfma_f32_32x32x16_bf16 v[112:127], v[52:55], v[80:83], v[112:127]
  ds_read_b64_tr_b16 v[66:67], v28 offset:32768
  ds_read_b128 v[36:39], v16 offset:36864
  v_mfma_f32_32x32x16_bf16 v[128:143], v[48:51], v[84:87], v[128:143]
  ds_read_b64_tr_b16 v[68:69], v26 offset:33024
  ds_read_b64_tr_b16 v[70:71], v28 offset:33024
  v_mfma_f32_32x32x16_bf16 v[144:159], v[52:55], v[84:87], v[144:159]
  ds_read_b128 v[40:43], v18 offset:32768
  ds_read_b64_tr_b16 v[72:73], v26 offset:36864
  v_mfma_f32_32x32x16_bf16 v[96:111], v[56:59], v[88:91], v[96:111]
  ds_read_b64_tr_b16 v[74:75], v28 offset:36864
  ds_read_b128 v[44:47], v18 offset:36864
  v_mfma_f32_32x32x16_bf16 v[112:127], v[60:63], v[88:91], v[112:127]
  ds_read_b64_tr_b16 v[76:77], v26 offset:37120
  ds_read_b64_tr_b16 v[78:79], v28 offset:37120
  v_mfma_f32_32x32x16_bf16 v[128:143], v[56:59], v[92:95], v[128:143]
  v_mfma_f32_32x32x16_bf16 v[144:159], v[60:63], v[92:95], v[144:159]
  s_waitcnt lgkmcnt(0)
  v_mfma_f32_32x32x16_bf16 v[96:111], v[32:35], v[64:67], v[96:111]
  ds_read_b128 v[48:51], v20 offset:32768
  ds_read_b64_tr_b16 v[80:81], v26 offset:40960
  v_mfma_f32_32x32x16_bf16 v[112:127], v[36:39], v[64:67], v[112:127]
  ds_read_b64_tr_b16 v[82:83], v28 offset:40960
  ds_read_b128 v[52:55], v20 offset:36864
  v_mfma_f32_32x32x16_bf16 v[128:143], v[32:35], v[68:71], v[128:143]
  ds_read_b64_tr_b16 v[84:85], v26 offset:41216
  ds_read_b64_tr_b16 v[86:87], v28 offset:41216
  v_mfma_f32_32x32x16_bf16 v[144:159], v[36:39], v[68:71], v[144:159]
  ds_read_b128 v[56:59], v22 offset:32768
  ds_read_b64_tr_b16 v[88:89], v26 offset:45056
  v_mfma_f32_32x32x16_bf16 v[96:111], v[40:43], v[72:75], v[96:111]
  ds_read_b64_tr_b16 v[90:91], v28 offset:45056
  ds_read_b128 v[60:63], v22 offset:36864
  v_mfma_f32_32x32x16_bf16 v[112:127], v[44:47], v[72:75], v[112:127]
  ds_read_b64_tr_b16 v[92:93], v26 offset:45312
  ds_read_b64_tr_b16 v[94:95], v28 offset:45312
  v_mfma_f32_32x32x16_bf16 v[128:143], v[40:43], v[76:79], v[128:143]
  v_mfma_f32_32x32x16_bf16 v[144:159], v[44:47], v[76:79], v[144:159]
  s_waitcnt lgkmcnt(0)
  s_barrier
  v_mfma_f32_32x32x16_bf16 v[96:111], v[48:51], v[80:83], v[96:111]
  ds_read_b128 v[32:35], v16 offset:49152
  ds_read_b64_tr_b16 v[64:65], v26 offset:49152
  v_mfma_f32_32x32x16_bf16 v[112:127], v[52:55], v[80:83], v[112:127]
  ds_read_b64_tr_b16 v[66:67], v28 offset:49152
  ds_read_b128 v[36:39], v16 offset:53248
  v_mfma_f32_32x32x16_bf16 v[128:143], v[48:51], v[84:87], v[128:143]
  ds_read_b64_tr_b16 v[68:69], v26 offset:49408
  ds_read_b64_tr_b16 v[70:71], v28 offset:49408
  v_mfma_f32_32x32x16_bf16 v[144:159], v[52:55], v[84:87], v[144:159]
  ds_read_b128 v[40:43], v18 offset:49152
  ds_read_b64_tr_b16 v[72:73], v26 offset:53248
  v_mfma_f32_32x32x16_bf16 v[96:111], v[56:59], v[88:91], v[96:111]
  ds_read_b64_tr_b16 v[74:75], v28 offset:53248
  ds_read_b128 v[44:47], v18 offset:53248
  v_mfma_f32_32x32x16_bf16 v[112:127], v[60:63], v[88:91], v[112:127]
  ds_read_b64_tr_b16 v[76:77], v26 offset:53504
  ds_read_b64_tr_b16 v[78:79], v28 offset:53504
  v_mfma_f32_32x32x16_bf16 v[128:143], v[56:59], v[92:95], v[128:143]
  v_mfma_f32_32x32x16_bf16 v[144:159], v[60:63], v[92:95], v[144:159]
  s_waitcnt lgkmcnt(0)
  s_mov_b32 s85, 0x40000
  s_mov_b64 exec, 1
  s_branch fchk_56
fpoll_54:
  buffer_load_dwordx2 v[222:223], v220, s[60:63], 0 offen sc1
fchk_56:
  s_waitcnt vmcnt(0)
  v_cmp_ne_u64 vcc, s[76:77], v[222:223]
  s_and_b64 exec, exec, vcc
  s_cbranch_execz fdone_55
  s_sub_u32 s85, s85, 1
  s_cbranch_scc1 fdone_55
  s_sleep 2
  s_branch fpoll_54
fdone_55:
  s_mov_b64 exec, -1
  v_lshrrev_b32 v220, 11, v15
  v_lshlrev_b32 v220, 3, v220
  v_lshlrev_b32 v221, 4, v1
  buffer_load_dwordx2 v[240:241], v220, s[60:63], s46 offen sc1
  buffer_load_dwordx4 v[242:245], v221, s[60:63], s45 offen offset:0 sc1
  buffer_load_dwordx4 v[246:249], v221, s[60:63], s45 offen offset:1024 sc1
  v_mfma_f32_32x32x16_bf16 v[96:111], v[32:35], v[64:67], v[96:111]
  ds_read_b128 v[48:51], v20 offset:49152
  ds_read_b64_tr_b16 v[80:81], v26 offset:57344
  v_mfma_f32_32x32x16_bf16 v[112:127], v[36:39], v[64:67], v[112:127]
  ds_read_b64_tr_b16 v[82:83], v28 offset:57344
  ds_read_b128 v[52:55], v20 offset:53248
  v_mfma_f32_32x32x16_bf16 v[128:143], v[32:35], v[68:71], v[128:143]
  ds_read_b64_tr_b16 v[84:85], v26 offset:57600
  ds_read_b64_tr_b16 v[86:87], v28 offset:57600
  v_mfma_f32_32x32x16_bf16 v[144:159], v[36:39], v[68:71], v[144:159]
  ds_read_b128 v[56:59], v22 offset:49152
  ds_read_b64_tr_b16 v[88:89], v26 offset:61440
  v_mfma_f32_32x32x16_bf16 v[96:111], v[40:43], v[72:75], v[96:111]
  ds_read_b64_tr_b16 v[90:91], v28 offset:61440
  ds_read_b128 v[60:63], v22 offset:53248
  v_mfma_f32_32x32x16_bf16 v[112:127], v[44:47], v[72:75], v[112:127]
  ds_read_b64_tr_b16 v[92:93], v26 offset:61696
  ds_read_b64_tr_b16 v[94:95], v28 offset:61696
  v_mfma_f32_32x32x16_bf16 v[128:143], v[40:43], v[76:79], v[128:143]
  v_mfma_f32_32x32x16_bf16 v[144:159], v[44:47], v[76:79], v[144:159]
  s_waitcnt lgkmcnt(0)
  s_barrier
  v_mfma_f32_32x32x16_bf16 v[96:111], v[48:51], v[80:83], v[96:111]
  ds_read_b128 v[32:35], v17 offset:0
  ds_read_b64_tr_b16 v[64:65], v27 offset:0
  v_mfma_f32_32x32x16_bf16 v[112:127], v[52:55], v[80:83], v[112:127]
  ds_read_b64_tr_b16 v[66:67], v29 offset:0
  ds_read_b128 v[36:39], v17 offset:4096
  v_mfma_f32_32x32x16_bf16 v[128:143], v[48:51], v[84:87], v[128:143]
  ds_read_b64_tr_b16 v[68:69], v27 offset:256
  ds_read_b64_tr_b16 v[70:71], v29 offset:256
  v_mfma_f32_32x32x16_bf16 v[144:159], v[52:55], v[84:87], v[144:159]
  ds_read_b128 v[40:43], v19 offset:0
  ds_read_b64_tr_b16 v[72:73], v27 offset:4096
  v_mfma_f32_32x32x16_bf16 v[96:111], v[56:59], v[88:91], v[96:111]
  ds_read_b64_tr_b16 v[74:75], v29 offset:4096
  ds_read_b128 v[44:47], v19 offset:4096
  v_mfma_f32_32x32x16_bf16 v[112:127], v[60:63], v[88:91], v[112:127]
  ds_read_b64_tr_b16 v[76:77], v27 offset:4352
  ds_read_b64_tr_b16 v[78:79], v29 offset:4352
  v_mfma_f32_32x32x16_bf16 v[128:143], v[56:59], v[92:95], v[128:143]
  v_mfma_f32_32x32x16_bf16 v[144:159], v[60:63], v[92:95], v[144:159]
  s_waitcnt lgkmcnt(0)
  v_mfma_f32_32x32x16_bf16 v[96:111], v[32:35], v[64:67], v[96:111]
  ds_read_b128 v[48:51], v21 offset:0
  ds_read_b64_tr_b16 v[80:81], v27 offset:8192
  v_mfma_f32_32x32x16_bf16 v[112:127], v[36:39], v[64:67], v[112:127]
  ds_read_b64_tr_b16 v[82:83], v29 offset:8192
  ds_read_b128 v[52:55], v21 offset:4096
  v_mfma_f32_32x32x16_bf16 v[128:143], v[32:35], v[68:71], v[128:143]
  ds_read_b64_tr_b16 v[84:85], v27 offset:8448
  ds_read_b64_tr_b16 v[86:87], v29 offset:8448
  v_mfma_f32_32x32x16_bf16 v[144:159], v[36:39], v[68:71], v[144:159]
  ds_read_b128 v[56:59], v23 offset:0
  ds_read_b64_tr_b16 v[88:89], v27 offset:12288
  v_mfma_f32_32x32x16_bf16 v[96:111], v[40:43], v[72:75], v[96:111]
  ds_read_b64_tr_b16 v[90:91], v29 offset:12288
  ds_read_b128 v[60:63], v23 offset:4096
  v_mfma_f32_32x32x16_bf16 v[112:127], v[44:47], v[72:75], v[112:127]
  ds_read_b64_tr_b16 v[92:93], v27 offset:12544
  ds_read_b64_tr_b16 v[94:95], v29 offset:12544
  v_mfma_f32_32x32x16_bf16 v[128:143], v[40:43], v[76:79], v[128:143]
  v_mfma_f32_32x32x16_bf16 v[144:159], v[44:47], v[76:79], v[144:159]
  s_waitcnt lgkmcnt(0)
  s_barrier
  v_mfma_f32_32x32x16_bf16 v[96:111], v[48:51], v[80:83], v[96:111]
  ds_read_b128 v[32:35], v17 offset:16384
  ds_read_b64_tr_b16 v[64:65], v27 offset:16384
  v_mfma_f32_32x32x16_bf16 v[112:127], v[52:55], v[80:83], v[112:127]
  ds_read_b64_tr_b16 v[66:67], v29 offset:16384
  ds_read_b128 v[36:39], v17 offset:20480
  v_mfma_f32_32x32x16_bf16 v[128:143], v[48:51], v[84:87], v[128:143]
  ds_read_b64_tr_b16 v[68:69], v27 offset:16640
  ds_read_b64_tr_b16 v[70:71], v29 offset:16640
  v_mfma_f32_32x32x16_bf16 v[144:159], v[52:55], v[84:87], v[144:159]
  ds_read_b128 v[40:43], v19 offset:16384
  ds_read_b64_tr_b16 v[72:73], v27 offset:20480
  v_mfma_f32_32x32x16_bf16 v[96:111], v[56:59], v[88:91], v[96:111]
  ds_read_b64_tr_b16 v[74:75], v29 offset:20480
  ds_read_b128 v[44:47], v19 offset:20480
  v_mfma_f32_32x32x16_bf16 v[112:127], v[60:63], v[88:91], v[112:127]
  ds_read_b64_tr_b16 v[76:77], v27 offset:20736
  ds_read_b64_tr_b16 v[78:79], v29 offset:20736
  v_mfma_f32_32x32x16_bf16 v[128:143], v[56:59], v[92:95], v[128:143]
  v_mfma_f32_32x32x16_bf16 v[144:159], v[60:63], v[92:95], v[144:159]
  s_waitcnt lgkmcnt(0)
  v_mfma_f32_32x32x16_bf16 v[96:111], v[32:35], v[64:67], v[96:111]
  ds_read_b128 v[48:51], v21 offset:16384
  ds_read_b64_tr_b16 v[80:81], v27 offset:24576
  v_mfma_f32_32x32x16_bf16 v[112:127], v[36:39], v[64:67], v[112:127]
  ds_read_b64_tr_b16 v[82:83], v29 offset:24576
  ds_read_b128 v[52:55], v21 offset:20480
  v_mfma_f32_32x32x16_bf16 v[128:143], v[32:35], v[68:71], v[128:143]
  ds_read_b64_tr_b16 v[84:85], v27 offset:24832
  ds_read_b64_tr_b16 v[86:87], v29 offset:24832
  v_mfma_f32_32x32x16_bf16 v[144:159], v[36:39], v[68:71], v[144:159]
  ds_read_b128 v[56:59], v23 offset:16384
  ds_read_b64_tr_b16 v[88:89], v27 offset:28672
  v_mfma_f32_32x32x16_bf16 v[96:111], v[40:43], v[72:75], v[96:111]
  ds_read_b64_tr_b16 v[90:91], v29 offset:28672
  ds_read_b128 v[60:63], v23 offset:20480
  v_mfma_f32_32x32x16_bf16 v[112:127], v[44:47], v[72:75], v[112:127]
  ds_read_b64_tr_b16 v[92:93], v27 offset:28928
  ds_read_b64_tr_b16 v[94:95], v29 offset:28928
  v_mfma_f32_32x32x16_bf16 v[128:143], v[40:43], v[76:79], v[128:143]
  v_mfma_f32_32x32x16_bf16 v[144:159], v[44:47], v[76:79], v[144:159]
  s_waitcnt lgkmcnt(0)
  s_barrier
  v_mfma_f32_32x32x16_bf16 v[96:111], v[48:51], v[80:83], v[96:111]
  ds_read_b128 v[32:35], v16 offset:0
  ds_read_b64_tr_b16 v[64:65], v26 offset:32768
  v_mfma_f32_32x32x16_bf16 v[112:127], v[52:55], v[80:83], v[112:127]
  ds_read_b64_tr_b16 v[66:67], v28 offset:32768
  ds_read_b128 v[36:39], v16 offset:4096
  v_mfma_f32_32x32x16_bf16 v[128:143], v[48:51], v[84:87], v[128:143]
  ds_read_b64_tr_b16 v[68:69], v26 offset:33024
  ds_read_b64_tr_b16 v[70:71], v28 offset:33024
  v_mfma_f32_32x32x16_bf16 v[144:159], v[52:55], v[84:87], v[144:159]
  ds_read_b128 v[40:43], v18 offset:0
  ds_read_b64_tr_b16 v[72:73], v26 offset:36864
  v_mfma_f32_32x32x16_bf16 v[96:111], v[56:59], v[88:91], v[96:111]
  ds_read_b64_tr_b16 v[74:75], v28 offset:36864
  ds_read_b128 v[44:47], v18 offset:4096
  v_mfma_f32_32x32x16_bf16 v[112:127], v[60:63], v[88:91], v[112:127]
  ds_read_b64_tr_b16 v[76:77], v26 offset:37120
  ds_read_b64_tr_b16 v[78:79], v28 offset:37120
  v_mfma_f32_32x32x16_bf16 v[128:143], v[56:59], v[92:95], v[128:143]
  v_mfma_f32_32x32x16_bf16 v[144:159], v[60:63], v[92:95], v[144:159]
  s_waitcnt lgkmcnt(0)
  v_mfma_f32_32x32x16_bf16 v[96:111], v[32:35], v[64:67], v[96:111]
  ds_read_b128 v[48:51], v20 offset:0
  ds_read_b64_tr_b16 v[80:81], v26 offset:40960
  s_waitcnt vmcnt(0)
  v_lshlrev_b32 v224, 16, v242
  v_mfma_f32_32x32x16_bf16 v[112:127], v[36:39], v[64:67], v[112:127]
  ds_read_b64_tr_b16 v[82:83], v28 offset:40960
  ds_read_b128 v[52:55], v20 offset:4096
  v_and_b32 v225, 0xffff0000, v242
  v_lshlrev_b32 v226, 16, v243
  v_mfma_f32_32x32x16_bf16 v[128:143], v[32:35], v[68:71], v[128:143]
  ds_read_b64_tr_b16 v[84:85], v26 offset:41216
  ds_read_b64_tr_b16 v[86:87], v28 offset:41216
  v_and_b32 v227, 0xffff0000, v243
  v_lshlrev_b32 v228, 16, v244
  v_mfma_f32_32x32x16_bf16 v[144:159], v[36:39], v[68:71], v[144:159]
  ds_read_b128 v[56:59], v22 offset:0
  ds_read_b64_tr_b16 v[88:89], v26 offset:45056
  v_and_b32 v229, 0xffff0000, v244
  v_lshlrev_b32 v230, 16, v245
  v_mfma_f32_32x32x16_bf16 v[96:111], v[40:43], v[72:75], v[96:111]
  ds_read_b64_tr_b16 v[90:91], v28 offset:45056
  ds_read_b128 v[60:63], v22 offset:4096
  v_and_b32 v231, 0xffff0000, v245
  v_mfma_f32_32x32x16_bf16 v[112:127], v[44:47], v[72:75], v[112:127]
  ds_read_b64_tr_b16 v[92:93], v26 offset:45312
  ds_read_b64_tr_b16 v[94:95], v28 offset:45312
  v_mfma_f32_32x32x16_bf16 v[128:143], v[40:43], v[76:79], v[128:143]
  v_mfma_f32_32x32x16_bf16 v[144:159], v[44:47], v[76:79], v[144:159]
  s_waitcnt lgkmcnt(0)
  s_barrier
  v_mfma_f32_32x32x16_bf16 v[96:111], v[48:51], v[80:83], v[96:111]
  ds_read_b128 v[32:35], v16 offset:16384
  ds_read_b64_tr_b16 v[64:65], v26 offset:49152
  v_lshlrev_b32 v232, 16, v246
  v_and_b32 v233, 0xffff0000, v246
  v_mfma_f32_32x32x16_bf16 v[112:127], v[52:55], v[80:83], v[112:127]
  ds_read_b64_tr_b16 v[66:67], v28 offset:49152
  ds_read_b128 v[36:39], v16 offset:20480
  v_lshlrev_b32 v234, 16, v247
  v_and_b32 v235, 0xffff0000, v247
  v_mfma_f32_32x32x16_bf16 v[128:143], v[48:51], v[84:87], v[128:143]
  ds_read_b64_tr_b16 v[68:69], v26 offset:49408
  ds_read_b64_tr_b16 v[70:71], v28 offset:49408
  v_lshlrev_b32 v236, 16, v248
  v_and_b32 v237, 0xffff0000, v248
  v_mfma_f32_32x32x16_bf16 v[144:159], v[52:55], v[84:87], v[144:159]
  ds_read_b128 v[40:43], v18 offset:16384
  ds_read_b64_tr_b16 v[72:73], v26 offset:53248
  v_lshlrev_b32 v238, 16, v249
  v_and_b32 v239, 0xffff0000, v249
  v_mfma_f32_32x32x16_bf16 v[96:111], v[56:59], v[88:91], v[96:111]
  ds_read_b64_tr_b16 v[74:75], v28 offset:53248
  ds_read_b128 v[44:47], v18 offset:20480
  v_mfma_f32_32x32x16_bf16 v[112:127], v[60:63], v[88:91], v[112:127]
  ds_read_b64_tr_b16 v[76:77], v26 offset:53504
  ds_read_b64_tr_b16 v[78:79], v28 offset:53504
  v_mfma_f32_32x32x16_bf16 v[128:143], v[56:59], v[92:95], v[128:143]
  v_mfma_f32_32x32x16_bf16 v[144:159], v[60:63], v[92:95], v[144:159]
  s_waitcnt lgkmcnt(0)
  v_mfma_f32_32x32x16_bf16 v[96:111], v[32:35], v[64:67], v[96:111]
  ds_read_b128 v[48:51], v20 offset:16384
  ds_read_b64_tr_b16 v[80:81], v26 offset:57344
  v_pk_mul_f32 v[224:225], v[224:225], v[240:241] op_sel_hi:[1,0]
  v_pk_mul_f32 v[226:227], v[226:227], v[240:241] op_sel_hi:[1,0]
  v_mfma_f32_32x32x16_bf16 v[112:127], v[36:39], v[64:67], v[112:127]
  ds_read_b64_tr_b16 v[82:83], v28 offset:57344
  ds_read_b128 v[52:55], v20 offset:20480
  v_pk_mul_f32 v[228:229], v[228:229], v[240:241] op_sel_hi:[1,0]
  v_pk_mul_f32 v[230:231], v[230:231], v[240:241] op_sel_hi:[1,0]
  v_mfma_f32_32x32x16_bf16 v[128:143], v[32:35], v[68:71], v[128:143]
  ds_read_b64_tr_b16 v[84:85], v26 offset:57600
  ds_read_b64_tr_b16 v[86:87], v28 offset:57600
  v_pk_mul_f32 v[232:233], v[232:233], v[240:241] op_sel_hi:[1,0]
  v_pk_mul_f32 v[234:235], v[234:235], v[240:241] op_sel_hi:[1,0]
  v_mfma_f32_32x32x16_bf16 v[144:159], v[36:39], v[68:71], v[144:159]
  ds_read_b128 v[56:59], v22 offset:16384
  ds_read_b64_tr_b16 v[88:89], v26 offset:61440
  v_pk_mul_f32 v[236:237], v[236:237], v[240:241] op_sel_hi:[1,0]
  v_pk_mul_f32 v[238:239], v[238:239], v[240:241] op_sel_hi:[1,0]
  v_mfma_f32_32x32x16_bf16 v[96:111], v[40:43], v[72:75], v[96:111]
  ds_read_b64_tr_b16 v[90:91], v28 offset:61440
  ds_read_b128 v[60:63], v22 offset:20480
  v_mfma_f32_32x32x16_bf16 v[112:127], v[44:47], v[72:75], v[112:127]
  ds_read_b64_tr_b16 v[92:93], v26 offset:61696
  ds_read_b64_tr_b16 v[94:95], v28 offset:61696
  v_mfma_f32_32x32x16_bf16 v[128:143], v[40:43], v[76:79], v[128:143]
  v_mfma_f32_32x32x16_bf16 v[144:159], v[44:47], v[76:79], v[144:159]
  s_waitcnt lgkmcnt(0)
  s_barrier
  v_mfma_f32_32x32x16_bf16 v[96:111], v[48:51], v[80:83], v[96:111]
  ds_read_b128 v[32:35], v16 offset:32768
  ds_read_b64_tr_b16 v[64:65], v27 offset:0
  v_mfma_f32_32x32x16_bf16 v[112:127], v[52:55], v[80:83], v[112:127]
  ds_read_b64_tr_b16 v[66:67], v29 offset:0
  ds_read_b128 v[36:39], v16 offset:36864
  v_mfma_f32_32x32x16_bf16 v[128:143], v[48:51], v[84:87], v[128:143]
  ds_read_b64_tr_b16 v[68:69], v27 offset:256
  ds_read_b64_tr_b16 v[70:71], v29 offset:256
  v_mfma_f32_32x32x16_bf16 v[144:159], v[52:55], v[84:87], v[144:159]
  ds_read_b128 v[40:43], v18 offset:32768
  ds_read_b64_tr_b16 v[72:73], v27 offset:4096
  v_mfma_f32_32x32x16_bf16 v[96:111], v[56:59], v[88:91], v[96:111]
  ds_read_b64_tr_b16 v[74:75], v29 offset:4096
  ds_read_b128 v[44:47], v18 offset:36864
  v_mfma_f32_32x32x16_bf16 v[112:127], v[60:63], v[88:91], v[112:127]
  ds_read_b64_tr_b16 v[76:77], v27 offset:4352
  ds_read_b64_tr_b16 v[78:79], v29 offset:4352
  v_mfma_f32_32x32x16_bf16 v[128:143], v[56:59], v[92:95], v[128:143]
  v_mfma_f32_32x32x16_bf16 v[144:159], v[60:63], v[92:95], v[144:159]
  s_waitcnt lgkmcnt(0)
  v_mfma_f32_32x32x16_bf16 v[96:111], v[32:35], v[64:67], v[96:111]
  ds_read_b128 v[48:51], v20 offset:32768
  ds_read_b64_tr_b16 v[80:81], v27 offset:8192
  v_mfma_f32_32x32x16_bf16 v[112:127], v[36:39], v[64:67], v[112:127]
  ds_read_b64_tr_b16 v[82:83], v29 offset:8192
  ds_read_b128 v[52:55], v20 offset:36864
  v_mfma_f32_32x32x16_bf16 v[128:143], v[32:35], v[68:71], v[128:143]
  ds_read_b64_tr_b16 v[84:85], v27 offset:8448
  ds_read_b64_tr_b16 v[86:87], v29 offset:8448
  v_mfma_f32_32x32x16_bf16 v[144:159], v[36:39], v[68:71], v[144:159]
  ds_read_b128 v[56:59], v22 offset:32768
  ds_read_b64_tr_b16 v[88:89], v27 offset:12288
  v_mfma_f32_32x32x16_bf16 v[96:111], v[40:43], v[72:75], v[96:111]
  ds_read_b64_tr_b16 v[90:91], v29 offset:12288
  ds_read_b128 v[60:63], v22 offset:36864
  v_mfma_f32_32x32x16_bf16 v[112:127], v[44:47], v[72:75], v[112:127]
  ds_read_b64_tr_b16 v[92:93], v27 offset:12544
  ds_read_b64_tr_b16 v[94:95], v29 offset:12544
  v_mfma_f32_32x32x16_bf16 v[128:143], v[40:43], v[76:79], v[128:143]
  v_mfma_f32_32x32x16_bf16 v[144:159], v[44:47], v[76:79], v[144:159]
  s_waitcnt lgkmcnt(0)
  s_barrier
  v_mfma_f32_32x32x16_bf16 v[96:111], v[48:51], v[80:83], v[96:111]
  ds_read_b128 v[32:35], v16 offset:49152
  ds_read_b64_tr_b16 v[64:65], v27 offset:16384
  v_mfma_f32_32x32x16_bf16 v[112:127], v[52:55], v[80:83], v[112:127]
  ds_read_b64_tr_b16 v[66:67], v29 offset:16384
  ds_read_b128 v[36:39], v16 offset:53248
  v_mfma_f32_32x32x16_bf16 v[128:143], v[48:51], v[84:87], v[128:143]
  ds_read_b64_tr_b16 v[68:69], v27 offset:16640
  ds_read_b64_tr_b16 v[70:71], v29 offset:16640
  v_mfma_f32_32x32x16_bf16 v[144:159], v[52:55], v[84:87], v[144:159]
  ds_read_b128 v[40:43], v18 offset:49152
  ds_read_b64_tr_b16 v[72:73], v27 offset:20480
  v_mfma_f32_32x32x16_bf16 v[96:111], v[56:59], v[88:91], v[96:111]
  ds_read_b64_tr_b16 v[74:75], v29 offset:20480
  ds_read_b128 v[44:47], v18 offset:53248
  v_mfma_f32_32x32x16_bf16 v[112:127], v[60:63], v[88:91], v[112:127]
  ds_read_b64_tr_b16 v[76:77], v27 offset:20736
  ds_read_b64_tr_b16 v[78:79], v29 offset:20736
  v_mfma_f32_32x32x16_bf16 v[128:143], v[56:59], v[92:95], v[128:143]
  v_mfma_f32_32x32x16_bf16 v[144:159], v[60:63], v[92:95], v[144:159]
  s_waitcnt lgkmcnt(0)
  v_mfma_f32_32x32x16_bf16 v[96:111], v[32:35], v[64:67], v[96:111]
  ds_read_b128 v[48:51], v20 offset:49152
  ds_read_b64_tr_b16 v[80:81], v27 offset:24576
  v_mfma_f32_32x32x16_bf16 v[112:127], v[36:39], v[64:67], v[112:127]
  ds_read_b64_tr_b16 v[82:83], v29 offset:24576
  ds_read_b128 v[52:55], v20 offset:53248
  v_mfma_f32_32x32x16_bf16 v[128:143], v[32:35], v[68:71], v[128:143]
  ds_read_b64_tr_b16 v[84:85], v27 offset:24832
  ds_read_b64_tr_b16 v[86:87], v29 offset:24832
  v_mfma_f32_32x32x16_bf16 v[144:159], v[36:39], v[68:71], v[144:159]
  ds_read_b128 v[56:59], v22 offset:49152
  ds_read_b64_tr_b16 v[88:89], v27 offset:28672
  v_mfma_f32_32x32x16_bf16 v[96:111], v[40:43], v[72:75], v[96:111]
  ds_read_b64_tr_b16 v[90:91], v29 offset:28672
  ds_read_b128 v[60:63], v22 offset:53248
  v_mfma_f32_32x32x16_bf16 v[112:127], v[44:47], v[72:75], v[112:127]
  ds_read_b64_tr_b16 v[92:93], v27 offset:28928
  ds_read_b64_tr_b16 v[94:95], v29 offset:28928
  v_mfma_f32_32x32x16_bf16 v[128:143], v[40:43], v[76:79], v[128:143]
  v_mfma_f32_32x32x16_bf16 v[144:159], v[44:47], v[76:79], v[144:159]
  s_waitcnt lgkmcnt(0)
  s_barrier
  v_mfma_f32_32x32x16_bf16 v[96:111], v[48:51], v[80:83], v[96:111]
  v_mfma_f32_32x32x16_bf16 v[112:127], v[52:55], v[80:83], v[112:127]
  v_mfma_f32_32x32x16_bf16 v[128:143], v[48:51], v[84:87], v[128:143]
  v_mfma_f32_32x32x16_bf16 v[144:159], v[52:55], v[84:87], v[144:159]
  v_mfma_f32_32x32x16_bf16 v[96:111], v[56:59], v[88:91], v[96:111]
  v_mfma_f32_32x32x16_bf16 v[112:127], v[60:63], v[88:91], v[112:127]
  v_mfma_f32_32x32x16_bf16 v[128:143], v[56:59], v[92:95], v[128:143]
  v_mfma_f32_32x32x16_bf16 v[144:159], v[60:63], v[92:95], v[144:159]
  s_nop 7
  s_nop 3
  v_cvt_pk_bf16_f32 v96, v96, v97
  v_cvt_pk_bf16_f32 v97, v98, v99
  v_cvt_pk_bf16_f32 v98, v100, v101
  v_cvt_pk_bf16_f32 v99, v102, v103
  buffer_store_dwordx4 v[96:99], v160, s[60:63], s16 offen offset:0 sc1
  v_cvt_pk_bf16_f32 v104, v104, v105
  v_cvt_pk_bf16_f32 v105, v106, v107
  v_cvt_pk_bf16_f32 v106, v108, v109
  v_cvt_pk_bf16_f32 v107, v110, v111
  buffer_store_dwordx4 v[104:107], v160, s[60:63], s16 offen offset:1024 sc1
  v_cvt_pk_bf16_f32 v112, v112, v113
  v_cvt_pk_bf16_f32 v113, v114, v115
  v_cvt_pk_bf16_f32 v114, v116, v117
  v_cvt_pk_bf16_f32 v115, v118, v119
  buffer_store_dwordx4 v[112:115], v160, s[60:63], s16 offen offset:2048 sc1
  v_cvt_pk_bf16_f32 v120, v120, v121
  v_cvt_pk_bf16_f32 v121, v122, v123
  v_cvt_pk_bf16_f32 v122, v124, v125
  v_cvt_pk_bf16_f32 v123, v126, v127
  buffer_store_dwordx4 v[120:123], v160, s[60:63], s16 offen offset:3072 sc1
  v_cvt_pk_bf16_f32 v128, v128, v129
  v_cvt_pk_bf16_f32 v129, v130, v131
  v_cvt_pk_bf16_f32 v130, v132, v133
  v_cvt_pk_bf16_f32 v131, v134, v135
  buffer_store_dwordx4 v[128:131], v160, s[60:63], s17 offen offset:0 sc1
  v_cvt_pk_bf16_f32 v136, v136, v137
  v_cvt_pk_bf16_f32 v137, v138, v139
  v_cvt_pk_bf16_f32 v138, v140, v141
  v_cvt_pk_bf16_f32 v139, v142, v143
  buffer_store_dwordx4 v[136:139], v160, s[60:63], s17 offen offset:1024 sc1
  v_cvt_pk_bf16_f32 v144, v144, v145
  v_cvt_pk_bf16_f32 v145, v146, v147
  v_cvt_pk_bf16_f32 v146, v148, v149
  v_cvt_pk_bf16_f32 v147, v150, v151
  buffer_store_dwordx4 v[144:147], v160, s[60:63], s17 offen offset:2048 sc1
  v_cvt_pk_bf16_f32 v152, v152, v153
  v_cvt_pk_bf16_f32 v153, v154, v155
  v_cvt_pk_bf16_f32 v154, v156, v157
  v_cvt_pk_bf16_f32 v155, v158, v159
  buffer_store_dwordx4 v[152:155], v160, s[60:63], s17 offen offset:3072 sc1
  v_mov_b32 v2, s76
  v_mov_b32 v3, s77
  v_lshlrev_b32 v4, 3, v1
  s_mov_b64 exec, 0xffff
  s_waitcnt vmcnt(0)
  buffer_store_dwordx2 v[2:3], v4, s[60:63], s83 offen sc1
  s_mov_b64 exec, -1
  s_branch L_p3cons
L_gate:
  s_lshl2_add_u32 s16, s4, s3
  s_lshl_b32 s16, s16, 5
  s_lshl_b32 s12, s16, 10
  v_lshlrev_b32 v2, 4, v1
  v_add_u32 v3, s12, v2
  global_load_dwordx4 v[80:83], v2, s[44:45]
  global_load_dwordx4 v[112:115], v2, s[32:33]
  s_mul_i32 s13, s3, 33280
  v_add_u32 v132, s13, v2
  v_mov_b32 v108, 0
  s_waitcnt vmcnt(0)
  v_lshlrev_b32 v84, 16, v80
  v_and_b32 v85, 0xffff0000, v80
  v_lshlrev_b32 v116, 16, v112
  v_and_b32 v117, 0xffff0000, v112
  v_lshlrev_b32 v86, 16, v81
  v_and_b32 v87, 0xffff0000, v81
  v_lshlrev_b32 v118, 16, v113
  v_and_b32 v119, 0xffff0000, v113
  v_lshlrev_b32 v88, 16, v82
  v_and_b32 v89, 0xffff0000, v82
  v_lshlrev_b32 v120, 16, v114
  v_and_b32 v121, 0xffff0000, v114
  v_lshlrev_b32 v90, 16, v83
  v_and_b32 v91, 0xffff0000, v83
  v_lshlrev_b32 v122, 16, v115
  v_and_b32 v123, 0xffff0000, v115
  v_mov_b32 v6, v1
  s_mov_b32 s17, 0
L_gateround:
  s_add_u32 s13, s17, 0
  buffer_load_dwordx4 v[16:19], v3, s[52:55], s13 offen offset:0
  buffer_load_dwordx4 v[20:23], v3, s[52:55], s13 offen offset:1024
  buffer_load_dwordx4 v[24:27], v3, s[52:55], s13 offen offset:2048
  buffer_load_dwordx4 v[28:31], v3, s[52:55], s13 offen offset:3072
  s_add_u32 s13, s17, 4096
  buffer_load_dwordx4 v[32:35], v3, s[52:55], s13 offen offset:0
  buffer_load_dwordx4 v[36:39], v3, s[52:55], s13 offen offset:1024
  buffer_load_dwordx4 v[40:43], v3, s[52:55], s13 offen offset:2048
  buffer_load_dwordx4 v[44:47], v3, s[52:55], s13 offen offset:3072
  s_add_u32 s13, s17, 8192
  buffer_load_dwordx4 v[48:51], v3, s[52:55], s13 offen offset:0
  buffer_load_dwordx4 v[52:55], v3, s[52:55], s13 offen offset:1024
  buffer_load_dwordx4 v[56:59], v3, s[52:55], s13 offen offset:2048
  buffer_load_dwordx4 v[60:63], v3, s[52:55], s13 offen offset:3072
  s_add_u32 s13, s17, 12288
  buffer_load_dwordx4 v[64:67], v3, s[52:55], s13 offen offset:0
  buffer_load_dwordx4 v[68:71], v3, s[52:55], s13 offen offset:1024
  buffer_load_dwordx4 v[72:75], v3, s[52:55], s13 offen offset:2048
  buffer_load_dwordx4 v[76:79], v3, s[52:55], s13 offen offset:3072
  s_waitcnt vmcnt(15)
  v_lshlrev_b32 v4, 16, v16
  v_and_b32 v5, 0xffff0000, v16
  v_pk_mul_f32 v[8:9], v[4:5], v[116:117]
  v_cvt_pk_bf16_f32 v124, v8, v9
  v_pk_mul_f32 v[4:5], v[4:5], v[84:85]
  v_cvt_pk_bf16_f32 v4, v4, v5
  v_and_b32 v5, 0xffff0000, v4
  v_lshlrev_b32 v4, 16, v4
  v_add_f32 v92, v4, v5
  v_lshlrev_b32 v4, 16, v17
  v_and_b32 v5, 0xffff0000, v17
  v_pk_mul_f32 v[8:9], v[4:5], v[118:119]
  v_cvt_pk_bf16_f32 v125, v8, v9
  v_pk_mul_f32 v[4:5], v[4:5], v[86:87]
  v_cvt_pk_bf16_f32 v4, v4, v5
  v_and_b32 v5, 0xffff0000, v4
  v_lshlrev_b32 v4, 16, v4
  v_add_f32 v92, v92, v4
  v_add_f32 v92, v92, v5
  v_lshlrev_b32 v4, 16, v18
  v_and_b32 v5, 0xffff0000, v18
  v_pk_mul_f32 v[8:9], v[4:5], v[120:121]
  v_cvt_pk_bf16_f32 v126, v8, v9
  v_pk_mul_f32 v[4:5], v[4:5], v[88:89]
  v_cvt_pk_bf16_f32 v4, v4, v5
  v_and_b32 v5, 0xffff0000, v4
  v_lshlrev_b32 v4, 16, v4
  v_add_f32 v92, v92, v4
  v_add_f32 v92, v92, v5
  v_lshlrev_b32 v4, 16, v19
  v_and_b32 v5, 0xffff0000, v19
  v_pk_mul_f32 v[8:9], v[4:5], v[122:123]
  v_cvt_pk_bf16_f32 v127, v8, v9
  v_pk_mul_f32 v[4:5], v[4:5], v[90:91]
  v_cvt_pk_bf16_f32 v4, v4, v5
  v_and_b32 v5, 0xffff0000, v4
  v_lshlrev_b32 v4, 16, v4
  v_add_f32 v92, v92, v4
  v_add_f32 v92, v92, v5
  ds_write_b128 v132, v[124:127] offset:0
  s_waitcnt lgkmcnt(1)
  s_waitcnt vmcnt(14)
  v_lshlrev_b32 v4, 16, v20
  v_and_b32 v5, 0xffff0000, v20
  v_pk_mul_f32 v[8:9], v[4:5], v[116:117]
  v_cvt_pk_bf16_f32 v128, v8, v9
  v_pk_mul_f32 v[4:5], v[4:5], v[84:85]
  v_cvt_pk_bf16_f32 v4, v4, v5
  v_and_b32 v5, 0xffff0000, v4
  v_lshlrev_b32 v4, 16, v4
  v_add_f32 v93, v4, v5
  v_lshlrev_b32 v4, 16, v21
  v_and_b32 v5, 0xffff0000, v21
  v_pk_mul_f32 v[8:9], v[4:5], v[118:119]
  v_cvt_pk_bf16_f32 v129, v8, v9
  v_pk_mul_f32 v[4:5], v[4:5], v[86:87]
  v_cvt_pk_bf16_f32 v4, v4, v5
  v_and_b32 v5, 0xffff0000, v4
  v_lshlrev_b32 v4, 16, v4
  v_add_f32 v93, v93, v4
  v_add_f32 v93, v93, v5
  v_lshlrev_b32 v4, 16, v22
  v_and_b32 v5, 0xffff0000, v22
  v_pk_mul_f32 v[8:9], v[4:5], v[120:121]
  v_cvt_pk_bf16_f32 v130, v8, v9
  v_pk_mul_f32 v[4:5], v[4:5], v[88:89]
  v_cvt_pk_bf16_f32 v4, v4, v5
  v_and_b32 v5, 0xffff0000, v4
  v_lshlrev_b32 v4, 16, v4
  v_add_f32 v93, v93, v4
  v_add_f32 v93, v93, v5
  v_lshlrev_b32 v4, 16, v23
  v_and_b32 v5, 0xffff0000, v23
  v_pk_mul_f32 v[8:9], v[4:5], v[122:123]
  v_cvt_pk_bf16_f32 v131, v8, v9
  v_pk_mul_f32 v[4:5], v[4:5], v[90:91]
  v_cvt_pk_bf16_f32 v4, v4, v5
  v_and_b32 v5, 0xffff0000, v4
  v_lshlrev_b32 v4, 16, v4
  v_add_f32 v93, v93, v4
  v_add_f32 v93, v93, v5
  ds_write_b128 v132, v[128:131] offset:1040
  s_waitcnt lgkmcnt(1)
  s_waitcnt vmcnt(13)
  v_lshlrev_b32 v4, 16, v24
  v_and_b32 v5, 0xffff0000, v24
  v_pk_mul_f32 v[8:9], v[4:5], v[116:117]
  v_cvt_pk_bf16_f32 v124, v8, v9
  v_pk_mul_f32 v[4:5], v[4:5], v[84:85]
  v_cvt_pk_bf16_f32 v4, v4, v5
  v_and_b32 v5, 0xffff0000, v4
  v_lshlrev_b32 v4, 16, v4
  v_add_f32 v94, v4, v5
  v_lshlrev_b32 v4, 16, v25
  v_and_b32 v5, 0xffff0000, v25
  v_pk_mul_f32 v[8:9], v[4:5], v[118:119]
  v_cvt_pk_bf16_f32 v125, v8, v9
  v_pk_mul_f32 v[4:5], v[4:5], v[86:87]
  v_cvt_pk_bf16_f32 v4, v4, v5
  v_and_b32 v5, 0xffff0000, v4
  v_lshlrev_b32 v4, 16, v4
  v_add_f32 v94, v94, v4
  v_add_f32 v94, v94, v5
  v_lshlrev_b32 v4, 16, v26
  v_and_b32 v5, 0xffff0000, v26
  v_pk_mul_f32 v[8:9], v[4:5], v[120:121]
  v_cvt_pk_bf16_f32 v126, v8, v9
  v_pk_mul_f32 v[4:5], v[4:5], v[88:89]
  v_cvt_pk_bf16_f32 v4, v4, v5
  v_and_b32 v5, 0xffff0000, v4
  v_lshlrev_b32 v4, 16, v4
  v_add_f32 v94, v94, v4
  v_add_f32 v94, v94, v5
  v_lshlrev_b32 v4, 16, v27
  v_and_b32 v5, 0xffff0000, v27
  v_pk_mul_f32 v[8:9], v[4:5], v[122:123]
  v_cvt_pk_bf16_f32 v127, v8, v9
  v_pk_mul_f32 v[4:5], v[4:5], v[90:91]
  v_cvt_pk_bf16_f32 v4, v4, v5
  v_and_b32 v5, 0xffff0000, v4
  v_lshlrev_b32 v4, 16, v4
  v_add_f32 v94, v94, v4
  v_add_f32 v94, v94, v5
  ds_write_b128 v132, v[124:127] offset:2080
  s_waitcnt lgkmcnt(1)
  s_waitcnt vmcnt(12)
  v_lshlrev_b32 v4, 16, v28
  v_and_b32 v5, 0xffff0000, v28
  v_pk_mul_f32 v[8:9], v[4:5], v[116:117]
  v_cvt_pk_bf16_f32 v128, v8, v9
  v_pk_mul_f32 v[4:5], v[4:5], v[84:85]
  v_cvt_pk_bf16_f32 v4, v4, v5
  v_and_b32 v5, 0xffff0000, v4
  v_lshlrev_b32 v4, 16, v4
  v_add_f32 v95, v4, v5
  v_lshlrev_b32 v4, 16, v29
  v_and_b32 v5, 0xffff0000, v29
  v_pk_mul_f32 v[8:9], v[4:5], v[118:119]
  v_cvt_pk_bf16_f32 v129, v8, v9
  v_pk_mul_f32 v[4:5], v[4:5], v[86:87]
  v_cvt_pk_bf16_f32 v4, v4, v5
  v_and_b32 v5, 0xffff0000, v4
  v_lshlrev_b32 v4, 16, v4
  v_add_f32 v95, v95, v4
  v_add_f32 v95, v95, v5
  v_lshlrev_b32 v4, 16, v30
  v_and_b32 v5, 0xffff0000, v30
  v_pk_mul_f32 v[8:9], v[4:5], v[120:121]
  v_cvt_pk_bf16_f32 v130, v8, v9
  v_pk_mul_f32 v[4:5], v[4:5], v[88:89]
  v_cvt_pk_bf16_f32 v4, v4, v5
  v_and_b32 v5, 0xffff0000, v4
  v_lshlrev_b32 v4, 16, v4
  v_add_f32 v95, v95, v4
  v_add_f32 v95, v95, v5
  v_lshlrev_b32 v4, 16, v31
  v_and_b32 v5, 0xffff0000, v31
  v_pk_mul_f32 v[8:9], v[4:5], v[122:123]
  v_cvt_pk_bf16_f32 v131, v8, v9
  v_pk_mul_f32 v[4:5], v[4:5], v[90:91]
  v_cvt_pk_bf16_f32 v4, v4, v5
  v_and_b32 v5, 0xffff0000, v4
  v_lshlrev_b32 v4, 16, v4
  v_add_f32 v95, v95, v4
  v_add_f32 v95, v95, v5
  ds_write_b128 v132, v[128:131] offset:3120
  s_waitcnt lgkmcnt(1)
  s_waitcnt vmcnt(11)
  v_lshlrev_b32 v4, 16, v32
  v_and_b32 v5, 0xffff0000, v32
  v_pk_mul_f32 v[8:9], v[4:5], v[116:117]
  v_cvt_pk_bf16_f32 v124, v8, v9
  v_pk_mul_f32 v[4:5], v[4:5], v[84:85]
  v_cvt_pk_bf16_f32 v4, v4, v5
  v_and_b32 v5, 0xffff0000, v4
  v_lshlrev_b32 v4, 16, v4
  v_add_f32 v96, v4, v5
  v_lshlrev_b32 v4, 16, v33
  v_and_b32 v5, 0xffff0000, v33
  v_pk_mul_f32 v[8:9], v[4:5], v[118:119]
  v_cvt_pk_bf16_f32 v125, v8, v9
  v_pk_mul_f32 v[4:5], v[4:5], v[86:87]
  v_cvt_pk_bf16_f32 v4, v4, v5
  v_and_b32 v5, 0xffff0000, v4
  v_lshlrev_b32 v4, 16, v4
  v_add_f32 v96, v96, v4
  v_add_f32 v96, v96, v5
  v_lshlrev_b32 v4, 16, v34
  v_and_b32 v5, 0xffff0000, v34
  v_pk_mul_f32 v[8:9], v[4:5], v[120:121]
  v_cvt_pk_bf16_f32 v126, v8, v9
  v_pk_mul_f32 v[4:5], v[4:5], v[88:89]
  v_cvt_pk_bf16_f32 v4, v4, v5
  v_and_b32 v5, 0xffff0000, v4
  v_lshlrev_b32 v4, 16, v4
  v_add_f32 v96, v96, v4
  v_add_f32 v96, v96, v5
  v_lshlrev_b32 v4, 16, v35
  v_and_b32 v5, 0xffff0000, v35
  v_pk_mul_f32 v[8:9], v[4:5], v[122:123]
  v_cvt_pk_bf16_f32 v127, v8, v9
  v_pk_mul_f32 v[4:5], v[4:5], v[90:91]
  v_cvt_pk_bf16_f32 v4, v4, v5
  v_and_b32 v5, 0xffff0000, v4
  v_lshlrev_b32 v4, 16, v4
  v_add_f32 v96, v96, v4
  v_add_f32 v96, v96, v5
  ds_write_b128 v132, v[124:127] offset:4160
  s_waitcnt lgkmcnt(1)
  s_waitcnt vmcnt(10)
  v_lshlrev_b32 v4, 16, v36
  v_and_b32 v5, 0xffff0000, v36
  v_pk_mul_f32 v[8:9], v[4:5], v[116:117]
  v_cvt_pk_bf16_f32 v128, v8, v9
  v_pk_mul_f32 v[4:5], v[4:5], v[84:85]
  v_cvt_pk_bf16_f32 v4, v4, v5
  v_and_b32 v5, 0xffff0000, v4
  v_lshlrev_b32 v4, 16, v4
  v_add_f32 v97, v4, v5
  v_lshlrev_b32 v4, 16, v37
  v_and_b32 v5, 0xffff0000, v37
  v_pk_mul_f32 v[8:9], v[4:5], v[118:119]
  v_cvt_pk_bf16_f32 v129, v8, v9
  v_pk_mul_f32 v[4:5], v[4:5], v[86:87]
  v_cvt_pk_bf16_f32 v4, v4, v5
  v_and_b32 v5, 0xffff0000, v4
  v_lshlrev_b32 v4, 16, v4
  v_add_f32 v97, v97, v4
  v_add_f32 v97, v97, v5
  v_lshlrev_b32 v4, 16, v38
  v_and_b32 v5, 0xffff0000, v38
  v_pk_mul_f32 v[8:9], v[4:5], v[120:121]
  v_cvt_pk_bf16_f32 v130, v8, v9
  v_pk_mul_f32 v[4:5], v[4:5], v[88:89]
  v_cvt_pk_bf16_f32 v4, v4, v5
  v_and_b32 v5, 0xffff0000, v4
  v_lshlrev_b32 v4, 16, v4
  v_add_f32 v97, v97, v4
  v_add_f32 v97, v97, v5
  v_lshlrev_b32 v4, 16, v39
  v_and_b32 v5, 0xffff0000, v39
  v_pk_mul_f32 v[8:9], v[4:5], v[122:123]
  v_cvt_pk_bf16_f32 v131, v8, v9
  v_pk_mul_f32 v[4:5], v[4:5], v[90:91]
  v_cvt_pk_bf16_f32 v4, v4, v5
  v_and_b32 v5, 0xffff0000, v4
  v_lshlrev_b32 v4, 16, v4
  v_add_f32 v97, v97, v4
  v_add_f32 v97, v97, v5
  ds_write_b128 v132, v[128:131] offset:5200
  s_waitcnt lgkmcnt(1)
  s_waitcnt vmcnt(9)
  v_lshlrev_b32 v4, 16, v40
  v_and_b32 v5, 0xffff0000, v40
  v_pk_mul_f32 v[8:9], v[4:5], v[116:117]
  v_cvt_pk_bf16_f32 v124, v8, v9
  v_pk_mul_f32 v[4:5], v[4:5], v[84:85]
  v_cvt_pk_bf16_f32 v4, v4, v5
  v_and_b32 v5, 0xffff0000, v4
  v_lshlrev_b32 v4, 16, v4
  v_add_f32 v98, v4, v5
  v_lshlrev_b32 v4, 16, v41
  v_and_b32 v5, 0xffff0000, v41
  v_pk_mul_f32 v[8:9], v[4:5], v[118:119]
  v_cvt_pk_bf16_f32 v125, v8, v9
  v_pk_mul_f32 v[4:5], v[4:5], v[86:87]
  v_cvt_pk_bf16_f32 v4, v4, v5
  v_and_b32 v5, 0xffff0000, v4
  v_lshlrev_b32 v4, 16, v4
  v_add_f32 v98, v98, v4
  v_add_f32 v98, v98, v5
  v_lshlrev_b32 v4, 16, v42
  v_and_b32 v5, 0xffff0000, v42
  v_pk_mul_f32 v[8:9], v[4:5], v[120:121]
  v_cvt_pk_bf16_f32 v126, v8, v9
  v_pk_mul_f32 v[4:5], v[4:5], v[88:89]
  v_cvt_pk_bf16_f32 v4, v4, v5
  v_and_b32 v5, 0xffff0000, v4
  v_lshlrev_b32 v4, 16, v4
  v_add_f32 v98, v98, v4
  v_add_f32 v98, v98, v5
  v_lshlrev_b32 v4, 16, v43
  v_and_b32 v5, 0xffff0000, v43
  v_pk_mul_f32 v[8:9], v[4:5], v[122:123]
  v_cvt_pk_bf16_f32 v127, v8, v9
  v_pk_mul_f32 v[4:5], v[4:5], v[90:91]
  v_cvt_pk_bf16_f32 v4, v4, v5
  v_and_b32 v5, 0xffff0000, v4
  v_lshlrev_b32 v4, 16, v4
  v_add_f32 v98, v98, v4
  v_add_f32 v98, v98, v5
  ds_write_b128 v132, v[124:127] offset:6240
  s_waitcnt lgkmcnt(1)
  s_waitcnt vmcnt(8)
  v_lshlrev_b32 v4, 16, v44
  v_and_b32 v5, 0xffff0000, v44
  v_pk_mul_f32 v[8:9], v[4:5], v[116:117]
  v_cvt_pk_bf16_f32 v128, v8, v9
  v_pk_mul_f32 v[4:5], v[4:5], v[84:85]
  v_cvt_pk_bf16_f32 v4, v4, v5
  v_and_b32 v5, 0xffff0000, v4
  v_lshlrev_b32 v4, 16, v4
  v_add_f32 v99, v4, v5
  v_lshlrev_b32 v4, 16, v45
  v_and_b32 v5, 0xffff0000, v45
  v_pk_mul_f32 v[8:9], v[4:5], v[118:119]
  v_cvt_pk_bf16_f32 v129, v8, v9
  v_pk_mul_f32 v[4:5], v[4:5], v[86:87]
  v_cvt_pk_bf16_f32 v4, v4, v5
  v_and_b32 v5, 0xffff0000, v4
  v_lshlrev_b32 v4, 16, v4
  v_add_f32 v99, v99, v4
  v_add_f32 v99, v99, v5
  v_lshlrev_b32 v4, 16, v46
  v_and_b32 v5, 0xffff0000, v46
  v_pk_mul_f32 v[8:9], v[4:5], v[120:121]
  v_cvt_pk_bf16_f32 v130, v8, v9
  v_pk_mul_f32 v[4:5], v[4:5], v[88:89]
  v_cvt_pk_bf16_f32 v4, v4, v5
  v_and_b32 v5, 0xffff0000, v4
  v_lshlrev_b32 v4, 16, v4
  v_add_f32 v99, v99, v4
  v_add_f32 v99, v99, v5
  v_lshlrev_b32 v4, 16, v47
  v_and_b32 v5, 0xffff0000, v47
  v_pk_mul_f32 v[8:9], v[4:5], v[122:123]
  v_cvt_pk_bf16_f32 v131, v8, v9
  v_pk_mul_f32 v[4:5], v[4:5], v[90:91]
  v_cvt_pk_bf16_f32 v4, v4, v5
  v_and_b32 v5, 0xffff0000, v4
  v_lshlrev_b32 v4, 16, v4
  v_add_f32 v99, v99, v4
  v_add_f32 v99, v99, v5
  ds_write_b128 v132, v[128:131] offset:7280
  s_waitcnt lgkmcnt(1)
  s_waitcnt vmcnt(7)
  v_lshlrev_b32 v4, 16, v48
  v_and_b32 v5, 0xffff0000, v48
  v_pk_mul_f32 v[8:9], v[4:5], v[116:117]
  v_cvt_pk_bf16_f32 v124, v8, v9
  v_pk_mul_f32 v[4:5], v[4:5], v[84:85]
  v_cvt_pk_bf16_f32 v4, v4, v5
  v_and_b32 v5, 0xffff0000, v4
  v_lshlrev_b32 v4, 16, v4
  v_add_f32 v100, v4, v5
  v_lshlrev_b32 v4, 16, v49
  v_and_b32 v5, 0xffff0000, v49
  v_pk_mul_f32 v[8:9], v[4:5], v[118:119]
  v_cvt_pk_bf16_f32 v125, v8, v9
  v_pk_mul_f32 v[4:5], v[4:5], v[86:87]
  v_cvt_pk_bf16_f32 v4, v4, v5
  v_and_b32 v5, 0xffff0000, v4
  v_lshlrev_b32 v4, 16, v4
  v_add_f32 v100, v100, v4
  v_add_f32 v100, v100, v5
  v_lshlrev_b32 v4, 16, v50
  v_and_b32 v5, 0xffff0000, v50
  v_pk_mul_f32 v[8:9], v[4:5], v[120:121]
  v_cvt_pk_bf16_f32 v126, v8, v9
  v_pk_mul_f32 v[4:5], v[4:5], v[88:89]
  v_cvt_pk_bf16_f32 v4, v4, v5
  v_and_b32 v5, 0xffff0000, v4
  v_lshlrev_b32 v4, 16, v4
  v_add_f32 v100, v100, v4
  v_add_f32 v100, v100, v5
  v_lshlrev_b32 v4, 16, v51
  v_and_b32 v5, 0xffff0000, v51
  v_pk_mul_f32 v[8:9], v[4:5], v[122:123]
  v_cvt_pk_bf16_f32 v127, v8, v9
  v_pk_mul_f32 v[4:5], v[4:5], v[90:91]
  v_cvt_pk_bf16_f32 v4, v4, v5
  v_and_b32 v5, 0xffff0000, v4
  v_lshlrev_b32 v4, 16, v4
  v_add_f32 v100, v100, v4
  v_add_f32 v100, v100, v5
  ds_write_b128 v132, v[124:127] offset:8320
  s_waitcnt lgkmcnt(1)
  s_waitcnt vmcnt(6)
  v_lshlrev_b32 v4, 16, v52
  v_and_b32 v5, 0xffff0000, v52
  v_pk_mul_f32 v[8:9], v[4:5], v[116:117]
  v_cvt_pk_bf16_f32 v128, v8, v9
  v_pk_mul_f32 v[4:5], v[4:5], v[84:85]
  v_cvt_pk_bf16_f32 v4, v4, v5
  v_and_b32 v5, 0xffff0000, v4
  v_lshlrev_b32 v4, 16, v4
  v_add_f32 v101, v4, v5
  v_lshlrev_b32 v4, 16, v53
  v_and_b32 v5, 0xffff0000, v53
  v_pk_mul_f32 v[8:9], v[4:5], v[118:119]
  v_cvt_pk_bf16_f32 v129, v8, v9
  v_pk_mul_f32 v[4:5], v[4:5], v[86:87]
  v_cvt_pk_bf16_f32 v4, v4, v5
  v_and_b32 v5, 0xffff0000, v4
  v_lshlrev_b32 v4, 16, v4
  v_add_f32 v101, v101, v4
  v_add_f32 v101, v101, v5
  v_lshlrev_b32 v4, 16, v54
  v_and_b32 v5, 0xffff0000, v54
  v_pk_mul_f32 v[8:9], v[4:5], v[120:121]
  v_cvt_pk_bf16_f32 v130, v8, v9
  v_pk_mul_f32 v[4:5], v[4:5], v[88:89]
  v_cvt_pk_bf16_f32 v4, v4, v5
  v_and_b32 v5, 0xffff0000, v4
  v_lshlrev_b32 v4, 16, v4
  v_add_f32 v101, v101, v4
  v_add_f32 v101, v101, v5
  v_lshlrev_b32 v4, 16, v55
  v_and_b32 v5, 0xffff0000, v55
  v_pk_mul_f32 v[8:9], v[4:5], v[122:123]
  v_cvt_pk_bf16_f32 v131, v8, v9
  v_pk_mul_f32 v[4:5], v[4:5], v[90:91]
  v_cvt_pk_bf16_f32 v4, v4, v5
  v_and_b32 v5, 0xffff0000, v4
  v_lshlrev_b32 v4, 16, v4
  v_add_f32 v101, v101, v4
  v_add_f32 v101, v101, v5
  ds_write_b128 v132, v[128:131] offset:9360
  s_waitcnt lgkmcnt(1)
  s_waitcnt vmcnt(5)
  v_lshlrev_b32 v4, 16, v56
  v_and_b32 v5, 0xffff0000, v56
  v_pk_mul_f32 v[8:9], v[4:5], v[116:117]
  v_cvt_pk_bf16_f32 v124, v8, v9
  v_pk_mul_f32 v[4:5], v[4:5], v[84:85]
  v_cvt_pk_bf16_f32 v4, v4, v5
  v_and_b32 v5, 0xffff0000, v4
  v_lshlrev_b32 v4, 16, v4
  v_add_f32 v102, v4, v5
  v_lshlrev_b32 v4, 16, v57
  v_and_b32 v5, 0xffff0000, v57
  v_pk_mul_f32 v[8:9], v[4:5], v[118:119]
  v_cvt_pk_bf16_f32 v125, v8, v9
  v_pk_mul_f32 v[4:5], v[4:5], v[86:87]
  v_cvt_pk_bf16_f32 v4, v4, v5
  v_and_b32 v5, 0xffff0000, v4
  v_lshlrev_b32 v4, 16, v4
  v_add_f32 v102, v102, v4
  v_add_f32 v102, v102, v5
  v_lshlrev_b32 v4, 16, v58
  v_and_b32 v5, 0xffff0000, v58
  v_pk_mul_f32 v[8:9], v[4:5], v[120:121]
  v_cvt_pk_bf16_f32 v126, v8, v9
  v_pk_mul_f32 v[4:5], v[4:5], v[88:89]
  v_cvt_pk_bf16_f32 v4, v4, v5
  v_and_b32 v5, 0xffff0000, v4
  v_lshlrev_b32 v4, 16, v4
  v_add_f32 v102, v102, v4
  v_add_f32 v102, v102, v5
  v_lshlrev_b32 v4, 16, v59
  v_and_b32 v5, 0xffff0000, v59
  v_pk_mul_f32 v[8:9], v[4:5], v[122:123]
  v_cvt_pk_bf16_f32 v127, v8, v9
  v_pk_mul_f32 v[4:5], v[4:5], v[90:91]
  v_cvt_pk_bf16_f32 v4, v4, v5
  v_and_b32 v5, 0xffff0000, v4
  v_lshlrev_b32 v4, 16, v4
  v_add_f32 v102, v102, v4
  v_add_f32 v102, v102, v5
  ds_write_b128 v132, v[124:127] offset:10400
  s_waitcnt lgkmcnt(1)
  s_waitcnt vmcnt(4)
  v_lshlrev_b32 v4, 16, v60
  v_and_b32 v5, 0xffff0000, v60
  v_pk_mul_f32 v[8:9], v[4:5], v[116:117]
  v_cvt_pk_bf16_f32 v128, v8, v9
  v_pk_mul_f32 v[4:5], v[4:5], v[84:85]
  v_cvt_pk_bf16_f32 v4, v4, v5
  v_and_b32 v5, 0xffff0000, v4
  v_lshlrev_b32 v4, 16, v4
  v_add_f32 v103, v4, v5
  v_lshlrev_b32 v4, 16, v61
  v_and_b32 v5, 0xffff0000, v61
  v_pk_mul_f32 v[8:9], v[4:5], v[118:119]
  v_cvt_pk_bf16_f32 v129, v8, v9
  v_pk_mul_f32 v[4:5], v[4:5], v[86:87]
  v_cvt_pk_bf16_f32 v4, v4, v5
  v_and_b32 v5, 0xffff0000, v4
  v_lshlrev_b32 v4, 16, v4
  v_add_f32 v103, v103, v4
  v_add_f32 v103, v103, v5
  v_lshlrev_b32 v4, 16, v62
  v_and_b32 v5, 0xffff0000, v62
  v_pk_mul_f32 v[8:9], v[4:5], v[120:121]
  v_cvt_pk_bf16_f32 v130, v8, v9
  v_pk_mul_f32 v[4:5], v[4:5], v[88:89]
  v_cvt_pk_bf16_f32 v4, v4, v5
  v_and_b32 v5, 0xffff0000, v4
  v_lshlrev_b32 v4, 16, v4
  v_add_f32 v103, v103, v4
  v_add_f32 v103, v103, v5
  v_lshlrev_b32 v4, 16, v63
  v_and_b32 v5, 0xffff0000, v63
  v_pk_mul_f32 v[8:9], v[4:5], v[122:123]
  v_cvt_pk_bf16_f32 v131, v8, v9
  v_pk_mul_f32 v[4:5], v[4:5], v[90:91]
  v_cvt_pk_bf16_f32 v4, v4, v5
  v_and_b32 v5, 0xffff0000, v4
  v_lshlrev_b32 v4, 16, v4
  v_add_f32 v103, v103, v4
  v_add_f32 v103, v103, v5
  ds_write_b128 v132, v[128:131] offset:11440
  s_waitcnt lgkmcnt(1)
  s_waitcnt vmcnt(3)
  v_lshlrev_b32 v4, 16, v64
  v_and_b32 v5, 0xffff0000, v64
  v_pk_mul_f32 v[8:9], v[4:5], v[116:117]
  v_cvt_pk_bf16_f32 v124, v8, v9
  v_pk_mul_f32 v[4:5], v[4:5], v[84:85]
  v_cvt_pk_bf16_f32 v4, v4, v5
  v_and_b32 v5, 0xffff0000, v4
  v_lshlrev_b32 v4, 16, v4
  v_add_f32 v104, v4, v5
  v_lshlrev_b32 v4, 16, v65
  v_and_b32 v5, 0xffff0000, v65
  v_pk_mul_f32 v[8:9], v[4:5], v[118:119]
  v_cvt_pk_bf16_f32 v125, v8, v9
  v_pk_mul_f32 v[4:5], v[4:5], v[86:87]
  v_cvt_pk_bf16_f32 v4, v4, v5
  v_and_b32 v5, 0xffff0000, v4
  v_lshlrev_b32 v4, 16, v4
  v_add_f32 v104, v104, v4
  v_add_f32 v104, v104, v5
  v_lshlrev_b32 v4, 16, v66
  v_and_b32 v5, 0xffff0000, v66
  v_pk_mul_f32 v[8:9], v[4:5], v[120:121]
  v_cvt_pk_bf16_f32 v126, v8, v9
  v_pk_mul_f32 v[4:5], v[4:5], v[88:89]
  v_cvt_pk_bf16_f32 v4, v4, v5
  v_and_b32 v5, 0xffff0000, v4
  v_lshlrev_b32 v4, 16, v4
  v_add_f32 v104, v104, v4
  v_add_f32 v104, v104, v5
  v_lshlrev_b32 v4, 16, v67
  v_and_b32 v5, 0xffff0000, v67
  v_pk_mul_f32 v[8:9], v[4:5], v[122:123]
  v_cvt_pk_bf16_f32 v127, v8, v9
  v_pk_mul_f32 v[4:5], v[4:5], v[90:91]
  v_cvt_pk_bf16_f32 v4, v4, v5
  v_and_b32 v5, 0xffff0000, v4
  v_lshlrev_b32 v4, 16, v4
  v_add_f32 v104, v104, v4
  v_add_f32 v104, v104, v5
  ds_write_b128 v132, v[124:127] offset:12480
  s_waitcnt lgkmcnt(1)
  s_waitcnt vmcnt(2)
  v_lshlrev_b32 v4, 16, v68
  v_and_b32 v5, 0xffff0000, v68
  v_pk_mul_f32 v[8:9], v[4:5], v[116:117]
  v_cvt_pk_bf16_f32 v128, v8, v9
  v_pk_mul_f32 v[4:5], v[4:5], v[84:85]
  v_cvt_pk_bf16_f32 v4, v4, v5
  v_and_b32 v5, 0xffff0000, v4
  v_lshlrev_b32 v4, 16, v4
  v_add_f32 v105, v4, v5
  v_lshlrev_b32 v4, 16, v69
  v_and_b32 v5, 0xffff0000, v69
  v_pk_mul_f32 v[8:9], v[4:5], v[118:119]
  v_cvt_pk_bf16_f32 v129, v8, v9
  v_pk_mul_f32 v[4:5], v[4:5], v[86:87]
  v_cvt_pk_bf16_f32 v4, v4, v5
  v_and_b32 v5, 0xffff0000, v4
  v_lshlrev_b32 v4, 16, v4
  v_add_f32 v105, v105, v4
  v_add_f32 v105, v105, v5
  v_lshlrev_b32 v4, 16, v70
  v_and_b32 v5, 0xffff0000, v70
  v_pk_mul_f32 v[8:9], v[4:5], v[120:121]
  v_cvt_pk_bf16_f32 v130, v8, v9
  v_pk_mul_f32 v[4:5], v[4:5], v[88:89]
  v_cvt_pk_bf16_f32 v4, v4, v5
  v_and_b32 v5, 0xffff0000, v4
  v_lshlrev_b32 v4, 16, v4
  v_add_f32 v105, v105, v4
  v_add_f32 v105, v105, v5
  v_lshlrev_b32 v4, 16, v71
  v_and_b32 v5, 0xffff0000, v71
  v_pk_mul_f32 v[8:9], v[4:5], v[122:123]
  v_cvt_pk_bf16_f32 v131, v8, v9
  v_pk_mul_f32 v[4:5], v[4:5], v[90:91]
  v_cvt_pk_bf16_f32 v4, v4, v5
  v_and_b32 v5, 0xffff0000, v4
  v_lshlrev_b32 v4, 16, v4
  v_add_f32 v105, v105, v4
  v_add_f32 v105, v105, v5
  ds_write_b128 v132, v[128:131] offset:13520
  s_waitcnt lgkmcnt(1)
  s_waitcnt vmcnt(1)
  v_lshlrev_b32 v4, 16, v72
  v_and_b32 v5, 0xffff0000, v72
  v_pk_mul_f32 v[8:9], v[4:5], v[116:117]
  v_cvt_pk_bf16_f32 v124, v8, v9
  v_pk_mul_f32 v[4:5], v[4:5], v[84:85]
  v_cvt_pk_bf16_f32 v4, v4, v5
  v_and_b32 v5, 0xffff0000, v4
  v_lshlrev_b32 v4, 16, v4
  v_add_f32 v106, v4, v5
  v_lshlrev_b32 v4, 16, v73
  v_and_b32 v5, 0xffff0000, v73
  v_pk_mul_f32 v[8:9], v[4:5], v[118:119]
  v_cvt_pk_bf16_f32 v125, v8, v9
  v_pk_mul_f32 v[4:5], v[4:5], v[86:87]
  v_cvt_pk_bf16_f32 v4, v4, v5
  v_and_b32 v5, 0xffff0000, v4
  v_lshlrev_b32 v4, 16, v4
  v_add_f32 v106, v106, v4
  v_add_f32 v106, v106, v5
  v_lshlrev_b32 v4, 16, v74
  v_and_b32 v5, 0xffff0000, v74
  v_pk_mul_f32 v[8:9], v[4:5], v[120:121]
  v_cvt_pk_bf16_f32 v126, v8, v9
  v_pk_mul_f32 v[4:5], v[4:5], v[88:89]
  v_cvt_pk_bf16_f32 v4, v4, v5
  v_and_b32 v5, 0xffff0000, v4
  v_lshlrev_b32 v4, 16, v4
  v_add_f32 v106, v106, v4
  v_add_f32 v106, v106, v5
  v_lshlrev_b32 v4, 16, v75
  v_and_b32 v5, 0xffff0000, v75
  v_pk_mul_f32 v[8:9], v[4:5], v[122:123]
  v_cvt_pk_bf16_f32 v127, v8, v9
  v_pk_mul_f32 v[4:5], v[4:5], v[90:91]
  v_cvt_pk_bf16_f32 v4, v4, v5
  v_and_b32 v5, 0xffff0000, v4
  v_lshlrev_b32 v4, 16, v4
  v_add_f32 v106, v106, v4
  v_add_f32 v106, v106, v5
  ds_write_b128 v132, v[124:127] offset:14560
  s_waitcnt lgkmcnt(1)
  s_waitcnt vmcnt(0)
  v_lshlrev_b32 v4, 16, v76
  v_and_b32 v5, 0xffff0000, v76
  v_pk_mul_f32 v[8:9], v[4:5], v[116:117]
  v_cvt_pk_bf16_f32 v128, v8, v9
  v_pk_mul_f32 v[4:5], v[4:5], v[84:85]
  v_cvt_pk_bf16_f32 v4, v4, v5
  v_and_b32 v5, 0xffff0000, v4
  v_lshlrev_b32 v4, 16, v4
  v_add_f32 v107, v4, v5
  v_lshlrev_b32 v4, 16, v77
  v_and_b32 v5, 0xffff0000, v77
  v_pk_mul_f32 v[8:9], v[4:5], v[118:119]
  v_cvt_pk_bf16_f32 v129, v8, v9
  v_pk_mul_f32 v[4:5], v[4:5], v[86:87]
  v_cvt_pk_bf16_f32 v4, v4, v5
  v_and_b32 v5, 0xffff0000, v4
  v_lshlrev_b32 v4, 16, v4
  v_add_f32 v107, v107, v4
  v_add_f32 v107, v107, v5
  v_lshlrev_b32 v4, 16, v78
  v_and_b32 v5, 0xffff0000, v78
  v_pk_mul_f32 v[8:9], v[4:5], v[120:121]
  v_cvt_pk_bf16_f32 v130, v8, v9
  v_pk_mul_f32 v[4:5], v[4:5], v[88:89]
  v_cvt_pk_bf16_f32 v4, v4, v5
  v_and_b32 v5, 0xffff0000, v4
  v_lshlrev_b32 v4, 16, v4
  v_add_f32 v107, v107, v4
  v_add_f32 v107, v107, v5
  v_lshlrev_b32 v4, 16, v79
  v_and_b32 v5, 0xffff0000, v79
  v_pk_mul_f32 v[8:9], v[4:5], v[122:123]
  v_cvt_pk_bf16_f32 v131, v8, v9
  v_pk_mul_f32 v[4:5], v[4:5], v[90:91]
  v_cvt_pk_bf16_f32 v4, v4, v5
  v_and_b32 v5, 0xffff0000, v4
  v_lshlrev_b32 v4, 16, v4
  v_add_f32 v107, v107, v4
  v_add_f32 v107, v107, v5
  ds_write_b128 v132, v[128:131] offset:15600
  s_waitcnt lgkmcnt(1)
  v_add_u32 v132, 16640, v132
  v_add_f32_dpp v92, v92, v92 row_ror:8 row_mask:0xf bank_mask:0xf
  v_add_f32_dpp v93, v93, v93 row_ror:8 row_mask:0xf bank_mask:0xf
  v_add_f32_dpp v94, v94, v94 row_ror:8 row_mask:0xf bank_mask:0xf
  v_add_f32_dpp v95, v95, v95 row_ror:8 row_mask:0xf bank_mask:0xf
  v_add_f32_dpp v96, v96, v96 row_ror:8 row_mask:0xf bank_mask:0xf
  v_add_f32_dpp v97, v97, v97 row_ror:8 row_mask:0xf bank_mask:0xf
  v_add_f32_dpp v98, v98, v98 row_ror:8 row_mask:0xf bank_mask:0xf
  v_add_f32_dpp v99, v99, v99 row_ror:8 row_mask:0xf bank_mask:0xf
  v_add_f32_dpp v100, v100, v100 row_ror:8 row_mask:0xf bank_mask:0xf
  v_add_f32_dpp v101, v101, v101 row_ror:8 row_mask:0xf bank_mask:0xf
  v_add_f32_dpp v102, v102, v102 row_ror:8 row_mask:0xf bank_mask:0xf
  v_add_f32_dpp v103, v103, v103 row_ror:8 row_mask:0xf bank_mask:0xf
  v_add_f32_dpp v104, v104, v104 row_ror:8 row_mask:0xf bank_mask:0xf
  v_add_f32_dpp v105, v105, v105 row_ror:8 row_mask:0xf bank_mask:0xf
  v_add_f32_dpp v106, v106, v106 row_ror:8 row_mask:0xf bank_mask:0xf
  v_add_f32_dpp v107, v107, v107 row_ror:8 row_mask:0xf bank_mask:0xf
  v_add_f32_dpp v92, v92, v92 row_ror:4 row_mask:0xf bank_mask:0xf
  v_add_f32_dpp v93, v93, v93 row_ror:4 row_mask:0xf bank_mask:0xf
  v_add_f32_dpp v94, v94, v94 row_ror:4 row_mask:0xf bank_mask:0xf
  v_add_f32_dpp v95, v95, v95 row_ror:4 row_mask:0xf bank_mask:0xf
  v_add_f32_dpp v96, v96, v96 row_ror:4 row_mask:0xf bank_mask:0xf
  v_add_f32_dpp v97, v97, v97 row_ror:4 row_mask:0xf bank_mask:0xf
  v_add_f32_dpp v98, v98, v98 row_ror:4 row_mask:0xf bank_mask:0xf
  v_add_f32_dpp v99, v99, v99 row_ror:4 row_mask:0xf bank_mask:0xf
  v_add_f32_dpp v100, v100, v100 row_ror:4 row_mask:0xf bank_mask:0xf
  v_add_f32_dpp v101, v101, v101 row_ror:4 row_mask:0xf bank_mask:0xf
  v_add_f32_dpp v102, v102, v102 row_ror:4 row_mask:0xf bank_mask:0xf
  v_add_f32_dpp v103, v103, v103 row_ror:4 row_mask:0xf bank_mask:0xf
  v_add_f32_dpp v104, v104, v104 row_ror:4 row_mask:0xf bank_mask:0xf
  v_add_f32_dpp v105, v105, v105 row_ror:4 row_mask:0xf bank_mask:0xf
  v_add_f32_dpp v106, v106, v106 row_ror:4 row_mask:0xf bank_mask:0xf
  v_add_f32_dpp v107, v107, v107 row_ror:4 row_mask:0xf bank_mask:0xf
  v_add_f32_dpp v92, v92, v92 row_ror:2 row_mask:0xf bank_mask:0xf
  v_add_f32_dpp v93, v93, v93 row_ror:2 row_mask:0xf bank_mask:0xf
  v_add_f32_dpp v94, v94, v94 row_ror:2 row_mask:0xf bank_mask:0xf
  v_add_f32_dpp v95, v95, v95 row_ror:2 row_mask:0xf bank_mask:0xf
  v_add_f32_dpp v96, v96, v96 row_ror:2 row_mask:0xf bank_mask:0xf
  v_add_f32_dpp v97, v97, v97 row_ror:2 row_mask:0xf bank_mask:0xf
  v_add_f32_dpp v98, v98, v98 row_ror:2 row_mask:0xf bank_mask:0xf
  v_add_f32_dpp v99, v99, v99 row_ror:2 row_mask:0xf bank_mask:0xf
  v_add_f32_dpp v100, v100, v100 row_ror:2 row_mask:0xf bank_mask:0xf
  v_add_f32_dpp v101, v101, v101 row_ror:2 row_mask:0xf bank_mask:0xf
  v_add_f32_dpp v102, v102, v102 row_ror:2 row_mask:0xf bank_mask:0xf
  v_add_f32_dpp v103, v103, v103 row_ror:2 row_mask:0xf bank_mask:0xf
  v_add_f32_dpp v104, v104, v104 row_ror:2 row_mask:0xf bank_mask:0xf
  v_add_f32_dpp v105, v105, v105 row_ror:2 row_mask:0xf bank_mask:0xf
  v_add_f32_dpp v106, v106, v106 row_ror:2 row_mask:0xf bank_mask:0xf
  v_add_f32_dpp v107, v107, v107 row_ror:2 row_mask:0xf bank_mask:0xf
  v_add_f32_dpp v92, v92, v92 row_ror:1 row_mask:0xf bank_mask:0xf
  v_add_f32_dpp v93, v93, v93 row_ror:1 row_mask:0xf bank_mask:0xf
  v_add_f32_dpp v94, v94, v94 row_ror:1 row_mask:0xf bank_mask:0xf
  v_add_f32_dpp v95, v95, v95 row_ror:1 row_mask:0xf bank_mask:0xf
  v_add_f32_dpp v96, v96, v96 row_ror:1 row_mask:0xf bank_mask:0xf
  v_add_f32_dpp v97, v97, v97 row_ror:1 row_mask:0xf bank_mask:0xf
  v_add_f32_dpp v98, v98, v98 row_ror:1 row_mask:0xf bank_mask:0xf
  v_add_f32_dpp v99, v99, v99 row_ror:1 row_mask:0xf bank_mask:0xf
  v_add_f32_dpp v100, v100, v100 row_ror:1 row_mask:0xf bank_mask:0xf
  v_add_f32_dpp v101, v101, v101 row_ror:1 row_mask:0xf bank_mask:0xf
  v_add_f32_dpp v102, v102, v102 row_ror:1 row_mask:0xf bank_mask:0xf
  v_add_f32_dpp v103, v103, v103 row_ror:1 row_mask:0xf bank_mask:0xf
  v_add_f32_dpp v104, v104, v104 row_ror:1 row_mask:0xf bank_mask:0xf
  v_add_f32_dpp v105, v105, v105 row_ror:1 row_mask:0xf bank_mask:0xf
  v_add_f32_dpp v106, v106, v106 row_ror:1 row_mask:0xf bank_mask:0xf
  v_add_f32_dpp v107, v107, v107 row_ror:1 row_mask:0xf bank_mask:0xf
  v_mov_b32 v16, v92
  v_mov_b32 v17, v93
  v_mov_b32 v18, v94
  v_mov_b32 v19, v95
  v_mov_b32 v20, v96
  v_mov_b32 v21, v97
  v_mov_b32 v22, v98
  v_mov_b32 v23, v99
  v_mov_b32 v24, v100
  v_mov_b32 v25, v101
  v_mov_b32 v26, v102
  v_mov_b32 v27, v103
  v_mov_b32 v28, v104
  v_mov_b32 v29, v105
  v_mov_b32 v30, v106
  v_mov_b32 v31, v107
  s_nop 0
  v_permlane16_swap_b32 v92, v16
  v_permlane16_swap_b32 v93, v17
  v_permlane16_swap_b32 v94, v18
  v_permlane16_swap_b32 v95, v19
  v_permlane16_swap_b32 v96, v20
  v_permlane16_swap_b32 v97, v21
  v_permlane16_swap_b32 v98, v22
  v_permlane16_swap_b32 v99, v23
  v_permlane16_swap_b32 v100, v24
  v_permlane16_swap_b32 v101, v25
  v_permlane16_swap_b32 v102, v26
  v_permlane16_swap_b32 v103, v27
  v_permlane16_swap_b32 v104, v28
  v_permlane16_swap_b32 v105, v29
  v_permlane16_swap_b32 v106, v30
  v_permlane16_swap_b32 v107, v31
  v_add_f32 v92, v92, v16
  v_add_f32 v93, v93, v17
  v_add_f32 v94, v94, v18
  v_add_f32 v95, v95, v19
  v_add_f32 v96, v96, v20
  v_add_f32 v97, v97, v21
  v_add_f32 v98, v98, v22
  v_add_f32 v99, v99, v23
  v_add_f32 v100, v100, v24
  v_add_f32 v101, v101, v25
  v_add_f32 v102, v102, v26
  v_add_f32 v103, v103, v27
  v_add_f32 v104, v104, v28
  v_add_f32 v105, v105, v29
  v_add_f32 v106, v106, v30
  v_add_f32 v107, v107, v31
  v_mov_b32 v16, v92
  v_mov_b32 v17, v93
  v_mov_b32 v18, v94
  v_mov_b32 v19, v95
  v_mov_b32 v20, v96
  v_mov_b32 v21, v97
  v_mov_b32 v22, v98
  v_mov_b32 v23, v99
  v_mov_b32 v24, v100
  v_mov_b32 v25, v101
  v_mov_b32 v26, v102
  v_mov_b32 v27, v103
  v_mov_b32 v28, v104
  v_mov_b32 v29, v105
  v_mov_b32 v30, v106
  v_mov_b32 v31, v107
  s_nop 0
  v_permlane32_swap_b32 v92, v16
  v_permlane32_swap_b32 v93, v17
  v_permlane32_swap_b32 v94, v18
  v_permlane32_swap_b32 v95, v19
  v_permlane32_swap_b32 v96, v20
  v_permlane32_swap_b32 v97, v21
  v_permlane32_swap_b32 v98, v22
  v_permlane32_swap_b32 v99, v23
  v_permlane32_swap_b32 v100, v24
  v_permlane32_swap_b32 v101, v25
  v_permlane32_swap_b32 v102, v26
  v_permlane32_swap_b32 v103, v27
  v_permlane32_swap_b32 v104, v28
  v_permlane32_swap_b32 v105, v29
  v_permlane32_swap_b32 v106, v30
  v_permlane32_swap_b32 v107, v31
  v_add_f32 v92, v92, v16
  v_add_f32 v93, v93, v17
  v_add_f32 v94, v94, v18
  v_add_f32 v95, v95, v19
  v_add_f32 v96, v96, v20
  v_add_f32 v97, v97, v21
  v_add_f32 v98, v98, v22
  v_add_f32 v99, v99, v23
  v_add_f32 v100, v100, v24
  v_add_f32 v101, v101, v25
  v_add_f32 v102, v102, v26
  v_add_f32 v103, v103, v27
  v_add_f32 v104, v104, v28
  v_add_f32 v105, v105, v29
  v_add_f32 v106, v106, v30
  v_add_f32 v107, v107, v31
  v_cmp_eq_u32 vcc, 0, v6
  s_nop 1
  v_cndmask_b32 v108, v108, v92, vcc
  v_cmp_eq_u32 vcc, 1, v6
  s_nop 1
  v_cndmask_b32 v108, v108, v93, vcc
  v_cmp_eq_u32 vcc, 2, v6
  s_nop 1
  v_cndmask_b32 v108, v108, v94, vcc
  v_cmp_eq_u32 vcc, 3, v6
  s_nop 1
  v_cndmask_b32 v108, v108, v95, vcc
  v_cmp_eq_u32 vcc, 4, v6
  s_nop 1
  v_cndmask_b32 v108, v108, v96, vcc
  v_cmp_eq_u32 vcc, 5, v6
  s_nop 1
  v_cndmask_b32 v108, v108, v97, vcc
  v_cmp_eq_u32 vcc, 6, v6
  s_nop 1
  v_cndmask_b32 v108, v108, v98, vcc
  v_cmp_eq_u32 vcc, 7, v6
  s_nop 1
  v_cndmask_b32 v108, v108, v99, vcc
  v_cmp_eq_u32 vcc, 8, v6
  s_nop 1
  v_cndmask_b32 v108, v108, v100, vcc
  v_cmp_eq_u32 vcc, 9, v6
  s_nop 1
  v_cndmask_b32 v108, v108, v101, vcc
  v_cmp_eq_u32 vcc, 10, v6
  s_nop 1
  v_cndmask_b32 v108, v108, v102, vcc
  v_cmp_eq_u32 vcc, 11, v6
  s_nop 1
  v_cndmask_b32 v108, v108, v103, vcc
  v_cmp_eq_u32 vcc, 12, v6
  s_nop 1
  v_cndmask_b32 v108, v108, v104, vcc
  v_cmp_eq_u32 vcc, 13, v6
  s_nop 1
  v_cndmask_b32 v108, v108, v105, vcc
  v_cmp_eq_u32 vcc, 14, v6
  s_nop 1
  v_cndmask_b32 v108, v108, v106, vcc
  v_cmp_eq_u32 vcc, 15, v6
  s_nop 1
  v_cndmask_b32 v108, v108, v107, vcc
  v_subrev_u32 v6, 16, v6
  s_add_u32 s17, s17, 16384
  s_cmp_lt_u32 s17, 32768
  s_cbranch_scc1 L_gateround
  v_cvt_pk_bf16_f32 v4, v108, v108
  v_lshlrev_b32 v4, 16, v4
  v_mul_f32 v4, 0xbfb8aa3b, v4
  v_exp_f32 v4, v4
  s_nop 0
  v_add_f32 v4, 1.0, v4
  v_rcp_f32 v4, v4
  s_nop 0
  v_cvt_pk_bf16_f32 v4, v4, v4
  v_lshlrev_b32 v80, 16, v4
  v_sub_f32 v4, 1.0, v80
  v_cvt_pk_bf16_f32 v4, v4, v4
  v_lshlrev_b32 v81, 16, v4
  s_lshl_b32 s11, s16, 3
  s_add_u32 s11, s11, 0x1100000
  v_lshlrev_b32 v2, 3, v1
  s_mov_b64 exec, 0xffffffff
  buffer_store_dwordx2 v[80:81], v2, s[60:63], s11 offen sc1
  s_mov_b64 exec, -1
  s_lshl2_add_u32 s11, s4, s3
  s_lshl_b32 s12, s11, 15
  s_add_u32 s17, s12, 0xf00000
  s_mul_i32 s13, s3, 33280
  v_mul_u32_u24 v7, 1040, v12
  v_lshl_add_u32 v7, v13, 3, v7
  v_add_u32 v7, s13, v7
  v_lshlrev_b32 v8, 4, v1
  s_waitcnt lgkmcnt(0)
  ds_read_b64 v[16:17], v7 offset:0
  ds_read_b64 v[18:19], v7 offset:16
  ds_read_b64 v[20:21], v7 offset:32
  ds_read_b64 v[22:23], v7 offset:48
  ds_read_b64 v[24:25], v7 offset:64
  ds_read_b64 v[26:27], v7 offset:80
  ds_read_b64 v[28:29], v7 offset:96
  ds_read_b64 v[30:31], v7 offset:112
  ds_read_b64 v[32:33], v7 offset:128
  ds_read_b64 v[34:35], v7 offset:144
  ds_read_b64 v[36:37], v7 offset:160
  ds_read_b64 v[38:39], v7 offset:176
  ds_read_b64 v[40:41], v7 offset:192
  ds_read_b64 v[42:43], v7 offset:208
  ds_read_b64 v[44:45], v7 offset:224
  ds_read_b64 v[46:47], v7 offset:240
  ds_read_b64 v[48:49], v7 offset:256
  ds_read_b64 v[50:51], v7 offset:272
  ds_read_b64 v[52:53], v7 offset:288
  ds_read_b64 v[54:55], v7 offset:304
  ds_read_b64 v[56:57], v7 offset:320
  ds_read_b64 v[58:59], v7 offset:336
  ds_read_b64 v[60:61], v7 offset:352
  ds_read_b64 v[62:63], v7 offset:368
  ds_read_b64 v[64:65], v7 offset:384
  ds_read_b64 v[66:67], v7 offset:400
  ds_read_b64 v[68:69], v7 offset:416
  ds_read_b64 v[70:71], v7 offset:432
  ds_read_b64 v[72:73], v7 offset:448
  ds_read_b64 v[74:75], v7 offset:464
  ds_read_b64 v[76:77], v7 offset:480
  ds_read_b64 v[78:79], v7 offset:496
  s_waitcnt lgkmcnt(0)
  buffer_store_dwordx4 v[16:19], v8, s[60:63], s17 offen offset:0 sc1
  buffer_store_dwordx4 v[20:23], v8, s[60:63], s17 offen offset:1024 sc1
  buffer_store_dwordx4 v[24:27], v8, s[60:63], s17 offen offset:2048 sc1
  buffer_store_dwordx4 v[28:31], v8, s[60:63], s17 offen offset:3072 sc1
  s_add_u32 s17, s17, 4096
  buffer_store_dwordx4 v[32:35], v8, s[60:63], s17 offen offset:0 sc1
  buffer_store_dwordx4 v[36:39], v8, s[60:63], s17 offen offset:1024 sc1
  buffer_store_dwordx4 v[40:43], v8, s[60:63], s17 offen offset:2048 sc1
  buffer_store_dwordx4 v[44:47], v8, s[60:63], s17 offen offset:3072 sc1
  s_add_u32 s17, s17, 4096
  buffer_store_dwordx4 v[48:51], v8, s[60:63], s17 offen offset:0 sc1
  buffer_store_dwordx4 v[52:55], v8, s[60:63], s17 offen offset:1024 sc1
  buffer_store_dwordx4 v[56:59], v8, s[60:63], s17 offen offset:2048 sc1
  buffer_store_dwordx4 v[60:63], v8, s[60:63], s17 offen offset:3072 sc1
  s_add_u32 s17, s17, 4096
  buffer_store_dwordx4 v[64:67], v8, s[60:63], s17 offen offset:0 sc1
  buffer_store_dwordx4 v[68:71], v8, s[60:63], s17 offen offset:1024 sc1
  buffer_store_dwordx4 v[72:75], v8, s[60:63], s17 offen offset:2048 sc1
  buffer_store_dwordx4 v[76:79], v8, s[60:63], s17 offen offset:3072 sc1
  s_nop 1
  ds_read_b64 v[16:17], v7 offset:512
  ds_read_b64 v[18:19], v7 offset:528
  ds_read_b64 v[20:21], v7 offset:544
  ds_read_b64 v[22:23], v7 offset:560
  ds_read_b64 v[24:25], v7 offset:576
  ds_read_b64 v[26:27], v7 offset:592
  ds_read_b64 v[28:29], v7 offset:608
  ds_read_b64 v[30:31], v7 offset:624
  ds_read_b64 v[32:33], v7 offset:640
  ds_read_b64 v[34:35], v7 offset:656
  ds_read_b64 v[36:37], v7 offset:672
  ds_read_b64 v[38:39], v7 offset:688
  ds_read_b64 v[40:41], v7 offset:704
  ds_read_b64 v[42:43], v7 offset:720
  ds_read_b64 v[44:45], v7 offset:736
  ds_read_b64 v[46:47], v7 offset:752
  ds_read_b64 v[48:49], v7 offset:768
  ds_read_b64 v[50:51], v7 offset:784
  ds_read_b64 v[52:53], v7 offset:800
  ds_read_b64 v[54:55], v7 offset:816
  ds_read_b64 v[56:57], v7 offset:832
  ds_read_b64 v[58:59], v7 offset:848
  ds_read_b64 v[60:61], v7 offset:864
  ds_read_b64 v[62:63], v7 offset:880
  ds_read_b64 v[64:65], v7 offset:896
  ds_read_b64 v[66:67], v7 offset:912
  ds_read_b64 v[68:69], v7 offset:928
  ds_read_b64 v[70:71], v7 offset:944
  ds_read_b64 v[72:73], v7 offset:960
  ds_read_b64 v[74:75], v7 offset:976
  ds_read_b64 v[76:77], v7 offset:992
  ds_read_b64 v[78:79], v7 offset:1008
  s_waitcnt lgkmcnt(0)
  s_add_u32 s17, s17, 4096
  buffer_store_dwordx4 v[16:19], v8, s[60:63], s17 offen offset:0 sc1
  buffer_store_dwordx4 v[20:23], v8, s[60:63], s17 offen offset:1024 sc1
  buffer_store_dwordx4 v[24:27], v8, s[60:63], s17 offen offset:2048 sc1
  buffer_store_dwordx4 v[28:31], v8, s[60:63], s17 offen offset:3072 sc1
  s_add_u32 s17, s17, 4096
  buffer_store_dwordx4 v[32:35], v8, s[60:63], s17 offen offset:0 sc1
  buffer_store_dwordx4 v[36:39], v8, s[60:63], s17 offen offset:1024 sc1
  buffer_store_dwordx4 v[40:43], v8, s[60:63], s17 offen offset:2048 sc1
  buffer_store_dwordx4 v[44:47], v8, s[60:63], s17 offen offset:3072 sc1
  s_add_u32 s17, s17, 4096
  buffer_store_dwordx4 v[48:51], v8, s[60:63], s17 offen offset:0 sc1
  buffer_store_dwordx4 v[52:55], v8, s[60:63], s17 offen offset:1024 sc1
  buffer_store_dwordx4 v[56:59], v8, s[60:63], s17 offen offset:2048 sc1
  buffer_store_dwordx4 v[60:63], v8, s[60:63], s17 offen offset:3072 sc1
  s_add_u32 s17, s17, 4096
  buffer_store_dwordx4 v[64:67], v8, s[60:63], s17 offen offset:0 sc1
  buffer_store_dwordx4 v[68:71], v8, s[60:63], s17 offen offset:1024 sc1
  buffer_store_dwordx4 v[72:75], v8, s[60:63], s17 offen offset:2048 sc1
  buffer_store_dwordx4 v[76:79], v8, s[60:63], s17 offen offset:3072 sc1
  s_nop 1
  s_barrier
  v_mov_b32 v9, 0
  global_load_dwordx2 v[10:11], v9, s[48:49] sc1
  s_mov_b32 s85, 0x40000
nonce_57:
  s_waitcnt vmcnt(0)
  v_readfirstlane_b32 s76, v10
  v_readfirstlane_b32 s77, v11
  s_cmp_lg_u32 s77, 0
  s_cbranch_scc1 nonce_ok_58
  s_sub_u32 s85, s85, 1
  s_cbranch_scc1 nonce_ok_58
  s_sleep 1
  v_mov_b32 v9, 0
  global_load_dwordx2 v[10:11], v9, s[48:49] sc1
  s_branch nonce_57
nonce_ok_58:
  v_mov_b32 v4, s76
  v_mov_b32 v5, s77
  v_lshlrev_b32 v6, 3, v1
  s_mov_b64 exec, 0xffff
  s_waitcnt vmcnt(0)
  buffer_store_dwordx2 v[4:5], v6, s[60:63], s83 offen sc1
  s_mov_b64 exec, -1
  s_lshr_b32 s44, s43, 16
  s_and_b32 s45, s44, 3
  s_add_u32 s45, s45, 60
  s_lshl_b32 s45, s45, 7
  s_lshl_b32 s46, s4, 13
  s_add_u32 s45, s45, s46
  s_add_u32 s45, s45, 0x11c0000
  v_mov_b32 v220, s45
  s_lshl_b32 s44, s44, 15
  s_and_b32 s45, s43, 0x780
  s_lshl4_add_u32 s44, s45, s44
  s_add_u32 s45, s44, 0xf00000
  s_add_u32 s44, s44, 0xd00000
  s_mov_b32 s46, 0x1100000
  s_mov_b64 exec, 1
  buffer_load_dwordx2 v[222:223], v220, s[60:63], 0 offen sc1
  s_mov_b64 exec, -1
  s_mov_b32 s85, 0x40000
  s_mov_b64 exec, 1
  s_branch fchk_61
fpoll_59:
  buffer_load_dwordx2 v[222:223], v220, s[60:63], 0 offen sc1
fchk_61:
  s_waitcnt vmcnt(0)
  v_cmp_ne_u64 vcc, s[76:77], v[222:223]
  s_and_b64 exec, exec, vcc
  s_cbranch_execz fdone_60
  s_sub_u32 s85, s85, 1
  s_cbranch_scc1 fdone_60
  s_sleep 2
  s_branch fpoll_59
fdone_60:
  s_mov_b64 exec, -1
  v_lshrrev_b32 v220, 11, v15
  v_lshlrev_b32 v220, 3, v220
  v_lshlrev_b32 v221, 4, v1
  buffer_load_dwordx2 v[240:241], v220, s[60:63], s46 offen sc1
  buffer_load_dwordx4 v[242:245], v221, s[60:63], s45 offen offset:0 sc1
  buffer_load_dwordx4 v[246:249], v221, s[60:63], s45 offen offset:1024 sc1
  s_waitcnt vmcnt(0)
  v_lshlrev_b32 v224, 16, v242
  v_and_b32 v225, 0xffff0000, v242
  v_lshlrev_b32 v226, 16, v243
  v_and_b32 v227, 0xffff0000, v243
  v_lshlrev_b32 v228, 16, v244
  v_and_b32 v229, 0xffff0000, v244
  v_lshlrev_b32 v230, 16, v245
  v_and_b32 v231, 0xffff0000, v245
  v_lshlrev_b32 v232, 16, v246
  v_and_b32 v233, 0xffff0000, v246
  v_lshlrev_b32 v234, 16, v247
  v_and_b32 v235, 0xffff0000, v247
  v_lshlrev_b32 v236, 16, v248
  v_and_b32 v237, 0xffff0000, v248
  v_lshlrev_b32 v238, 16, v249
  v_and_b32 v239, 0xffff0000, v249
  v_pk_mul_f32 v[224:225], v[224:225], v[240:241] op_sel_hi:[1,0]
  v_pk_mul_f32 v[226:227], v[226:227], v[240:241] op_sel_hi:[1,0]
  v_pk_mul_f32 v[228:229], v[228:229], v[240:241] op_sel_hi:[1,0]
  v_pk_mul_f32 v[230:231], v[230:231], v[240:241] op_sel_hi:[1,0]
  v_pk_mul_f32 v[232:233], v[232:233], v[240:241] op_sel_hi:[1,0]
  v_pk_mul_f32 v[234:235], v[234:235], v[240:241] op_sel_hi:[1,0]
  v_pk_mul_f32 v[236:237], v[236:237], v[240:241] op_sel_hi:[1,0]
  v_pk_mul_f32 v[238:239], v[238:239], v[240:241] op_sel_hi:[1,0]
L_p3cons:
  s_lshl_b32 s11, s4, 13
  s_add_u32 s11, s11, 0x11c0000
  s_lshr_b32 s12, s9, 1
  s_add_u32 s12, s12, 11
  s_lshl1_add_u32 s12, s12, s10
  s_and_b32 s13, s9, 1
  s_lshl1_add_u32 s12, s12, s13
  s_lshl_b32 s12, s12, 7
  s_add_u32 s11, s11, s12
  v_mov_b32 v16, s11
  v_lshlrev_b32 v20, 4, v1
  v_bfe_u32 v2, v1, 2, 2
  v_lshl_add_u32 v3, v13, 3, v2
  v_lshlrev_b32 v3, 7, v3
  v_lshrrev_b32 v2, 1, v2
  v_xor_b32 v2, s34, v2
  v_lshl_add_u32 v3, v2, 6, v3
  v_bfe_u32 v2, v1, 4, 1
  v_lshl_add_u32 v3, v2, 5, v3
  v_and_b32 v2, 3, v1
  v_lshl_add_u32 v21, v2, 3, v3
  v_add_u32 v32, 0x10000, v21
  s_lshl_b32 s12, s35, 12
  v_lshl_add_u32 v22, v1, 4, s12
  v_add_u32 v33, 0x10000, v22
  v_add_u32 v34, 0x20000, v22
  s_barrier
  s_mov_b64 exec, 1
  buffer_load_dwordx2 v[18:19], v16, s[60:63], 0 offen sc1
  s_mov_b64 exec, -1
  ds_read_b64_tr_b16 v[36:37], v21 offset:0
  ds_read_b64_tr_b16 v[38:39], v21 offset:512
  ds_read_b128 v[68:71], v33 offset:8192
  ds_read_b64_tr_b16 v[40:41], v21 offset:2048
  ds_read_b64_tr_b16 v[42:43], v21 offset:2560
  ds_read_b128 v[72:75], v33 offset:9216
  ds_read_b64_tr_b16 v[44:45], v21 offset:4096
  ds_read_b64_tr_b16 v[46:47], v21 offset:4608
  ds_read_b128 v[76:79], v33 offset:10240
  ds_read_b64_tr_b16 v[48:49], v21 offset:6144
  ds_read_b64_tr_b16 v[50:51], v21 offset:6656
  ds_read_b128 v[80:83], v33 offset:11264
  s_waitcnt lgkmcnt(0)
  s_barrier
  v_mfma_f32_32x32x16_bf16 v[100:115], v[36:39], v[68:71], 0
  ds_read_b64_tr_b16 v[52:53], v21 offset:8192
  ds_read_b64_tr_b16 v[54:55], v21 offset:8704
  ds_read_b128 v[84:87], v33 offset:16384
  ds_read_b64_tr_b16 v[56:57], v21 offset:10240
  v_mfma_f32_32x32x16_bf16 v[100:115], v[40:43], v[72:75], v[100:115]
  ds_read_b64_tr_b16 v[58:59], v21 offset:10752
  ds_read_b128 v[88:91], v33 offset:17408
  ds_read_b64_tr_b16 v[60:61], v21 offset:12288
  ds_read_b64_tr_b16 v[62:63], v21 offset:12800
  v_mfma_f32_32x32x16_bf16 v[100:115], v[44:47], v[76:79], v[100:115]
  ds_read_b128 v[92:95], v33 offset:18432
  ds_read_b64_tr_b16 v[64:65], v21 offset:14336
  ds_read_b64_tr_b16 v[66:67], v21 offset:14848
  ds_read_b128 v[96:99], v33 offset:19456
  v_mfma_f32_32x32x16_bf16 v[100:115], v[48:51], v[80:83], v[100:115]
  s_waitcnt lgkmcnt(0)
  s_barrier
  v_mfma_f32_32x32x16_bf16 v[100:115], v[52:55], v[84:87], v[100:115]
  ds_read_b64_tr_b16 v[36:37], v21 offset:16384
  ds_read_b64_tr_b16 v[38:39], v21 offset:16896
  ds_read_b128 v[68:71], v33 offset:24576
  ds_read_b64_tr_b16 v[40:41], v21 offset:18432
  v_mfma_f32_32x32x16_bf16 v[100:115], v[56:59], v[88:91], v[100:115]
  ds_read_b64_tr_b16 v[42:43], v21 offset:18944
  ds_read_b128 v[72:75], v33 offset:25600
  ds_read_b64_tr_b16 v[44:45], v21 offset:20480
  ds_read_b64_tr_b16 v[46:47], v21 offset:20992
  v_mfma_f32_32x32x16_bf16 v[100:115], v[60:63], v[92:95], v[100:115]
  ds_read_b128 v[76:79], v33 offset:26624
  ds_read_b64_tr_b16 v[48:49], v21 offset:22528
  ds_read_b64_tr_b16 v[50:51], v21 offset:23040
  ds_read_b128 v[80:83], v33 offset:27648
  v_mfma_f32_32x32x16_bf16 v[100:115], v[64:67], v[96:99], v[100:115]
  s_waitcnt lgkmcnt(0)
  s_barrier
  v_mfma_f32_32x32x16_bf16 v[100:115], v[36:39], v[68:71], v[100:115]
  ds_read_b64_tr_b16 v[52:53], v21 offset:24576
  ds_read_b64_tr_b16 v[54:55], v21 offset:25088
  ds_read_b128 v[84:87], v33 offset:32768
  ds_read_b64_tr_b16 v[56:57], v21 offset:26624
  v_mfma_f32_32x32x16_bf16 v[100:115], v[40:43], v[72:75], v[100:115]
  ds_read_b64_tr_b16 v[58:59], v21 offset:27136
  ds_read_b128 v[88:91], v33 offset:33792
  ds_read_b64_tr_b16 v[60:61], v21 offset:28672
  ds_read_b64_tr_b16 v[62:63], v21 offset:29184
  v_mfma_f32_32x32x16_bf16 v[100:115], v[44:47], v[76:79], v[100:115]
  ds_read_b128 v[92:95], v33 offset:34816
  ds_read_b64_tr_b16 v[64:65], v21 offset:30720
  ds_read_b64_tr_b16 v[66:67], v21 offset:31232
  ds_read_b128 v[96:99], v33 offset:35840
  v_mfma_f32_32x32x16_bf16 v[100:115], v[48:51], v[80:83], v[100:115]
  s_waitcnt lgkmcnt(0)
  s_barrier
  v_mfma_f32_32x32x16_bf16 v[100:115], v[52:55], v[84:87], v[100:115]
  ds_read_b64_tr_b16 v[36:37], v21 offset:32768
  ds_read_b64_tr_b16 v[38:39], v21 offset:33280
  ds_read_b128 v[68:71], v33 offset:40960
  ds_read_b64_tr_b16 v[40:41], v21 offset:34816
  v_mfma_f32_32x32x16_bf16 v[100:115], v[56:59], v[88:91], v[100:115]
  ds_read_b64_tr_b16 v[42:43], v21 offset:35328
  ds_read_b128 v[72:75], v33 offset:41984
  ds_read_b64_tr_b16 v[44:45], v21 offset:36864
  ds_read_b64_tr_b16 v[46:47], v21 offset:37376
  v_mfma_f32_32x32x16_bf16 v[100:115], v[60:63], v[92:95], v[100:115]
  ds_read_b128 v[76:79], v33 offset:43008
  ds_read_b64_tr_b16 v[48:49], v21 offset:38912
  ds_read_b64_tr_b16 v[50:51], v21 offset:39424
  ds_read_b128 v[80:83], v33 offset:44032
  v_mfma_f32_32x32x16_bf16 v[100:115], v[64:67], v[96:99], v[100:115]
  s_waitcnt lgkmcnt(0)
  s_barrier
  v_mfma_f32_32x32x16_bf16 v[100:115], v[36:39], v[68:71], v[100:115]
  ds_read_b64_tr_b16 v[52:53], v21 offset:40960
  ds_read_b64_tr_b16 v[54:55], v21 offset:41472
  ds_read_b128 v[84:87], v33 offset:49152
  ds_read_b64_tr_b16 v[56:57], v21 offset:43008
  v_mfma_f32_32x32x16_bf16 v[100:115], v[40:43], v[72:75], v[100:115]
  ds_read_b64_tr_b16 v[58:59], v21 offset:43520
  ds_read_b128 v[88:91], v33 offset:50176
  ds_read_b64_tr_b16 v[60:61], v21 offset:45056
  ds_read_b64_tr_b16 v[62:63], v21 offset:45568
  v_mfma_f32_32x32x16_bf16 v[100:115], v[44:47], v[76:79], v[100:115]
  ds_read_b128 v[92:95], v33 offset:51200
  ds_read_b64_tr_b16 v[64:65], v21 offset:47104
  ds_read_b64_tr_b16 v[66:67], v21 offset:47616
  ds_read_b128 v[96:99], v33 offset:52224
  v_mfma_f32_32x32x16_bf16 v[100:115], v[48:51], v[80:83], v[100:115]
  s_waitcnt lgkmcnt(0)
  s_barrier
  s_mov_b32 s85, 0x40000
  s_mov_b64 exec, 1
  s_branch fchk_64
fpoll_62:
  buffer_load_dwordx2 v[18:19], v16, s[60:63], 0 offen sc1
fchk_64:
  s_waitcnt vmcnt(0)
  v_cmp_ne_u64 vcc, s[76:77], v[18:19]
  s_and_b64 exec, exec, vcc
  s_cbranch_execz fdone_63
  s_sub_u32 s85, s85, 1
  s_cbranch_scc1 fdone_63
  s_sleep 2
  s_branch fpoll_62
fdone_63:
  s_mov_b64 exec, -1
  buffer_load_dwordx4 v[24:27], v20, s[60:63], s44 offen offset:0 sc1
  buffer_load_dwordx4 v[28:31], v20, s[60:63], s44 offen offset:1024 sc1
  v_mfma_f32_32x32x16_bf16 v[100:115], v[52:55], v[84:87], v[100:115]
  ds_read_b64_tr_b16 v[36:37], v21 offset:49152
  ds_read_b64_tr_b16 v[38:39], v21 offset:49664
  ds_read_b128 v[68:71], v33 offset:57344
  ds_read_b64_tr_b16 v[40:41], v21 offset:51200
  v_mfma_f32_32x32x16_bf16 v[100:115], v[56:59], v[88:91], v[100:115]
  ds_read_b64_tr_b16 v[42:43], v21 offset:51712
  ds_read_b128 v[72:75], v33 offset:58368
  ds_read_b64_tr_b16 v[44:45], v21 offset:53248
  ds_read_b64_tr_b16 v[46:47], v21 offset:53760
  v_mfma_f32_32x32x16_bf16 v[100:115], v[60:63], v[92:95], v[100:115]
  ds_read_b128 v[76:79], v33 offset:59392
  ds_read_b64_tr_b16 v[48:49], v21 offset:55296
  ds_read_b64_tr_b16 v[50:51], v21 offset:55808
  ds_read_b128 v[80:83], v33 offset:60416
  v_mfma_f32_32x32x16_bf16 v[100:115], v[64:67], v[96:99], v[100:115]
  s_waitcnt lgkmcnt(0)
  s_barrier
  v_mfma_f32_32x32x16_bf16 v[100:115], v[36:39], v[68:71], v[100:115]
  ds_read_b64_tr_b16 v[52:53], v21 offset:57344
  ds_read_b64_tr_b16 v[54:55], v21 offset:57856
  ds_read_b128 v[84:87], v34 offset:0
  ds_read_b64_tr_b16 v[56:57], v21 offset:59392
  v_mfma_f32_32x32x16_bf16 v[100:115], v[40:43], v[72:75], v[100:115]
  ds_read_b64_tr_b16 v[58:59], v21 offset:59904
  ds_read_b128 v[88:91], v34 offset:1024
  ds_read_b64_tr_b16 v[60:61], v21 offset:61440
  ds_read_b64_tr_b16 v[62:63], v21 offset:61952
  v_mfma_f32_32x32x16_bf16 v[100:115], v[44:47], v[76:79], v[100:115]
  ds_read_b128 v[92:95], v34 offset:2048
  ds_read_b64_tr_b16 v[64:65], v21 offset:63488
  ds_read_b64_tr_b16 v[66:67], v21 offset:64000
  ds_read_b128 v[96:99], v34 offset:3072
  v_mfma_f32_32x32x16_bf16 v[100:115], v[48:51], v[80:83], v[100:115]
  s_waitcnt lgkmcnt(0)
  s_barrier
  v_mfma_f32_32x32x16_bf16 v[100:115], v[52:55], v[84:87], v[100:115]
  ds_read_b64_tr_b16 v[36:37], v32 offset:0
  ds_read_b64_tr_b16 v[38:39], v32 offset:512
  ds_read_b128 v[68:71], v34 offset:8192
  ds_read_b64_tr_b16 v[40:41], v32 offset:2048
  v_mfma_f32_32x32x16_bf16 v[100:115], v[56:59], v[88:91], v[100:115]
  ds_read_b64_tr_b16 v[42:43], v32 offset:2560
  ds_read_b128 v[72:75], v34 offset:9216
  ds_read_b64_tr_b16 v[44:45], v32 offset:4096
  ds_read_b64_tr_b16 v[46:47], v32 offset:4608
  v_mfma_f32_32x32x16_bf16 v[100:115], v[60:63], v[92:95], v[100:115]
  ds_read_b128 v[76:79], v34 offset:10240
  ds_read_b64_tr_b16 v[48:49], v32 offset:6144
  ds_read_b64_tr_b16 v[50:51], v32 offset:6656
  ds_read_b128 v[80:83], v34 offset:11264
  v_mfma_f32_32x32x16_bf16 v[100:115], v[64:67], v[96:99], v[100:115]
  s_waitcnt lgkmcnt(0)
  s_barrier
  v_mfma_f32_32x32x16_bf16 v[100:115], v[36:39], v[68:71], v[100:115]
  ds_read_b64_tr_b16 v[52:53], v21 offset:0
  ds_read_b64_tr_b16 v[54:55], v21 offset:512
  ds_read_b128 v[84:87], v34 offset:16384
  ds_read_b64_tr_b16 v[56:57], v21 offset:2048
  v_mfma_f32_32x32x16_bf16 v[100:115], v[40:43], v[72:75], v[100:115]
  ds_read_b64_tr_b16 v[58:59], v21 offset:2560
  ds_read_b128 v[88:91], v34 offset:17408
  ds_read_b64_tr_b16 v[60:61], v21 offset:4096
  ds_read_b64_tr_b16 v[62:63], v21 offset:4608
  v_mfma_f32_32x32x16_bf16 v[100:115], v[44:47], v[76:79], v[100:115]
  ds_read_b128 v[92:95], v34 offset:18432
  ds_read_b64_tr_b16 v[64:65], v21 offset:6144
  ds_read_b64_tr_b16 v[66:67], v21 offset:6656
  ds_read_b128 v[96:99], v34 offset:19456
  v_mfma_f32_32x32x16_bf16 v[100:115], v[48:51], v[80:83], v[100:115]
  s_waitcnt lgkmcnt(0)
  s_barrier
  v_mfma_f32_32x32x16_bf16 v[100:115], v[52:55], v[84:87], v[100:115]
  ds_read_b64_tr_b16 v[36:37], v21 offset:8192
  ds_read_b64_tr_b16 v[38:39], v21 offset:8704
  ds_read_b128 v[68:71], v34 offset:24576
  ds_read_b64_tr_b16 v[40:41], v21 offset:10240
  v_mfma_f32_32x32x16_bf16 v[100:115], v[56:59], v[88:91], v[100:115]
  ds_read_b64_tr_b16 v[42:43], v21 offset:10752
  ds_read_b128 v[72:75], v34 offset:25600
  ds_read_b64_tr_b16 v[44:45], v21 offset:12288
  ds_read_b64_tr_b16 v[46:47], v21 offset:12800
  v_mfma_f32_32x32x16_bf16 v[100:115], v[60:63], v[92:95], v[100:115]
  ds_read_b128 v[76:79], v34 offset:26624
  ds_read_b64_tr_b16 v[48:49], v21 offset:14336
  ds_read_b64_tr_b16 v[50:51], v21 offset:14848
  ds_read_b128 v[80:83], v34 offset:27648
  v_mfma_f32_32x32x16_bf16 v[100:115], v[64:67], v[96:99], v[100:115]
  s_waitcnt lgkmcnt(0)
  v_mfma_f32_32x32x16_bf16 v[100:115], v[36:39], v[68:71], v[100:115]
  v_mfma_f32_32x32x16_bf16 v[100:115], v[40:43], v[72:75], v[100:115]
  v_mfma_f32_32x32x16_bf16 v[100:115], v[44:47], v[76:79], v[100:115]
  v_mfma_f32_32x32x16_bf16 v[100:115], v[48:51], v[80:83], v[100:115]
  s_waitcnt vmcnt(0)
  v_lshlrev_b32 v2, 16, v24
  v_and_b32 v3, 0xffff0000, v24
  v_pk_fma_f32 v[224:225], v[2:3], v[240:241], v[224:225] op_sel_hi:[1,0,1]
  v_lshlrev_b32 v4, 16, v25
  v_and_b32 v5, 0xffff0000, v25
  v_pk_fma_f32 v[226:227], v[4:5], v[240:241], v[226:227] op_sel_hi:[1,0,1]
  v_lshlrev_b32 v2, 16, v26
  v_and_b32 v3, 0xffff0000, v26
  v_pk_fma_f32 v[228:229], v[2:3], v[240:241], v[228:229] op_sel_hi:[1,0,1]
  v_lshlrev_b32 v4, 16, v27
  v_and_b32 v5, 0xffff0000, v27
  v_pk_fma_f32 v[230:231], v[4:5], v[240:241], v[230:231] op_sel_hi:[1,0,1]
  v_lshlrev_b32 v2, 16, v28
  v_and_b32 v3, 0xffff0000, v28
  v_pk_fma_f32 v[232:233], v[2:3], v[240:241], v[232:233] op_sel_hi:[1,0,1]
  v_lshlrev_b32 v4, 16, v29
  v_and_b32 v5, 0xffff0000, v29
  v_pk_fma_f32 v[234:235], v[4:5], v[240:241], v[234:235] op_sel_hi:[1,0,1]
  v_lshlrev_b32 v2, 16, v30
  v_and_b32 v3, 0xffff0000, v30
  v_pk_fma_f32 v[236:237], v[2:3], v[240:241], v[236:237] op_sel_hi:[1,0,1]
  v_lshlrev_b32 v4, 16, v31
  v_and_b32 v5, 0xffff0000, v31
  v_pk_fma_f32 v[238:239], v[4:5], v[240:241], v[238:239] op_sel_hi:[1,0,1]
  v_pk_fma_f32 v[224:225], v[100:101], v[240:241], v[224:225] op_sel:[0,1,0] op_sel_hi:[1,1,1]
  v_pk_fma_f32 v[226:227], v[102:103], v[240:241], v[226:227] op_sel:[0,1,0] op_sel_hi:[1,1,1]
  buffer_store_dwordx4 v[224:227], v15, s[72:75], 0 offen offset:0
  v_pk_fma_f32 v[228:229], v[104:105], v[240:241], v[228:229] op_sel:[0,1,0] op_sel_hi:[1,1,1]
  v_pk_fma_f32 v[230:231], v[106:107], v[240:241], v[230:231] op_sel:[0,1,0] op_sel_hi:[1,1,1]
  buffer_store_dwordx4 v[228:231], v15, s[72:75], 0 offen offset:32
  v_pk_fma_f32 v[232:233], v[108:109], v[240:241], v[232:233] op_sel:[0,1,0] op_sel_hi:[1,1,1]
  v_pk_fma_f32 v[234:235], v[110:111], v[240:241], v[234:235] op_sel:[0,1,0] op_sel_hi:[1,1,1]
  buffer_store_dwordx4 v[232:235], v15, s[72:75], 0 offen offset:64
  v_pk_fma_f32 v[236:237], v[112:113], v[240:241], v[236:237] op_sel:[0,1,0] op_sel_hi:[1,1,1]
  v_pk_fma_f32 v[238:239], v[114:115], v[240:241], v[238:239] op_sel:[0,1,0] op_sel_hi:[1,1,1]
  buffer_store_dwordx4 v[236:239], v15, s[72:75], 0 offen offset:96
  s_endpgm
L_end:
  s_endpgm
.section .rodata,"a"
.p2align 6
.amdhsa_kernel gated_mix__ssm_conv_s5__mixer_gmlp__prompt_kernel
  .amdhsa_next_free_vgpr 256
  .amdhsa_next_free_sgpr 102
  .amdhsa_accum_offset 256
  .amdhsa_group_segment_fixed_size 0
  .amdhsa_kernarg_size 144
  .amdhsa_user_sgpr_count 2
  .amdhsa_user_sgpr_kernarg_segment_ptr 1
  .amdhsa_system_sgpr_workgroup_id_x 1
.end_amdhsa_kernel
```
